```python
import torch

def _softmax(x, axis=-1):
    return torch.softmax(x, dim=axis)
def _gelu(x):
    return torch.nn.functional.gelu(x, approximate="tanh")
def _silu(x):
    return torch.nn.functional.silu(x)
def _sigmoid(x):
    return torch.sigmoid(x)
def _layernorm(x, axis=-1, eps=1e-5):
    m = x.mean(dim=axis, keepdim=True)
    v = x.var(dim=axis, keepdim=True, unbiased=False)
    return (x - m) / torch.sqrt(v + eps)
def _scatter_add(tgt, idx, src, axis=0):
    return tgt.clone().index_add_(axis, idx, src)
def _segment_sum(src, seg, n):
    out = torch.zeros((n,) + src.shape[1:], dtype=src.dtype)
    return out.index_add_(0, seg, src)
def _pad(x, pw):
    flat = tuple(v for pair in reversed(pw) for v in pair)
    return torch.nn.functional.pad(x, flat)

kernel_name = 'parallel_sum__softmax_full_mha__glu_gated_reglu__prompt'

def setup_inputs():

    _w = (lambda a: (lambda t: t.to(torch.bfloat16) if t.is_floating_point() else t)(torch.as_tensor(a)))
    def _A_setup():
        B, S, D = 1, 2048, 640
        return {
            "x": _w((lambda *s: torch.randn(*s, dtype=torch.bfloat16) * 0.05)(B, S, D)),
            "wqkv": _w((lambda *s: torch.randn(*s, dtype=torch.bfloat16) * 0.05)(D, 3 * D)),
            "wo": _w((lambda *s: torch.randn(*s, dtype=torch.bfloat16) * 0.05)(D, D)),
        }
    _A_in = _A_setup()

    def _B_setup():
        B, S, D, F = 1, 2048, 640, 1536
        return {
            "x": _w((lambda *s: torch.randn(*s, dtype=torch.bfloat16) * 0.05)(B, S, D)),
            "W_gate": _w((lambda *s: torch.randn(*s, dtype=torch.bfloat16) * 0.4)(D, F) * (2.0 / D) ** 0.5),
            "W_up": _w((lambda *s: torch.randn(*s, dtype=torch.bfloat16) * 0.4)(D, F) * (2.0 / D) ** 0.5),
            "W_down": _w((lambda *s: torch.randn(*s, dtype=torch.bfloat16) * 0.4)(F, D) * (1.0 / F) ** 0.5),
        }
    _B_in = _B_setup()

    return {
        "A_x": _A_in["x"],
        "A_wqkv": _A_in["wqkv"],
        "A_wo": _A_in["wo"],
        "B_x": _B_in["x"],
        "B_W_gate": _B_in["W_gate"],
        "B_W_up": _B_in["W_up"],
        "B_W_down": _B_in["W_down"],
    }

def reference(A_x, A_wqkv, A_wo, B_x, B_W_gate, B_W_up, B_W_down):
    def _A_ref(x, wqkv, wo):
        B, S, D = x.shape
        H = 32; Dh = D // H
        qkv = (lambda x, *d: x.permute(*d))((x @ wqkv).reshape(B, S, 3, H, Dh), 2, 0, 3, 1, 4)
        q, k, v = qkv[0], qkv[1], qkv[2]
        scale = Dh ** -0.5
        scores = torch.einsum("bhqd,bhkd->bhqk", q, k) * scale
        p = _softmax(scores, axis=-1)
        o = torch.einsum("bhqk,bhkd->bhqd", p, v)
        return (lambda x, *d: x.permute(*d))(o, 0, 2, 1, 3).reshape(B, S, D) @ wo

    def _B_ref(x, W_gate, W_up, W_down):
        gate = torch.einsum("bsd,df->bsf", x, W_gate)
        up = torch.einsum("bsd,df->bsf", x, W_up)
        gate = gate * (lambda x, dt: x.to(dt))(gate > 0, gate.dtype)
        h = gate * up
        return torch.einsum("bsf,fd->bsd", h, W_down)

    x = A_x
    xn = _layernorm(x, axis=-1)
    return x + _A_ref(xn, A_wqkv, A_wo) + _B_ref(xn, B_W_gate, B_W_up, B_W_down)
```

```asm
; @launch grid=(256,1,1) block=(512,1,1) lds=163840
.amdgcn_target "amdgcn-amd-amdhsa--gfx950"
.text
.globl parallel_sum__softmax_full_mha__glu_gated_reglu__prompt_kernel
.p2align 8
.type parallel_sum__softmax_full_mha__glu_gated_reglu__prompt_kernel,@function
parallel_sum__softmax_full_mha__glu_gated_reglu__prompt_kernel:
  s_cmp_ge_u32 s2, 256
  s_cbranch_scc1 L_end
  s_load_dwordx4 s[4:7], s[0:1], 0
  s_load_dwordx2 s[50:51], s[0:1], 16
  s_load_dwordx4 s[52:55], s[0:1], 32
  s_load_dwordx4 s[64:67], s[0:1], 48
  s_load_dwordx4 s[68:71], s[0:1], 64
  v_lshrrev_b32 v1, 6, v0
  v_and_b32 v2, 63, v0
  v_readfirstlane_b32 s38, v1
  s_and_b32 s42, s2, 7
  s_lshr_b32 s41, s2, 3
  s_lshr_b32 s39, s42, 2
  s_lshl_b32 s39, s39, 3
  s_and_b32 s3, s41, 7
  s_add_u32 s39, s39, s3
  s_and_b32 s43, s42, 3
  s_lshl_b32 s43, s43, 2
  s_lshr_b32 s3, s41, 3
  s_add_u32 s43, s43, s3
  s_min_u32 s40, s43, 14
  s_and_b32 s59, s38, 3
  s_mov_b32 s44, -1
  s_mov_b32 s45, 0
  s_mov_b32 s46, 0xfffff
  s_mov_b32 s47, 0xfffff
  v_and_b32 v3, 31, v2
  v_lshrrev_b32 v4, 5, v2
  s_lshl_b32 s60, s39, 4
  s_add_u32 s60, s60, s43
  s_mul_i32 s60, s60, 3
  s_add_u32 s60, s60, s38
  s_mul_i32 s61, s60, 6554
  s_lshr_b32 s61, s61, 16
  s_mul_i32 s63, s59, 49152
  s_mul_i32 s3, s43, 192
  s_add_u32 s63, s63, s3
  s_waitcnt lgkmcnt(0)
  s_mov_b32 s8, s4
  s_and_b32 s9, s5, 0xffff
  s_mov_b32 s10, 2621440
  s_mov_b32 s11, 0x20000
  s_mov_b32 s12, s6
  s_and_b32 s13, s7, 0xffff
  s_mov_b32 s14, 2457600
  s_mov_b32 s15, 0x20000
  s_mov_b32 s16, s70
  s_and_b32 s17, s71, 0xffff
  s_mov_b32 s18, 29360128
  s_mov_b32 s19, 0x20000
  s_mov_b32 s20, s52
  s_and_b32 s21, s53, 0xffff
  s_mov_b32 s22, 1966080
  s_mov_b32 s23, 0x20000
  s_mov_b32 s24, s54
  s_and_b32 s25, s55, 0xffff
  s_mov_b32 s26, 1966080
  s_mov_b32 s27, 0x20000
  s_mov_b32 s28, s66
  s_and_b32 s29, s67, 0xffff
  s_mov_b32 s30, 2621440
  s_mov_b32 s31, 0x20000
  s_mov_b64 s[36:37], s[68:69]
  s_cmp_lt_u32 s61, 20
  s_cselect_b32 s32, s50, s64
  s_cselect_b32 s33, s51, s65
  s_mov_b32 s34, 1966080
  s_cselect_b32 s34, 819200, s34
  s_and_b32 s33, s33, 0xffff
  s_mov_b32 s35, 0x20000
  s_mul_i32 s50, s41, 12
  s_mul_i32 s51, s59, 3
  s_add_u32 s50, s50, s51
  s_lshr_b32 s54, s38, 2
  s_xor_b32 s54, s54, 1
  s_mov_b32 s7, 0x20000
  s_cmp_ge_u32 s50, 255
  s_cbranch_scc1 L_pf_1_w
  s_mov_b32 s4, s8
  s_mov_b32 s5, s9
  s_mov_b32 s6, s10
  s_movk_i32 s3, 256
  v_lshrrev_b32 v214, 3, v2
  v_mul_u32_u24 v214, 1280, v214
  v_and_b32 v1, 7, v2
  v_lshl_add_u32 v214, v1, 4, v214
  s_lshr_b32 s51, s42, 2
  s_mul_i32 s51, s51, 1310720
  s_add_u32 s52, s50, 0
  s_lshr_b32 s53, s52, 1
  s_mul_i32 s53, s53, 10240
  s_and_b32 s52, s52, 1
  s_lshl_b32 s52, s52, 7
  s_add_u32 s53, s53, s52
  s_add_u32 s69, s53, s51
  s_add_u32 s52, s50, 1
  s_lshr_b32 s53, s52, 1
  s_mul_i32 s53, s53, 10240
  s_and_b32 s52, s52, 1
  s_lshl_b32 s52, s52, 7
  s_add_u32 s53, s53, s52
  s_add_u32 s70, s53, s51
  s_add_u32 s52, s50, 2
  s_lshr_b32 s53, s52, 1
  s_mul_i32 s53, s53, 10240
  s_and_b32 s52, s52, 1
  s_lshl_b32 s52, s52, 7
  s_add_u32 s53, s53, s52
  s_add_u32 s71, s53, s51
  s_branch L_pf_1
L_pf_1_w:
  s_mov_b32 s4, s12
  s_mov_b32 s5, s13
  s_mov_b32 s6, s14
  s_mov_b32 s3, 491520
  v_lshlrev_b32 v214, 4, v2
  s_sub_u32 s50, s50, 255
  s_mul_i32 s50, s50, 3840
  s_and_b32 s51, s42, 3
  s_lshl_b32 s51, s51, 10
  s_add_u32 s50, s50, s51
  s_add_u32 s69, s50, 0
  s_add_u32 s70, s50, 3840
  s_add_u32 s71, s50, 7680
L_pf_1:
  s_mul_i32 s50, s54, s3
  s_add_u32 s69, s69, s50
  s_add_u32 s70, s70, s50
  s_add_u32 s71, s71, s50
  buffer_load_dwordx4 v[216:219], v214, s[4:7], s69 offen
  s_add_u32 s69, s69, s3
  buffer_load_dwordx4 v[216:219], v214, s[4:7], s70 offen
  s_add_u32 s70, s70, s3
  buffer_load_dwordx4 v[216:219], v214, s[4:7], s71 offen
  s_add_u32 s71, s71, s3
  s_lshl_b32 s67, s39, 3
  s_add_u32 s67, s67, s38
  s_lshl_b32 s67, s67, 4
  s_add_u32 s67, s67, s43
  s_lshl_b32 s67, s67, 7
  s_add_u32 s67, s67, 28442624
  s_or_b32 s50, s2, s38
  s_cmp_lg_u32 s50, 0
  s_cbranch_scc1 L_nonce_done
  s_memrealtime s[50:51]
  v_mov_b32 v9, 0
  s_waitcnt lgkmcnt(0)
  s_or_b32 s50, s50, 1
  v_mov_b32 v10, s50
  s_mov_b64 exec, 1
  global_store_dword v9, v10, s[36:37] sc1
  s_mov_b64 exec, -1
L_nonce_done:
  v_lshrrev_b32 v9, 4, v2
  v_lshrrev_b32 v10, 3, v2
  v_mul_u32_u24 v10, 1280, v10
  v_and_b32 v11, 7, v2
  v_xor_b32 v220, v11, v9
  v_xor_b32 v221, 4, v220
  v_lshl_add_u32 v220, v220, 4, v10
  v_lshl_add_u32 v221, v221, 4, v10
  s_lshl_b32 s64, s39, 7
  s_lshl_b32 s50, s59, 5
  s_add_u32 s64, s64, s50
  s_mul_i32 s64, s64, 1280
  s_lshl_b32 s65, s59, 12
  s_mul_i32 s66, s59, 3072
  s_cmp_ge_u32 s38, 4
  s_cbranch_scc1 L_B
  buffer_load_dwordx4 v[216:219], v214, s[4:7], s69 offen
  buffer_load_dwordx4 v[216:219], v214, s[4:7], s70 offen
  buffer_load_dwordx4 v[216:219], v214, s[4:7], s71 offen
  v_add_u32 v10, 0, v2
  v_mul_u32_u24 v11, 5462, v10
  v_lshrrev_b32 v11, 16, v11
  v_mul_u32_u24 v9, 12, v11
  v_sub_u32 v9, v10, v9
  v_mul_u32_u24 v11, 3072, v11
  v_lshl_add_u32 v222, v9, 4, v11
  v_add_u32 v10, 64, v2
  v_mul_u32_u24 v11, 5462, v10
  v_lshrrev_b32 v11, 16, v11
  v_mul_u32_u24 v9, 12, v11
  v_sub_u32 v9, v10, v9
  v_mul_u32_u24 v11, 3072, v11
  v_lshl_add_u32 v223, v9, 4, v11
  v_add_u32 v10, 128, v2
  v_mul_u32_u24 v11, 5462, v10
  v_lshrrev_b32 v11, 16, v11
  v_mul_u32_u24 v9, 12, v11
  v_sub_u32 v9, v10, v9
  v_mul_u32_u24 v11, 3072, v11
  v_lshl_add_u32 v224, v9, 4, v11
  v_lshrrev_b32 v9, 4, v2
  v_and_b32 v9, 1, v9
  v_and_b32 v10, 15, v2
  v_cmp_eq_u32 vcc, v10, v9
  v_mov_b32 v10, 0x3f803f80
  s_nop 0
  v_cndmask_b32 v168, 0, v10, vcc
  v_cndmask_b32 v169, 0, v10, vcc
  v_cndmask_b32 v170, 0, v10, vcc
  v_cndmask_b32 v171, 0, v10, vcc
  s_and_b32 s68, s38, 1
  s_lshr_b32 s69, s38, 1
  v_lshrrev_b32 v5, 1, v3
  v_and_b32 v5, 7, v5
  s_xor_b32 s50, s69, 0
  s_lshl_b32 s51, s68, 1
  s_add_u32 s50, s50, s51
  s_lshl_b32 s50, s50, 12
  v_lshl_add_u32 v6, v3, 7, s50
  v_or_b32 v7, 0, v4
  v_xor_b32 v7, v7, v5
  v_lshl_add_u32 v40, v7, 4, v6
  v_or_b32 v7, 2, v4
  v_xor_b32 v7, v7, v5
  v_lshl_add_u32 v41, v7, 4, v6
  v_or_b32 v7, 4, v4
  v_xor_b32 v7, v7, v5
  v_lshl_add_u32 v42, v7, 4, v6
  v_or_b32 v7, 6, v4
  v_xor_b32 v7, v7, v5
  v_lshl_add_u32 v43, v7, 4, v6
  s_xor_b32 s50, s69, 1
  s_lshl_b32 s51, s68, 1
  s_add_u32 s50, s50, s51
  s_lshl_b32 s50, s50, 12
  v_lshl_add_u32 v6, v3, 7, s50
  v_or_b32 v7, 0, v4
  v_xor_b32 v7, v7, v5
  v_lshl_add_u32 v44, v7, 4, v6
  v_or_b32 v7, 2, v4
  v_xor_b32 v7, v7, v5
  v_lshl_add_u32 v45, v7, 4, v6
  v_or_b32 v7, 4, v4
  v_xor_b32 v7, v7, v5
  v_lshl_add_u32 v46, v7, 4, v6
  v_or_b32 v7, 6, v4
  v_xor_b32 v7, v7, v5
  v_lshl_add_u32 v47, v7, 4, v6
  v_lshrrev_b32 v5, 2, v2
  v_and_b32 v5, 3, v5
  v_lshl_add_u32 v6, v4, 3, v5
  v_lshlrev_b32 v6, 8, v6
  v_lshrrev_b32 v7, 4, v2
  v_and_b32 v7, 1, v7
  v_lshl_add_u32 v6, v7, 5, v6
  v_and_b32 v7, 3, v2
  v_lshl_add_u32 v6, v7, 3, v6
  v_add_u32 v6, 0x10000, v6
  s_xor_b32 s50, s68, 0
  s_lshl_b32 s51, s69, 1
  s_add_u32 s50, s50, s51
  v_xor_b32 v7, s50, v5
  v_lshl_add_u32 v56, v7, 6, v6
  s_xor_b32 s50, s68, 1
  s_lshl_b32 s51, s69, 1
  s_add_u32 s50, s50, s51
  v_xor_b32 v7, s50, v5
  v_lshl_add_u32 v57, v7, 6, v6
  v_mov_b32 v64, 0
  v_mov_b32 v65, 0
  v_mov_b32 v66, 0
  v_mov_b32 v67, 0
  v_mov_b32 v68, 0
  v_mov_b32 v69, 0
  v_mov_b32 v70, 0
  v_mov_b32 v71, 0
  v_mov_b32 v72, 0
  v_mov_b32 v73, 0
  v_mov_b32 v74, 0
  v_mov_b32 v75, 0
  v_mov_b32 v76, 0
  v_mov_b32 v77, 0
  v_mov_b32 v78, 0
  v_mov_b32 v79, 0
  v_mov_b32 v80, 0
  v_mov_b32 v81, 0
  v_mov_b32 v82, 0
  v_mov_b32 v83, 0
  v_mov_b32 v84, 0
  v_mov_b32 v85, 0
  v_mov_b32 v86, 0
  v_mov_b32 v87, 0
  v_mov_b32 v88, 0
  v_mov_b32 v89, 0
  v_mov_b32 v90, 0
  v_mov_b32 v91, 0
  v_mov_b32 v92, 0
  v_mov_b32 v93, 0
  v_mov_b32 v94, 0
  v_mov_b32 v95, 0
  v_mov_b32 v96, 0
  v_mov_b32 v97, 0
  v_mov_b32 v98, 0
  v_mov_b32 v99, 0
  v_mov_b32 v100, 0
  v_mov_b32 v101, 0
  v_mov_b32 v102, 0
  v_mov_b32 v103, 0
  v_mov_b32 v104, 0
  v_mov_b32 v105, 0
  v_mov_b32 v106, 0
  v_mov_b32 v107, 0
  v_mov_b32 v108, 0
  v_mov_b32 v109, 0
  v_mov_b32 v110, 0
  v_mov_b32 v111, 0
  v_mov_b32 v112, 0
  v_mov_b32 v113, 0
  v_mov_b32 v114, 0
  v_mov_b32 v115, 0
  v_mov_b32 v116, 0
  v_mov_b32 v117, 0
  v_mov_b32 v118, 0
  v_mov_b32 v119, 0
  v_mov_b32 v120, 0
  v_mov_b32 v121, 0
  v_mov_b32 v122, 0
  v_mov_b32 v123, 0
  v_mov_b32 v124, 0
  v_mov_b32 v125, 0
  v_mov_b32 v126, 0
  v_mov_b32 v127, 0
  v_mov_b32 v172, 0
  v_mov_b32 v60, 0
  v_mov_b32 v173, 0
  v_mov_b32 v61, 0
  v_mov_b32 v174, 0
  v_mov_b32 v62, 0
  v_mov_b32 v175, 0
  v_mov_b32 v63, 0
  v_mov_b32 v58, 0
  v_mov_b32 v59, 0
  s_mul_i32 s52, s61, 10
  s_sub_u32 s52, s60, s52
  s_cmp_lt_u32 s61, 20
  s_cselect_b32 s53, 0, 20
  s_cselect_b64 s[48:49], -1, 0
  s_sub_u32 s53, s61, s53
  s_lshl_b32 s53, s53, 5
  s_lshl_b32 s70, s52, 7
  s_lshl_b32 s71, s38, 12
  s_add_u32 s71, s71, 90112
  v_lshrrev_b32 v5, 3, v2
  v_and_b32 v6, 7, v2
  v_add_u32 v7, s53, v5
  v_mul_u32_u24 v176, 1639, v7
  v_lshrrev_b32 v176, 16, v176
  v_mul_u32_u24 v176, 40, v176
  v_sub_u32 v176, v7, v176
  v_cmp_le_u32 vcc, 24, v176
  v_cmp_le_u32 s[56:57], 20, v176
  v_mov_b32 v177, 16
  s_nop 0
  v_cndmask_b32 v177, 0, v177, s[56:57]
  v_cndmask_b32 v177, v177, -4, vcc
  v_cndmask_b32 v177, 0, v177, s[48:49]
  v_add_u32 v7, v7, v177
  v_mul_u32_u24 v7, 1280, v7
  v_lshl_add_u32 v230, v6, 4, v7
  v_add_u32 v230, s70, v230
  v_add_u32 v7, s53, v5
  v_add_u32 v7, 8, v7
  v_mul_u32_u24 v176, 1639, v7
  v_lshrrev_b32 v176, 16, v176
  v_mul_u32_u24 v176, 40, v176
  v_sub_u32 v176, v7, v176
  v_cmp_le_u32 vcc, 24, v176
  v_cmp_le_u32 s[56:57], 20, v176
  v_mov_b32 v177, 16
  s_nop 0
  v_cndmask_b32 v177, 0, v177, s[56:57]
  v_cndmask_b32 v177, v177, -4, vcc
  v_cndmask_b32 v177, 0, v177, s[48:49]
  v_add_u32 v7, v7, v177
  v_mul_u32_u24 v7, 1280, v7
  v_lshl_add_u32 v231, v6, 4, v7
  v_add_u32 v231, s70, v231
  v_add_u32 v7, s53, v5
  v_add_u32 v7, 16, v7
  v_mul_u32_u24 v176, 1639, v7
  v_lshrrev_b32 v176, 16, v176
  v_mul_u32_u24 v176, 40, v176
  v_sub_u32 v176, v7, v176
  v_cmp_le_u32 vcc, 24, v176
  v_cmp_le_u32 s[56:57], 20, v176
  v_mov_b32 v177, 16
  s_nop 0
  v_cndmask_b32 v177, 0, v177, s[56:57]
  v_cndmask_b32 v177, v177, -4, vcc
  v_cndmask_b32 v177, 0, v177, s[48:49]
  v_add_u32 v7, v7, v177
  v_mul_u32_u24 v7, 1280, v7
  v_lshl_add_u32 v232, v6, 4, v7
  v_add_u32 v232, s70, v232
  v_add_u32 v7, s53, v5
  v_add_u32 v7, 24, v7
  v_mul_u32_u24 v176, 1639, v7
  v_lshrrev_b32 v176, 16, v176
  v_mul_u32_u24 v176, 40, v176
  v_sub_u32 v176, v7, v176
  v_cmp_le_u32 vcc, 24, v176
  v_cmp_le_u32 s[56:57], 20, v176
  v_mov_b32 v177, 16
  s_nop 0
  v_cndmask_b32 v177, 0, v177, s[56:57]
  v_cndmask_b32 v177, v177, -4, vcc
  v_cndmask_b32 v177, 0, v177, s[48:49]
  v_add_u32 v7, v7, v177
  v_mul_u32_u24 v7, 1280, v7
  v_lshl_add_u32 v233, v6, 4, v7
  v_add_u32 v233, s70, v233
  v_lshrrev_b32 v5, 4, v2
  v_lshrrev_b32 v6, 2, v2
  v_and_b32 v6, 3, v6
  v_lshl_add_u32 v5, v5, 3, v6
  v_lshlrev_b32 v5, 7, v5
  v_and_b32 v6, 3, v2
  v_lshl_add_u32 v5, v6, 3, v5
  v_add_u32 v234, s71, v5
  s_and_b32 s50, s38, 1
  s_cmp_eq_u32 s50, 0
  s_cselect_b32 s4, s20, s24
  s_cselect_b32 s5, s21, s25
  s_mov_b32 s6, 1966080
  s_lshl_b32 s50, s41, 1
  s_lshr_b32 s51, s59, 1
  s_add_u32 s50, s50, s51
  s_mul_i32 s3, s50, 12288
  s_and_b32 s50, s42, 3
  s_mul_i32 s50, s50, 768
  s_add_u32 s3, s3, s50
  v_lshrrev_b32 v214, 4, v2
  v_mul_u32_u24 v214, 3072, v214
  v_and_b32 v1, 15, v2
  v_lshl_add_u32 v214, v1, 4, v214
  s_cmp_ge_u32 s40, 10
  s_cbranch_scc1 L_p1_vtype
  s_barrier
  ds_read_b128 v[8:11], v40 offset:0
  ds_read_b64_tr_b16 v[24:25], v56 offset:0
  ds_read_b64_tr_b16 v[26:27], v56 offset:1024
  ds_read_b64_tr_b16 v[28:29], v57 offset:0
  ds_read_b64_tr_b16 v[30:31], v57 offset:1024
  ds_read_b128 v[12:15], v44 offset:0
  s_waitcnt lgkmcnt(3)
  v_mfma_f32_32x32x16_bf16 v[64:79], v[24:27], v[8:11], v[64:79]
  ds_read_b128 v[16:19], v41 offset:0
  ds_read_b64_tr_b16 v[32:33], v56 offset:4096
  s_waitcnt lgkmcnt(3)
  v_mfma_f32_32x32x16_bf16 v[80:95], v[28:31], v[8:11], v[80:95]
  ds_read_b64_tr_b16 v[34:35], v56 offset:5120
  ds_read_b64_tr_b16 v[36:37], v57 offset:4096
  s_waitcnt lgkmcnt(4)
  v_mfma_f32_32x32x16_bf16 v[96:111], v[24:27], v[12:15], v[96:111]
  ds_read_b64_tr_b16 v[38:39], v57 offset:5120
  ds_read_b128 v[20:23], v45 offset:0
  v_mfma_f32_16x16x32_bf16 v[172:175], v[168:171], v[24:27], v[172:175]
  v_mfma_f32_32x32x16_bf16 v[112:127], v[28:31], v[12:15], v[112:127]
  v_mfma_f32_16x16x32_bf16 v[60:63], v[168:171], v[8:11], v[60:63]
  s_waitcnt lgkmcnt(3)
  v_mfma_f32_32x32x16_bf16 v[64:79], v[32:35], v[16:19], v[64:79]
  ds_read_b128 v[8:11], v42 offset:0
  ds_read_b64_tr_b16 v[24:25], v56 offset:8192
  s_waitcnt lgkmcnt(3)
  v_mfma_f32_32x32x16_bf16 v[80:95], v[36:39], v[16:19], v[80:95]
  ds_read_b64_tr_b16 v[26:27], v56 offset:9216
  ds_read_b64_tr_b16 v[28:29], v57 offset:8192
  s_waitcnt lgkmcnt(4)
  v_mfma_f32_32x32x16_bf16 v[96:111], v[32:35], v[20:23], v[96:111]
  ds_read_b64_tr_b16 v[30:31], v57 offset:9216
  ds_read_b128 v[12:15], v46 offset:0
  v_mfma_f32_16x16x32_bf16 v[172:175], v[168:171], v[32:35], v[172:175]
  v_mfma_f32_32x32x16_bf16 v[112:127], v[36:39], v[20:23], v[112:127]
  v_mfma_f32_16x16x32_bf16 v[60:63], v[168:171], v[16:19], v[60:63]
  s_waitcnt lgkmcnt(3)
  v_mfma_f32_32x32x16_bf16 v[64:79], v[24:27], v[8:11], v[64:79]
  ds_read_b128 v[16:19], v43 offset:0
  ds_read_b64_tr_b16 v[32:33], v56 offset:12288
  s_waitcnt lgkmcnt(3)
  v_mfma_f32_32x32x16_bf16 v[80:95], v[28:31], v[8:11], v[80:95]
  ds_read_b64_tr_b16 v[34:35], v56 offset:13312
  ds_read_b64_tr_b16 v[36:37], v57 offset:12288
  s_waitcnt lgkmcnt(4)
  v_mfma_f32_32x32x16_bf16 v[96:111], v[24:27], v[12:15], v[96:111]
  ds_read_b64_tr_b16 v[38:39], v57 offset:13312
  ds_read_b128 v[20:23], v47 offset:0
  v_mfma_f32_16x16x32_bf16 v[172:175], v[168:171], v[24:27], v[172:175]
  v_mfma_f32_32x32x16_bf16 v[112:127], v[28:31], v[12:15], v[112:127]
  v_mfma_f32_16x16x32_bf16 v[60:63], v[168:171], v[8:11], v[60:63]
  s_waitcnt lgkmcnt(0)
  s_barrier
  v_mfma_f32_32x32x16_bf16 v[64:79], v[32:35], v[16:19], v[64:79]
  ds_read_b128 v[8:11], v40 offset:16384
  ds_read_b64_tr_b16 v[24:25], v56 offset:16384
  v_mfma_f32_32x32x16_bf16 v[80:95], v[36:39], v[16:19], v[80:95]
  ds_read_b64_tr_b16 v[26:27], v56 offset:17408
  ds_read_b64_tr_b16 v[28:29], v57 offset:16384
  v_mfma_f32_32x32x16_bf16 v[96:111], v[32:35], v[20:23], v[96:111]
  ds_read_b64_tr_b16 v[30:31], v57 offset:17408
  ds_read_b128 v[12:15], v44 offset:16384
  v_mfma_f32_16x16x32_bf16 v[172:175], v[168:171], v[32:35], v[172:175]
  v_mfma_f32_32x32x16_bf16 v[112:127], v[36:39], v[20:23], v[112:127]
  v_mfma_f32_16x16x32_bf16 v[60:63], v[168:171], v[16:19], v[60:63]
  s_waitcnt lgkmcnt(3)
  v_mfma_f32_32x32x16_bf16 v[64:79], v[24:27], v[8:11], v[64:79]
  ds_read_b128 v[16:19], v41 offset:16384
  ds_read_b64_tr_b16 v[32:33], v56 offset:20480
  s_waitcnt lgkmcnt(3)
  v_mfma_f32_32x32x16_bf16 v[80:95], v[28:31], v[8:11], v[80:95]
  ds_read_b64_tr_b16 v[34:35], v56 offset:21504
  ds_read_b64_tr_b16 v[36:37], v57 offset:20480
  s_waitcnt lgkmcnt(4)
  v_mfma_f32_32x32x16_bf16 v[96:111], v[24:27], v[12:15], v[96:111]
  ds_read_b64_tr_b16 v[38:39], v57 offset:21504
  ds_read_b128 v[20:23], v45 offset:16384
  v_mfma_f32_16x16x32_bf16 v[172:175], v[168:171], v[24:27], v[172:175]
  v_mfma_f32_32x32x16_bf16 v[112:127], v[28:31], v[12:15], v[112:127]
  v_mfma_f32_16x16x32_bf16 v[60:63], v[168:171], v[8:11], v[60:63]
  s_waitcnt lgkmcnt(3)
  v_mfma_f32_32x32x16_bf16 v[64:79], v[32:35], v[16:19], v[64:79]
  ds_read_b128 v[8:11], v42 offset:16384
  ds_read_b64_tr_b16 v[24:25], v56 offset:24576
  s_waitcnt lgkmcnt(3)
  v_mfma_f32_32x32x16_bf16 v[80:95], v[36:39], v[16:19], v[80:95]
  ds_read_b64_tr_b16 v[26:27], v56 offset:25600
  ds_read_b64_tr_b16 v[28:29], v57 offset:24576
  s_waitcnt lgkmcnt(4)
  v_mfma_f32_32x32x16_bf16 v[96:111], v[32:35], v[20:23], v[96:111]
  ds_read_b64_tr_b16 v[30:31], v57 offset:25600
  ds_read_b128 v[12:15], v46 offset:16384
  v_mfma_f32_16x16x32_bf16 v[172:175], v[168:171], v[32:35], v[172:175]
  v_mfma_f32_32x32x16_bf16 v[112:127], v[36:39], v[20:23], v[112:127]
  v_mfma_f32_16x16x32_bf16 v[60:63], v[168:171], v[16:19], v[60:63]
  s_waitcnt lgkmcnt(3)
  v_mfma_f32_32x32x16_bf16 v[64:79], v[24:27], v[8:11], v[64:79]
  ds_read_b128 v[16:19], v43 offset:16384
  ds_read_b64_tr_b16 v[32:33], v56 offset:28672
  s_waitcnt lgkmcnt(3)
  v_mfma_f32_32x32x16_bf16 v[80:95], v[28:31], v[8:11], v[80:95]
  ds_read_b64_tr_b16 v[34:35], v56 offset:29696
  ds_read_b64_tr_b16 v[36:37], v57 offset:28672
  s_waitcnt lgkmcnt(4)
  v_mfma_f32_32x32x16_bf16 v[96:111], v[24:27], v[12:15], v[96:111]
  ds_read_b64_tr_b16 v[38:39], v57 offset:29696
  ds_read_b128 v[20:23], v47 offset:16384
  v_mfma_f32_16x16x32_bf16 v[172:175], v[168:171], v[24:27], v[172:175]
  v_mfma_f32_32x32x16_bf16 v[112:127], v[28:31], v[12:15], v[112:127]
  v_mfma_f32_16x16x32_bf16 v[60:63], v[168:171], v[8:11], v[60:63]
  s_waitcnt lgkmcnt(0)
  s_barrier
  v_mfma_f32_32x32x16_bf16 v[64:79], v[32:35], v[16:19], v[64:79]
  ds_read_b128 v[8:11], v40 offset:32768
  ds_read_b64_tr_b16 v[24:25], v56 offset:32768
  v_mfma_f32_32x32x16_bf16 v[80:95], v[36:39], v[16:19], v[80:95]
  ds_read_b64_tr_b16 v[26:27], v56 offset:33792
  ds_read_b64_tr_b16 v[28:29], v57 offset:32768
  v_mfma_f32_32x32x16_bf16 v[96:111], v[32:35], v[20:23], v[96:111]
  ds_read_b64_tr_b16 v[30:31], v57 offset:33792
  ds_read_b128 v[12:15], v44 offset:32768
  v_mfma_f32_16x16x32_bf16 v[172:175], v[168:171], v[32:35], v[172:175]
  v_mfma_f32_32x32x16_bf16 v[112:127], v[36:39], v[20:23], v[112:127]
  v_mfma_f32_16x16x32_bf16 v[60:63], v[168:171], v[16:19], v[60:63]
  s_waitcnt lgkmcnt(3)
  v_mfma_f32_32x32x16_bf16 v[64:79], v[24:27], v[8:11], v[64:79]
  ds_read_b128 v[16:19], v41 offset:32768
  ds_read_b64_tr_b16 v[32:33], v56 offset:36864
  s_waitcnt lgkmcnt(3)
  v_mfma_f32_32x32x16_bf16 v[80:95], v[28:31], v[8:11], v[80:95]
  ds_read_b64_tr_b16 v[34:35], v56 offset:37888
  ds_read_b64_tr_b16 v[36:37], v57 offset:36864
  s_waitcnt lgkmcnt(4)
  v_mfma_f32_32x32x16_bf16 v[96:111], v[24:27], v[12:15], v[96:111]
  ds_read_b64_tr_b16 v[38:39], v57 offset:37888
  ds_read_b128 v[20:23], v45 offset:32768
  v_mfma_f32_16x16x32_bf16 v[172:175], v[168:171], v[24:27], v[172:175]
  v_mfma_f32_32x32x16_bf16 v[112:127], v[28:31], v[12:15], v[112:127]
  v_mfma_f32_16x16x32_bf16 v[60:63], v[168:171], v[8:11], v[60:63]
  s_waitcnt lgkmcnt(3)
  v_mfma_f32_32x32x16_bf16 v[64:79], v[32:35], v[16:19], v[64:79]
  ds_read_b128 v[8:11], v42 offset:32768
  ds_read_b64_tr_b16 v[24:25], v56 offset:40960
  s_waitcnt lgkmcnt(3)
  v_mfma_f32_32x32x16_bf16 v[80:95], v[36:39], v[16:19], v[80:95]
  ds_read_b64_tr_b16 v[26:27], v56 offset:41984
  ds_read_b64_tr_b16 v[28:29], v57 offset:40960
  s_waitcnt lgkmcnt(4)
  v_mfma_f32_32x32x16_bf16 v[96:111], v[32:35], v[20:23], v[96:111]
  ds_read_b64_tr_b16 v[30:31], v57 offset:41984
  ds_read_b128 v[12:15], v46 offset:32768
  v_mfma_f32_16x16x32_bf16 v[172:175], v[168:171], v[32:35], v[172:175]
  v_mfma_f32_32x32x16_bf16 v[112:127], v[36:39], v[20:23], v[112:127]
  v_mfma_f32_16x16x32_bf16 v[60:63], v[168:171], v[16:19], v[60:63]
  s_waitcnt lgkmcnt(3)
  v_mfma_f32_32x32x16_bf16 v[64:79], v[24:27], v[8:11], v[64:79]
  ds_read_b128 v[16:19], v43 offset:32768
  ds_read_b64_tr_b16 v[32:33], v56 offset:45056
  s_waitcnt lgkmcnt(3)
  v_mfma_f32_32x32x16_bf16 v[80:95], v[28:31], v[8:11], v[80:95]
  ds_read_b64_tr_b16 v[34:35], v56 offset:46080
  ds_read_b64_tr_b16 v[36:37], v57 offset:45056
  s_waitcnt lgkmcnt(4)
  v_mfma_f32_32x32x16_bf16 v[96:111], v[24:27], v[12:15], v[96:111]
  ds_read_b64_tr_b16 v[38:39], v57 offset:46080
  ds_read_b128 v[20:23], v47 offset:32768
  v_mfma_f32_16x16x32_bf16 v[172:175], v[168:171], v[24:27], v[172:175]
  v_mfma_f32_32x32x16_bf16 v[112:127], v[28:31], v[12:15], v[112:127]
  v_mfma_f32_16x16x32_bf16 v[60:63], v[168:171], v[8:11], v[60:63]
  s_waitcnt lgkmcnt(0)
  s_barrier
  v_mfma_f32_32x32x16_bf16 v[64:79], v[32:35], v[16:19], v[64:79]
  ds_read_b128 v[8:11], v40 offset:49152
  ds_read_b64_tr_b16 v[24:25], v56 offset:49152
  v_mfma_f32_32x32x16_bf16 v[80:95], v[36:39], v[16:19], v[80:95]
  ds_read_b64_tr_b16 v[26:27], v56 offset:50176
  ds_read_b64_tr_b16 v[28:29], v57 offset:49152
  v_mfma_f32_32x32x16_bf16 v[96:111], v[32:35], v[20:23], v[96:111]
  ds_read_b64_tr_b16 v[30:31], v57 offset:50176
  ds_read_b128 v[12:15], v44 offset:49152
  v_mfma_f32_16x16x32_bf16 v[172:175], v[168:171], v[32:35], v[172:175]
  v_mfma_f32_32x32x16_bf16 v[112:127], v[36:39], v[20:23], v[112:127]
  v_mfma_f32_16x16x32_bf16 v[60:63], v[168:171], v[16:19], v[60:63]
  s_waitcnt lgkmcnt(3)
  v_mfma_f32_32x32x16_bf16 v[64:79], v[24:27], v[8:11], v[64:79]
  ds_read_b128 v[16:19], v41 offset:49152
  ds_read_b64_tr_b16 v[32:33], v56 offset:53248
  s_waitcnt lgkmcnt(3)
  v_mfma_f32_32x32x16_bf16 v[80:95], v[28:31], v[8:11], v[80:95]
  ds_read_b64_tr_b16 v[34:35], v56 offset:54272
  ds_read_b64_tr_b16 v[36:37], v57 offset:53248
  s_waitcnt lgkmcnt(4)
  v_mfma_f32_32x32x16_bf16 v[96:111], v[24:27], v[12:15], v[96:111]
  ds_read_b64_tr_b16 v[38:39], v57 offset:54272
  ds_read_b128 v[20:23], v45 offset:49152
  v_mfma_f32_16x16x32_bf16 v[172:175], v[168:171], v[24:27], v[172:175]
  v_mfma_f32_32x32x16_bf16 v[112:127], v[28:31], v[12:15], v[112:127]
  v_mfma_f32_16x16x32_bf16 v[60:63], v[168:171], v[8:11], v[60:63]
  s_waitcnt lgkmcnt(3)
  v_mfma_f32_32x32x16_bf16 v[64:79], v[32:35], v[16:19], v[64:79]
  ds_read_b128 v[8:11], v42 offset:49152
  ds_read_b64_tr_b16 v[24:25], v56 offset:57344
  s_waitcnt lgkmcnt(3)
  v_mfma_f32_32x32x16_bf16 v[80:95], v[36:39], v[16:19], v[80:95]
  ds_read_b64_tr_b16 v[26:27], v56 offset:58368
  ds_read_b64_tr_b16 v[28:29], v57 offset:57344
  s_waitcnt lgkmcnt(4)
  v_mfma_f32_32x32x16_bf16 v[96:111], v[32:35], v[20:23], v[96:111]
  ds_read_b64_tr_b16 v[30:31], v57 offset:58368
  ds_read_b128 v[12:15], v46 offset:49152
  v_mfma_f32_16x16x32_bf16 v[172:175], v[168:171], v[32:35], v[172:175]
  v_mfma_f32_32x32x16_bf16 v[112:127], v[36:39], v[20:23], v[112:127]
  s_add_u32 s50, s3, 1572864
  buffer_load_dwordx4 v[216:219], v214, s[4:7], s50 offen offset:0
  v_mfma_f32_16x16x32_bf16 v[60:63], v[168:171], v[16:19], v[60:63]
  s_waitcnt lgkmcnt(3)
  v_mfma_f32_32x32x16_bf16 v[64:79], v[24:27], v[8:11], v[64:79]
  ds_read_b128 v[16:19], v43 offset:49152
  ds_read_b64_tr_b16 v[32:33], v56 offset:61440
  s_waitcnt lgkmcnt(3)
  v_mfma_f32_32x32x16_bf16 v[80:95], v[28:31], v[8:11], v[80:95]
  ds_read_b64_tr_b16 v[34:35], v56 offset:62464
  ds_read_b64_tr_b16 v[36:37], v57 offset:61440
  s_waitcnt lgkmcnt(4)
  v_mfma_f32_32x32x16_bf16 v[96:111], v[24:27], v[12:15], v[96:111]
  ds_read_b64_tr_b16 v[38:39], v57 offset:62464
  ds_read_b128 v[20:23], v47 offset:49152
  v_mfma_f32_16x16x32_bf16 v[172:175], v[168:171], v[24:27], v[172:175]
  v_mfma_f32_32x32x16_bf16 v[112:127], v[28:31], v[12:15], v[112:127]
  v_mfma_f32_16x16x32_bf16 v[60:63], v[168:171], v[8:11], v[60:63]
  s_waitcnt lgkmcnt(0)
  s_barrier
  v_mfma_f32_32x32x16_bf16 v[64:79], v[32:35], v[16:19], v[64:79]
  ds_read_b128 v[8:11], v40 offset:0
  ds_read_b64_tr_b16 v[24:25], v56 offset:0
  v_mfma_f32_32x32x16_bf16 v[80:95], v[36:39], v[16:19], v[80:95]
  ds_read_b64_tr_b16 v[26:27], v56 offset:1024
  ds_read_b64_tr_b16 v[28:29], v57 offset:0
  v_mfma_f32_32x32x16_bf16 v[96:111], v[32:35], v[20:23], v[96:111]
  ds_read_b64_tr_b16 v[30:31], v57 offset:1024
  ds_read_b128 v[12:15], v44 offset:0
  v_mfma_f32_16x16x32_bf16 v[172:175], v[168:171], v[32:35], v[172:175]
  v_mfma_f32_32x32x16_bf16 v[112:127], v[36:39], v[20:23], v[112:127]
  s_add_u32 s50, s3, 1572864
  buffer_load_dwordx4 v[216:219], v214, s[4:7], s50 offen offset:256
  v_mfma_f32_16x16x32_bf16 v[60:63], v[168:171], v[16:19], v[60:63]
  s_waitcnt lgkmcnt(3)
  v_mfma_f32_32x32x16_bf16 v[64:79], v[24:27], v[8:11], v[64:79]
  ds_read_b128 v[16:19], v41 offset:0
  ds_read_b64_tr_b16 v[32:33], v56 offset:4096
  s_waitcnt lgkmcnt(3)
  v_mfma_f32_32x32x16_bf16 v[80:95], v[28:31], v[8:11], v[80:95]
  ds_read_b64_tr_b16 v[34:35], v56 offset:5120
  ds_read_b64_tr_b16 v[36:37], v57 offset:4096
  s_waitcnt lgkmcnt(4)
  v_mfma_f32_32x32x16_bf16 v[96:111], v[24:27], v[12:15], v[96:111]
  ds_read_b64_tr_b16 v[38:39], v57 offset:5120
  ds_read_b128 v[20:23], v45 offset:0
  v_mfma_f32_16x16x32_bf16 v[172:175], v[168:171], v[24:27], v[172:175]
  v_mfma_f32_32x32x16_bf16 v[112:127], v[28:31], v[12:15], v[112:127]
  v_mfma_f32_16x16x32_bf16 v[60:63], v[168:171], v[8:11], v[60:63]
  s_waitcnt lgkmcnt(3)
  v_mfma_f32_32x32x16_bf16 v[64:79], v[32:35], v[16:19], v[64:79]
  ds_read_b128 v[8:11], v42 offset:0
  ds_read_b64_tr_b16 v[24:25], v56 offset:8192
  s_waitcnt lgkmcnt(3)
  v_mfma_f32_32x32x16_bf16 v[80:95], v[36:39], v[16:19], v[80:95]
  ds_read_b64_tr_b16 v[26:27], v56 offset:9216
  ds_read_b64_tr_b16 v[28:29], v57 offset:8192
  s_waitcnt lgkmcnt(4)
  v_mfma_f32_32x32x16_bf16 v[96:111], v[32:35], v[20:23], v[96:111]
  ds_read_b64_tr_b16 v[30:31], v57 offset:9216
  ds_read_b128 v[12:15], v46 offset:0
  v_mfma_f32_16x16x32_bf16 v[172:175], v[168:171], v[32:35], v[172:175]
  v_mfma_f32_32x32x16_bf16 v[112:127], v[36:39], v[20:23], v[112:127]
  s_add_u32 s50, s3, 1572864
  buffer_load_dwordx4 v[216:219], v214, s[4:7], s50 offen offset:512
  v_mfma_f32_16x16x32_bf16 v[60:63], v[168:171], v[16:19], v[60:63]
  s_waitcnt lgkmcnt(3)
  v_mfma_f32_32x32x16_bf16 v[64:79], v[24:27], v[8:11], v[64:79]
  ds_read_b128 v[16:19], v43 offset:0
  ds_read_b64_tr_b16 v[32:33], v56 offset:12288
  s_waitcnt lgkmcnt(3)
  v_mfma_f32_32x32x16_bf16 v[80:95], v[28:31], v[8:11], v[80:95]
  ds_read_b64_tr_b16 v[34:35], v56 offset:13312
  ds_read_b64_tr_b16 v[36:37], v57 offset:12288
  s_waitcnt lgkmcnt(4)
  v_mfma_f32_32x32x16_bf16 v[96:111], v[24:27], v[12:15], v[96:111]
  ds_read_b64_tr_b16 v[38:39], v57 offset:13312
  ds_read_b128 v[20:23], v47 offset:0
  v_mfma_f32_16x16x32_bf16 v[172:175], v[168:171], v[24:27], v[172:175]
  v_mfma_f32_32x32x16_bf16 v[112:127], v[28:31], v[12:15], v[112:127]
  v_mfma_f32_16x16x32_bf16 v[60:63], v[168:171], v[8:11], v[60:63]
  s_waitcnt lgkmcnt(0)
  s_barrier
  v_mfma_f32_32x32x16_bf16 v[64:79], v[32:35], v[16:19], v[64:79]
  ds_read_b128 v[8:11], v40 offset:16384
  ds_read_b64_tr_b16 v[24:25], v56 offset:16384
  v_mfma_f32_32x32x16_bf16 v[80:95], v[36:39], v[16:19], v[80:95]
  ds_read_b64_tr_b16 v[26:27], v56 offset:17408
  ds_read_b64_tr_b16 v[28:29], v57 offset:16384
  v_mfma_f32_32x32x16_bf16 v[96:111], v[32:35], v[20:23], v[96:111]
  ds_read_b64_tr_b16 v[30:31], v57 offset:17408
  ds_read_b128 v[12:15], v44 offset:16384
  v_mfma_f32_16x16x32_bf16 v[172:175], v[168:171], v[32:35], v[172:175]
  v_mfma_f32_32x32x16_bf16 v[112:127], v[36:39], v[20:23], v[112:127]
  s_add_u32 s50, s3, 786432
  buffer_load_dwordx4 v[216:219], v214, s[4:7], s50 offen offset:0
  v_mfma_f32_16x16x32_bf16 v[60:63], v[168:171], v[16:19], v[60:63]
  s_waitcnt lgkmcnt(3)
  v_mfma_f32_32x32x16_bf16 v[64:79], v[24:27], v[8:11], v[64:79]
  ds_read_b128 v[16:19], v41 offset:16384
  ds_read_b64_tr_b16 v[32:33], v56 offset:20480
  s_waitcnt lgkmcnt(3)
  v_mfma_f32_32x32x16_bf16 v[80:95], v[28:31], v[8:11], v[80:95]
  ds_read_b64_tr_b16 v[34:35], v56 offset:21504
  ds_read_b64_tr_b16 v[36:37], v57 offset:20480
  s_waitcnt lgkmcnt(4)
  v_mfma_f32_32x32x16_bf16 v[96:111], v[24:27], v[12:15], v[96:111]
  ds_read_b64_tr_b16 v[38:39], v57 offset:21504
  ds_read_b128 v[20:23], v45 offset:16384
  v_mfma_f32_16x16x32_bf16 v[172:175], v[168:171], v[24:27], v[172:175]
  v_mfma_f32_32x32x16_bf16 v[112:127], v[28:31], v[12:15], v[112:127]
  v_mfma_f32_16x16x32_bf16 v[60:63], v[168:171], v[8:11], v[60:63]
  s_waitcnt lgkmcnt(3)
  v_mfma_f32_32x32x16_bf16 v[64:79], v[32:35], v[16:19], v[64:79]
  ds_read_b128 v[8:11], v42 offset:16384
  ds_read_b64_tr_b16 v[24:25], v56 offset:24576
  s_waitcnt lgkmcnt(3)
  v_mfma_f32_32x32x16_bf16 v[80:95], v[36:39], v[16:19], v[80:95]
  ds_read_b64_tr_b16 v[26:27], v56 offset:25600
  ds_read_b64_tr_b16 v[28:29], v57 offset:24576
  s_waitcnt lgkmcnt(4)
  v_mfma_f32_32x32x16_bf16 v[96:111], v[32:35], v[20:23], v[96:111]
  ds_read_b64_tr_b16 v[30:31], v57 offset:25600
  ds_read_b128 v[12:15], v46 offset:16384
  v_mfma_f32_16x16x32_bf16 v[172:175], v[168:171], v[32:35], v[172:175]
  v_mfma_f32_32x32x16_bf16 v[112:127], v[36:39], v[20:23], v[112:127]
  s_add_u32 s50, s3, 786432
  buffer_load_dwordx4 v[216:219], v214, s[4:7], s50 offen offset:256
  v_mfma_f32_16x16x32_bf16 v[60:63], v[168:171], v[16:19], v[60:63]
  s_waitcnt lgkmcnt(3)
  v_mfma_f32_32x32x16_bf16 v[64:79], v[24:27], v[8:11], v[64:79]
  ds_read_b128 v[16:19], v43 offset:16384
  ds_read_b64_tr_b16 v[32:33], v56 offset:28672
  s_waitcnt lgkmcnt(3)
  v_mfma_f32_32x32x16_bf16 v[80:95], v[28:31], v[8:11], v[80:95]
  ds_read_b64_tr_b16 v[34:35], v56 offset:29696
  ds_read_b64_tr_b16 v[36:37], v57 offset:28672
  s_waitcnt lgkmcnt(4)
  v_mfma_f32_32x32x16_bf16 v[96:111], v[24:27], v[12:15], v[96:111]
  ds_read_b64_tr_b16 v[38:39], v57 offset:29696
  ds_read_b128 v[20:23], v47 offset:16384
  v_mfma_f32_16x16x32_bf16 v[172:175], v[168:171], v[24:27], v[172:175]
  v_mfma_f32_32x32x16_bf16 v[112:127], v[28:31], v[12:15], v[112:127]
  v_mfma_f32_16x16x32_bf16 v[60:63], v[168:171], v[8:11], v[60:63]
  s_waitcnt lgkmcnt(0)
  s_barrier
  v_mfma_f32_32x32x16_bf16 v[64:79], v[32:35], v[16:19], v[64:79]
  ds_read_b128 v[8:11], v40 offset:32768
  ds_read_b64_tr_b16 v[24:25], v56 offset:32768
  v_mfma_f32_32x32x16_bf16 v[80:95], v[36:39], v[16:19], v[80:95]
  ds_read_b64_tr_b16 v[26:27], v56 offset:33792
  ds_read_b64_tr_b16 v[28:29], v57 offset:32768
  v_mfma_f32_32x32x16_bf16 v[96:111], v[32:35], v[20:23], v[96:111]
  ds_read_b64_tr_b16 v[30:31], v57 offset:33792
  ds_read_b128 v[12:15], v44 offset:32768
  v_mfma_f32_16x16x32_bf16 v[172:175], v[168:171], v[32:35], v[172:175]
  v_mfma_f32_32x32x16_bf16 v[112:127], v[36:39], v[20:23], v[112:127]
  s_add_u32 s50, s3, 786432
  buffer_load_dwordx4 v[216:219], v214, s[4:7], s50 offen offset:512
  v_mfma_f32_16x16x32_bf16 v[60:63], v[168:171], v[16:19], v[60:63]
  s_waitcnt lgkmcnt(3)
  v_mfma_f32_32x32x16_bf16 v[64:79], v[24:27], v[8:11], v[64:79]
  ds_read_b128 v[16:19], v41 offset:32768
  ds_read_b64_tr_b16 v[32:33], v56 offset:36864
  s_waitcnt lgkmcnt(3)
  v_mfma_f32_32x32x16_bf16 v[80:95], v[28:31], v[8:11], v[80:95]
  ds_read_b64_tr_b16 v[34:35], v56 offset:37888
  ds_read_b64_tr_b16 v[36:37], v57 offset:36864
  s_waitcnt lgkmcnt(4)
  v_mfma_f32_32x32x16_bf16 v[96:111], v[24:27], v[12:15], v[96:111]
  ds_read_b64_tr_b16 v[38:39], v57 offset:37888
  ds_read_b128 v[20:23], v45 offset:32768
  v_mfma_f32_16x16x32_bf16 v[172:175], v[168:171], v[24:27], v[172:175]
  v_mfma_f32_32x32x16_bf16 v[112:127], v[28:31], v[12:15], v[112:127]
  v_mfma_f32_16x16x32_bf16 v[60:63], v[168:171], v[8:11], v[60:63]
  s_waitcnt lgkmcnt(3)
  v_mfma_f32_32x32x16_bf16 v[64:79], v[32:35], v[16:19], v[64:79]
  ds_read_b128 v[8:11], v42 offset:32768
  ds_read_b64_tr_b16 v[24:25], v56 offset:40960
  s_waitcnt lgkmcnt(3)
  v_mfma_f32_32x32x16_bf16 v[80:95], v[36:39], v[16:19], v[80:95]
  ds_read_b64_tr_b16 v[26:27], v56 offset:41984
  ds_read_b64_tr_b16 v[28:29], v57 offset:40960
  s_waitcnt lgkmcnt(4)
  v_mfma_f32_32x32x16_bf16 v[96:111], v[32:35], v[20:23], v[96:111]
  ds_read_b64_tr_b16 v[30:31], v57 offset:41984
  ds_read_b128 v[12:15], v46 offset:32768
  v_mfma_f32_16x16x32_bf16 v[172:175], v[168:171], v[32:35], v[172:175]
  v_mfma_f32_32x32x16_bf16 v[112:127], v[36:39], v[20:23], v[112:127]
  s_add_u32 s50, s3, 0
  buffer_load_dwordx4 v[216:219], v214, s[4:7], s50 offen offset:0
  v_mfma_f32_16x16x32_bf16 v[60:63], v[168:171], v[16:19], v[60:63]
  s_waitcnt lgkmcnt(3)
  v_mfma_f32_32x32x16_bf16 v[64:79], v[24:27], v[8:11], v[64:79]
  ds_read_b128 v[16:19], v43 offset:32768
  ds_read_b64_tr_b16 v[32:33], v56 offset:45056
  s_waitcnt lgkmcnt(3)
  v_mfma_f32_32x32x16_bf16 v[80:95], v[28:31], v[8:11], v[80:95]
  ds_read_b64_tr_b16 v[34:35], v56 offset:46080
  ds_read_b64_tr_b16 v[36:37], v57 offset:45056
  s_waitcnt lgkmcnt(4)
  v_mfma_f32_32x32x16_bf16 v[96:111], v[24:27], v[12:15], v[96:111]
  ds_read_b64_tr_b16 v[38:39], v57 offset:46080
  ds_read_b128 v[20:23], v47 offset:32768
  v_mfma_f32_16x16x32_bf16 v[172:175], v[168:171], v[24:27], v[172:175]
  v_mfma_f32_32x32x16_bf16 v[112:127], v[28:31], v[12:15], v[112:127]
  v_mfma_f32_16x16x32_bf16 v[60:63], v[168:171], v[8:11], v[60:63]
  s_waitcnt lgkmcnt(0)
  s_barrier
  v_mfma_f32_32x32x16_bf16 v[64:79], v[32:35], v[16:19], v[64:79]
  ds_read_b128 v[8:11], v40 offset:49152
  ds_read_b64_tr_b16 v[24:25], v56 offset:49152
  v_mfma_f32_32x32x16_bf16 v[80:95], v[36:39], v[16:19], v[80:95]
  ds_read_b64_tr_b16 v[26:27], v56 offset:50176
  ds_read_b64_tr_b16 v[28:29], v57 offset:49152
  v_mfma_f32_32x32x16_bf16 v[96:111], v[32:35], v[20:23], v[96:111]
  ds_read_b64_tr_b16 v[30:31], v57 offset:50176
  ds_read_b128 v[12:15], v44 offset:49152
  v_mfma_f32_16x16x32_bf16 v[172:175], v[168:171], v[32:35], v[172:175]
  v_mfma_f32_32x32x16_bf16 v[112:127], v[36:39], v[20:23], v[112:127]
  s_add_u32 s50, s3, 0
  buffer_load_dwordx4 v[216:219], v214, s[4:7], s50 offen offset:256
  v_mfma_f32_16x16x32_bf16 v[60:63], v[168:171], v[16:19], v[60:63]
  s_waitcnt lgkmcnt(3)
  v_mfma_f32_32x32x16_bf16 v[64:79], v[24:27], v[8:11], v[64:79]
  ds_read_b128 v[16:19], v41 offset:49152
  ds_read_b64_tr_b16 v[32:33], v56 offset:53248
  s_waitcnt lgkmcnt(3)
  v_mfma_f32_32x32x16_bf16 v[80:95], v[28:31], v[8:11], v[80:95]
  ds_read_b64_tr_b16 v[34:35], v56 offset:54272
  ds_read_b64_tr_b16 v[36:37], v57 offset:53248
  s_waitcnt lgkmcnt(4)
  v_mfma_f32_32x32x16_bf16 v[96:111], v[24:27], v[12:15], v[96:111]
  ds_read_b64_tr_b16 v[38:39], v57 offset:54272
  ds_read_b128 v[20:23], v45 offset:49152
  v_mfma_f32_16x16x32_bf16 v[172:175], v[168:171], v[24:27], v[172:175]
  v_mfma_f32_32x32x16_bf16 v[112:127], v[28:31], v[12:15], v[112:127]
  v_mfma_f32_16x16x32_bf16 v[60:63], v[168:171], v[8:11], v[60:63]
  s_waitcnt lgkmcnt(3)
  v_mfma_f32_32x32x16_bf16 v[64:79], v[32:35], v[16:19], v[64:79]
  ds_read_b128 v[8:11], v42 offset:49152
  ds_read_b64_tr_b16 v[24:25], v56 offset:57344
  s_waitcnt lgkmcnt(3)
  v_mfma_f32_32x32x16_bf16 v[80:95], v[36:39], v[16:19], v[80:95]
  ds_read_b64_tr_b16 v[26:27], v56 offset:58368
  ds_read_b64_tr_b16 v[28:29], v57 offset:57344
  s_waitcnt lgkmcnt(4)
  v_mfma_f32_32x32x16_bf16 v[96:111], v[32:35], v[20:23], v[96:111]
  ds_read_b64_tr_b16 v[30:31], v57 offset:58368
  ds_read_b128 v[12:15], v46 offset:49152
  v_mfma_f32_16x16x32_bf16 v[172:175], v[168:171], v[32:35], v[172:175]
  v_mfma_f32_32x32x16_bf16 v[112:127], v[36:39], v[20:23], v[112:127]
  s_add_u32 s50, s3, 0
  buffer_load_dwordx4 v[216:219], v214, s[4:7], s50 offen offset:512
  v_mfma_f32_16x16x32_bf16 v[60:63], v[168:171], v[16:19], v[60:63]
  s_waitcnt lgkmcnt(3)
  v_mfma_f32_32x32x16_bf16 v[64:79], v[24:27], v[8:11], v[64:79]
  ds_read_b128 v[16:19], v43 offset:49152
  ds_read_b64_tr_b16 v[32:33], v56 offset:61440
  s_waitcnt lgkmcnt(3)
  v_mfma_f32_32x32x16_bf16 v[80:95], v[28:31], v[8:11], v[80:95]
  ds_read_b64_tr_b16 v[34:35], v56 offset:62464
  ds_read_b64_tr_b16 v[36:37], v57 offset:61440
  s_waitcnt lgkmcnt(4)
  v_mfma_f32_32x32x16_bf16 v[96:111], v[24:27], v[12:15], v[96:111]
  ds_read_b64_tr_b16 v[38:39], v57 offset:62464
  ds_read_b128 v[20:23], v47 offset:49152
  v_mfma_f32_16x16x32_bf16 v[172:175], v[168:171], v[24:27], v[172:175]
  v_mfma_f32_32x32x16_bf16 v[112:127], v[28:31], v[12:15], v[112:127]
  v_mfma_f32_16x16x32_bf16 v[60:63], v[168:171], v[8:11], v[60:63]
  s_waitcnt lgkmcnt(0)
  s_barrier
  v_mfma_f32_32x32x16_bf16 v[64:79], v[32:35], v[16:19], v[64:79]
  ds_read_b128 v[8:11], v40 offset:0
  ds_read_b64_tr_b16 v[24:25], v56 offset:0
  v_mfma_f32_32x32x16_bf16 v[80:95], v[36:39], v[16:19], v[80:95]
  ds_read_b64_tr_b16 v[26:27], v56 offset:1024
  ds_read_b64_tr_b16 v[28:29], v57 offset:0
  v_mfma_f32_32x32x16_bf16 v[96:111], v[32:35], v[20:23], v[96:111]
  ds_read_b64_tr_b16 v[30:31], v57 offset:1024
  ds_read_b128 v[12:15], v44 offset:0
  v_mfma_f32_16x16x32_bf16 v[172:175], v[168:171], v[32:35], v[172:175]
  v_mfma_f32_32x32x16_bf16 v[112:127], v[36:39], v[20:23], v[112:127]
  v_mfma_f32_16x16x32_bf16 v[60:63], v[168:171], v[16:19], v[60:63]
  s_waitcnt lgkmcnt(3)
  v_mfma_f32_32x32x16_bf16 v[64:79], v[24:27], v[8:11], v[64:79]
  ds_read_b128 v[16:19], v41 offset:0
  ds_read_b64_tr_b16 v[32:33], v56 offset:4096
  s_waitcnt lgkmcnt(3)
  v_mfma_f32_32x32x16_bf16 v[80:95], v[28:31], v[8:11], v[80:95]
  ds_read_b64_tr_b16 v[34:35], v56 offset:5120
  ds_read_b64_tr_b16 v[36:37], v57 offset:4096
  s_waitcnt lgkmcnt(4)
  v_mfma_f32_32x32x16_bf16 v[96:111], v[24:27], v[12:15], v[96:111]
  ds_read_b64_tr_b16 v[38:39], v57 offset:5120
  ds_read_b128 v[20:23], v45 offset:0
  v_mfma_f32_16x16x32_bf16 v[172:175], v[168:171], v[24:27], v[172:175]
  v_mfma_f32_32x32x16_bf16 v[112:127], v[28:31], v[12:15], v[112:127]
  v_mfma_f32_16x16x32_bf16 v[60:63], v[168:171], v[8:11], v[60:63]
  s_waitcnt lgkmcnt(3)
  v_mfma_f32_32x32x16_bf16 v[64:79], v[32:35], v[16:19], v[64:79]
  ds_read_b128 v[8:11], v42 offset:0
  ds_read_b64_tr_b16 v[24:25], v56 offset:8192
  s_waitcnt lgkmcnt(3)
  v_mfma_f32_32x32x16_bf16 v[80:95], v[36:39], v[16:19], v[80:95]
  ds_read_b64_tr_b16 v[26:27], v56 offset:9216
  ds_read_b64_tr_b16 v[28:29], v57 offset:8192
  s_waitcnt lgkmcnt(4)
  v_mfma_f32_32x32x16_bf16 v[96:111], v[32:35], v[20:23], v[96:111]
  ds_read_b64_tr_b16 v[30:31], v57 offset:9216
  ds_read_b128 v[12:15], v46 offset:0
  v_mfma_f32_16x16x32_bf16 v[172:175], v[168:171], v[32:35], v[172:175]
  v_mfma_f32_32x32x16_bf16 v[112:127], v[36:39], v[20:23], v[112:127]
  v_mov_b32 v215, 0
  global_load_dword v215, v215, s[36:37] sc1
  v_mfma_f32_16x16x32_bf16 v[60:63], v[168:171], v[16:19], v[60:63]
  s_waitcnt lgkmcnt(3)
  v_mfma_f32_32x32x16_bf16 v[64:79], v[24:27], v[8:11], v[64:79]
  ds_read_b128 v[16:19], v43 offset:0
  ds_read_b64_tr_b16 v[32:33], v56 offset:12288
  s_waitcnt lgkmcnt(3)
  v_mfma_f32_32x32x16_bf16 v[80:95], v[28:31], v[8:11], v[80:95]
  ds_read_b64_tr_b16 v[34:35], v56 offset:13312
  ds_read_b64_tr_b16 v[36:37], v57 offset:12288
  s_waitcnt lgkmcnt(4)
  v_mfma_f32_32x32x16_bf16 v[96:111], v[24:27], v[12:15], v[96:111]
  ds_read_b64_tr_b16 v[38:39], v57 offset:13312
  ds_read_b128 v[20:23], v47 offset:0
  v_mfma_f32_16x16x32_bf16 v[172:175], v[168:171], v[24:27], v[172:175]
  v_mfma_f32_32x32x16_bf16 v[112:127], v[28:31], v[12:15], v[112:127]
  v_mfma_f32_16x16x32_bf16 v[60:63], v[168:171], v[8:11], v[60:63]
  s_waitcnt lgkmcnt(0)
  s_barrier
  v_mfma_f32_32x32x16_bf16 v[64:79], v[32:35], v[16:19], v[64:79]
  ds_read_b128 v[8:11], v40 offset:16384
  ds_read_b64_tr_b16 v[24:25], v56 offset:16384
  v_mfma_f32_32x32x16_bf16 v[80:95], v[36:39], v[16:19], v[80:95]
  ds_read_b64_tr_b16 v[26:27], v56 offset:17408
  ds_read_b64_tr_b16 v[28:29], v57 offset:16384
  v_mfma_f32_32x32x16_bf16 v[96:111], v[32:35], v[20:23], v[96:111]
  ds_read_b64_tr_b16 v[30:31], v57 offset:17408
  ds_read_b128 v[12:15], v44 offset:16384
  v_mfma_f32_16x16x32_bf16 v[172:175], v[168:171], v[32:35], v[172:175]
  v_mfma_f32_32x32x16_bf16 v[112:127], v[36:39], v[20:23], v[112:127]
  v_mfma_f32_16x16x32_bf16 v[60:63], v[168:171], v[16:19], v[60:63]
  s_waitcnt lgkmcnt(3)
  v_mfma_f32_32x32x16_bf16 v[64:79], v[24:27], v[8:11], v[64:79]
  ds_read_b128 v[16:19], v41 offset:16384
  ds_read_b64_tr_b16 v[32:33], v56 offset:20480
  s_waitcnt lgkmcnt(3)
  v_mfma_f32_32x32x16_bf16 v[80:95], v[28:31], v[8:11], v[80:95]
  ds_read_b64_tr_b16 v[34:35], v56 offset:21504
  ds_read_b64_tr_b16 v[36:37], v57 offset:20480
  s_waitcnt lgkmcnt(4)
  v_mfma_f32_32x32x16_bf16 v[96:111], v[24:27], v[12:15], v[96:111]
  ds_read_b64_tr_b16 v[38:39], v57 offset:21504
  ds_read_b128 v[20:23], v45 offset:16384
  v_mfma_f32_16x16x32_bf16 v[172:175], v[168:171], v[24:27], v[172:175]
  v_mfma_f32_32x32x16_bf16 v[112:127], v[28:31], v[12:15], v[112:127]
  v_mfma_f32_16x16x32_bf16 v[60:63], v[168:171], v[8:11], v[60:63]
  s_waitcnt lgkmcnt(3)
  v_mfma_f32_32x32x16_bf16 v[64:79], v[32:35], v[16:19], v[64:79]
  ds_read_b128 v[8:11], v42 offset:16384
  ds_read_b64_tr_b16 v[24:25], v56 offset:24576
  s_waitcnt lgkmcnt(3)
  v_mfma_f32_32x32x16_bf16 v[80:95], v[36:39], v[16:19], v[80:95]
  ds_read_b64_tr_b16 v[26:27], v56 offset:25600
  ds_read_b64_tr_b16 v[28:29], v57 offset:24576
  s_waitcnt lgkmcnt(4)
  v_mfma_f32_32x32x16_bf16 v[96:111], v[32:35], v[20:23], v[96:111]
  ds_read_b64_tr_b16 v[30:31], v57 offset:25600
  ds_read_b128 v[12:15], v46 offset:16384
  v_mfma_f32_16x16x32_bf16 v[172:175], v[168:171], v[32:35], v[172:175]
  v_mfma_f32_32x32x16_bf16 v[112:127], v[36:39], v[20:23], v[112:127]
  v_mfma_f32_16x16x32_bf16 v[60:63], v[168:171], v[16:19], v[60:63]
  s_waitcnt lgkmcnt(3)
  v_mfma_f32_32x32x16_bf16 v[64:79], v[24:27], v[8:11], v[64:79]
  ds_read_b128 v[16:19], v43 offset:16384
  ds_read_b64_tr_b16 v[32:33], v56 offset:28672
  s_waitcnt lgkmcnt(3)
  v_mfma_f32_32x32x16_bf16 v[80:95], v[28:31], v[8:11], v[80:95]
  ds_read_b64_tr_b16 v[34:35], v56 offset:29696
  ds_read_b64_tr_b16 v[36:37], v57 offset:28672
  s_waitcnt lgkmcnt(4)
  v_mfma_f32_32x32x16_bf16 v[96:111], v[24:27], v[12:15], v[96:111]
  ds_read_b64_tr_b16 v[38:39], v57 offset:29696
  ds_read_b128 v[20:23], v47 offset:16384
  v_mfma_f32_16x16x32_bf16 v[172:175], v[168:171], v[24:27], v[172:175]
  v_mfma_f32_32x32x16_bf16 v[112:127], v[28:31], v[12:15], v[112:127]
  v_mfma_f32_16x16x32_bf16 v[60:63], v[168:171], v[8:11], v[60:63]
  s_waitcnt lgkmcnt(3)
  v_mfma_f32_32x32x16_bf16 v[64:79], v[32:35], v[16:19], v[64:79]
  s_waitcnt lgkmcnt(1)
  v_mfma_f32_32x32x16_bf16 v[80:95], v[36:39], v[16:19], v[80:95]
  s_waitcnt lgkmcnt(0)
  v_mfma_f32_32x32x16_bf16 v[96:111], v[32:35], v[20:23], v[96:111]
  v_mfma_f32_16x16x32_bf16 v[172:175], v[168:171], v[32:35], v[172:175]
  v_mfma_f32_32x32x16_bf16 v[112:127], v[36:39], v[20:23], v[112:127]
  v_mfma_f32_16x16x32_bf16 v[60:63], v[168:171], v[16:19], v[60:63]
  s_lshl_b32 s50, s69, 1
  s_add_u32 s50, s50, s68
  s_lshl_b32 s50, s50, 7
  s_add_u32 s50, s50, 70656
  v_lshl_add_u32 v176, v3, 2, s50
  s_lshl_b32 s50, s68, 1
  s_add_u32 s50, s50, s69
  s_lshl_b32 s50, s50, 7
  s_add_u32 s50, s50, 65536
  v_lshl_add_u32 v177, v3, 2, s50
  s_nop 1
  s_mov_b64 exec, 0xffff
  ds_write_b32 v176, v172
  ds_write_b32 v176, v173 offset:64
  ds_write_b32 v177, v60 offset:5632
  ds_write_b32 v177, v61 offset:5696
  s_mov_b64 exec, -1
  s_waitcnt lgkmcnt(0)
  s_barrier
  s_waitcnt vmcnt(0)
  s_mov_b32 s51, 0
L_non_2:
  v_readfirstlane_b32 s58, v215
  s_add_u32 s51, s51, 1
  s_cmp_lg_u32 s58, 0
  s_cbranch_scc1 L_non_2_ok
  s_cmp_ge_u32 s51, 0x20000
  s_cbranch_scc1 L_non_2_ok
  s_sleep 8
  v_mov_b32 v215, 0
  global_load_dword v215, v215, s[36:37] sc1
  s_waitcnt vmcnt(0)
  s_branch L_non_2
L_non_2_ok:
  s_cmp_eq_u32 s43, 15
  s_cbranch_scc1 L_A_dummy
  s_cmp_lt_u32 s40, 5
  s_cselect_b32 s61, 0x3ea52b5c, 1.0
  s_cselect_b32 s62, 0, 5
  s_mov_b32 s56, 5242880
  s_cselect_b32 s56, 0, s56
  s_sub_u32 s62, s40, s62
  s_lshl_b32 s62, s62, 7
  s_xor_b32 s60, s69, 0
  s_lshl_b32 s57, s68, 1
  s_add_u32 s60, s60, s57
  s_lshl_b32 s60, s60, 5
  v_add_u32 v11, s60, v3
  v_lshlrev_b32 v22, 2, v11
  v_add_u32 v22, 65536, v22
  v_lshlrev_b32 v8, 4, v11
  v_lshlrev_b32 v20, 3, v11
  s_xor_b32 s60, s69, 1
  s_lshl_b32 s57, s68, 1
  s_add_u32 s60, s60, s57
  s_lshl_b32 s60, s60, 5
  v_add_u32 v11, s60, v3
  v_lshlrev_b32 v23, 2, v11
  v_add_u32 v23, 65536, v23
  v_lshlrev_b32 v9, 4, v11
  v_lshlrev_b32 v21, 3, v11
  s_xor_b32 s60, s68, 0
  s_lshl_b32 s57, s69, 1
  s_add_u32 s60, s60, s57
  s_lshl_b32 s60, s60, 5
  v_lshl_add_u32 v10, v4, 2, s60
  v_lshlrev_b32 v10, 2, v10
  v_add_u32 v10, 65536, v10
  ds_read_b128 v[136:139], v10 offset:5120
  ds_read_b128 v[140:143], v10 offset:5152
  ds_read_b128 v[144:147], v10 offset:5184
  ds_read_b128 v[148:151], v10 offset:5216
  s_add_u32 s60, s60, s62
  v_lshl_add_u32 v12, v4, 3, s60
  s_xor_b32 s60, s68, 1
  s_lshl_b32 s57, s69, 1
  s_add_u32 s60, s60, s57
  s_lshl_b32 s60, s60, 5
  v_lshl_add_u32 v10, v4, 2, s60
  v_lshlrev_b32 v10, 2, v10
  v_add_u32 v10, 65536, v10
  ds_read_b128 v[152:155], v10 offset:5120
  ds_read_b128 v[156:159], v10 offset:5152
  ds_read_b128 v[160:163], v10 offset:5184
  ds_read_b128 v[164:167], v10 offset:5216
  s_add_u32 s60, s60, s62
  v_lshl_add_u32 v13, v4, 3, s60
  s_mul_i32 s60, s39, 10240
  s_add_u32 s60, s60, s56
  s_add_u32 s62, s60, 163840
  s_mov_b32 s70, 163840
  s_barrier
  ds_read_b32 v128, v22 offset:2048
  ds_read_b32 v130, v22 offset:2560
  ds_read_b32 v129, v23 offset:2048
  ds_read_b32 v131, v23 offset:2560
  s_waitcnt lgkmcnt(0)
  v_mul_f32 v130, s61, v130
  v_mul_f32 v131, s61, v131
  v_add_u32 v14, 0, v12
  v_mul_u32_u24 v15, 1639, v14
  v_lshrrev_b32 v15, 16, v15
  v_mul_u32_u24 v16, 40, v15
  v_sub_u32 v16, v14, v16
  v_lshrrev_b32 v16, 3, v16
  v_cmp_lt_u32 vcc, 2, v16
  v_cmp_eq_u32 s[48:49], 2, v16
  v_lshlrev_b32 v15, 1, v15
  v_cndmask_b32 v14, 0, 1, vcc
  v_add_u32 v15, v15, v14
  v_mul_u32_u24 v14, 3, v14
  v_sub_u32 v16, v16, v14
  v_mul_lo_u32 v15, v15, s70
  v_lshl_add_u32 v15, v16, 11, v15
  v_fmac_f32 v64, v136, v128
  v_fmac_f32 v65, v137, v128
  v_fmac_f32 v66, v138, v128
  v_fmac_f32 v67, v139, v128
  v_fmac_f32 v68, v140, v128
  v_fmac_f32 v69, v141, v128
  v_fmac_f32 v70, v142, v128
  v_fmac_f32 v71, v143, v128
  v_mul_f32 v64, v64, v130
  v_mul_f32 v65, v65, v130
  v_mul_f32 v66, v66, v130
  v_mul_f32 v67, v67, v130
  v_mul_f32 v68, v68, v130
  v_mul_f32 v69, v69, v130
  v_mul_f32 v70, v70, v130
  v_mul_f32 v71, v71, v130
  v_cvt_pk_bf16_f32 v64, v64, v65
  v_cvt_pk_bf16_f32 v65, v66, v67
  v_cvt_pk_bf16_f32 v66, v68, v69
  v_cvt_pk_bf16_f32 v67, v70, v71
  v_add_u32 v17, v15, v8
  v_add_u32 v18, v15, v20
  v_permlane32_swap_b32 v64, v66
  v_permlane32_swap_b32 v65, v67
  s_andn2_b64 exec, exec, s[48:49]
  buffer_store_dwordx4 v[64:67], v17, s[16:19], s60 offen sc1
  s_mov_b64 exec, s[48:49]
  s_cbranch_execz L_qk_ns_3
  buffer_store_dwordx2 v[64:65], v18, s[16:19], s60 offen sc1
  buffer_store_dwordx2 v[66:67], v18, s[16:19], s62 offen sc1
L_qk_ns_3:
  s_mov_b64 exec, -1
  v_fmac_f32 v96, v136, v129
  v_fmac_f32 v97, v137, v129
  v_fmac_f32 v98, v138, v129
  v_fmac_f32 v99, v139, v129
  v_fmac_f32 v100, v140, v129
  v_fmac_f32 v101, v141, v129
  v_fmac_f32 v102, v142, v129
  v_fmac_f32 v103, v143, v129
  v_mul_f32 v96, v96, v131
  v_mul_f32 v97, v97, v131
  v_mul_f32 v98, v98, v131
  v_mul_f32 v99, v99, v131
  v_mul_f32 v100, v100, v131
  v_mul_f32 v101, v101, v131
  v_mul_f32 v102, v102, v131
  v_mul_f32 v103, v103, v131
  v_cvt_pk_bf16_f32 v96, v96, v97
  v_cvt_pk_bf16_f32 v97, v98, v99
  v_cvt_pk_bf16_f32 v98, v100, v101
  v_cvt_pk_bf16_f32 v99, v102, v103
  v_add_u32 v17, v15, v9
  v_add_u32 v18, v15, v21
  v_permlane32_swap_b32 v96, v98
  v_permlane32_swap_b32 v97, v99
  s_andn2_b64 exec, exec, s[48:49]
  buffer_store_dwordx4 v[96:99], v17, s[16:19], s60 offen sc1
  s_mov_b64 exec, s[48:49]
  s_cbranch_execz L_qk_ns_4
  buffer_store_dwordx2 v[96:97], v18, s[16:19], s60 offen sc1
  buffer_store_dwordx2 v[98:99], v18, s[16:19], s62 offen sc1
L_qk_ns_4:
  s_mov_b64 exec, -1
  v_add_u32 v14, 16, v12
  v_mul_u32_u24 v15, 1639, v14
  v_lshrrev_b32 v15, 16, v15
  v_mul_u32_u24 v16, 40, v15
  v_sub_u32 v16, v14, v16
  v_lshrrev_b32 v16, 3, v16
  v_cmp_lt_u32 vcc, 2, v16
  v_cmp_eq_u32 s[48:49], 2, v16
  v_lshlrev_b32 v15, 1, v15
  v_cndmask_b32 v14, 0, 1, vcc
  v_add_u32 v15, v15, v14
  v_mul_u32_u24 v14, 3, v14
  v_sub_u32 v16, v16, v14
  v_mul_lo_u32 v15, v15, s70
  v_lshl_add_u32 v15, v16, 11, v15
  v_fmac_f32 v72, v144, v128
  v_fmac_f32 v73, v145, v128
  v_fmac_f32 v74, v146, v128
  v_fmac_f32 v75, v147, v128
  v_fmac_f32 v76, v148, v128
  v_fmac_f32 v77, v149, v128
  v_fmac_f32 v78, v150, v128
  v_fmac_f32 v79, v151, v128
  v_mul_f32 v72, v72, v130
  v_mul_f32 v73, v73, v130
  v_mul_f32 v74, v74, v130
  v_mul_f32 v75, v75, v130
  v_mul_f32 v76, v76, v130
  v_mul_f32 v77, v77, v130
  v_mul_f32 v78, v78, v130
  v_mul_f32 v79, v79, v130
  v_cvt_pk_bf16_f32 v72, v72, v73
  v_cvt_pk_bf16_f32 v73, v74, v75
  v_cvt_pk_bf16_f32 v74, v76, v77
  v_cvt_pk_bf16_f32 v75, v78, v79
  v_add_u32 v17, v15, v8
  v_add_u32 v18, v15, v20
  v_permlane32_swap_b32 v72, v74
  v_permlane32_swap_b32 v73, v75
  s_andn2_b64 exec, exec, s[48:49]
  buffer_store_dwordx4 v[72:75], v17, s[16:19], s60 offen sc1
  s_mov_b64 exec, s[48:49]
  s_cbranch_execz L_qk_ns_5
  buffer_store_dwordx2 v[72:73], v18, s[16:19], s60 offen sc1
  buffer_store_dwordx2 v[74:75], v18, s[16:19], s62 offen sc1
L_qk_ns_5:
  s_mov_b64 exec, -1
  v_fmac_f32 v104, v144, v129
  v_fmac_f32 v105, v145, v129
  v_fmac_f32 v106, v146, v129
  v_fmac_f32 v107, v147, v129
  v_fmac_f32 v108, v148, v129
  v_fmac_f32 v109, v149, v129
  v_fmac_f32 v110, v150, v129
  v_fmac_f32 v111, v151, v129
  v_mul_f32 v104, v104, v131
  v_mul_f32 v105, v105, v131
  v_mul_f32 v106, v106, v131
  v_mul_f32 v107, v107, v131
  v_mul_f32 v108, v108, v131
  v_mul_f32 v109, v109, v131
  v_mul_f32 v110, v110, v131
  v_mul_f32 v111, v111, v131
  v_cvt_pk_bf16_f32 v104, v104, v105
  v_cvt_pk_bf16_f32 v105, v106, v107
  v_cvt_pk_bf16_f32 v106, v108, v109
  v_cvt_pk_bf16_f32 v107, v110, v111
  v_add_u32 v17, v15, v9
  v_add_u32 v18, v15, v21
  v_permlane32_swap_b32 v104, v106
  v_permlane32_swap_b32 v105, v107
  s_andn2_b64 exec, exec, s[48:49]
  buffer_store_dwordx4 v[104:107], v17, s[16:19], s60 offen sc1
  s_mov_b64 exec, s[48:49]
  s_cbranch_execz L_qk_ns_6
  buffer_store_dwordx2 v[104:105], v18, s[16:19], s60 offen sc1
  buffer_store_dwordx2 v[106:107], v18, s[16:19], s62 offen sc1
L_qk_ns_6:
  s_mov_b64 exec, -1
  v_add_u32 v14, 0, v13
  v_mul_u32_u24 v15, 1639, v14
  v_lshrrev_b32 v15, 16, v15
  v_mul_u32_u24 v16, 40, v15
  v_sub_u32 v16, v14, v16
  v_lshrrev_b32 v16, 3, v16
  v_cmp_lt_u32 vcc, 2, v16
  v_cmp_eq_u32 s[48:49], 2, v16
  v_lshlrev_b32 v15, 1, v15
  v_cndmask_b32 v14, 0, 1, vcc
  v_add_u32 v15, v15, v14
  v_mul_u32_u24 v14, 3, v14
  v_sub_u32 v16, v16, v14
  v_mul_lo_u32 v15, v15, s70
  v_lshl_add_u32 v15, v16, 11, v15
  s_waitcnt lgkmcnt(0)
  s_barrier
  v_fmac_f32 v80, v152, v128
  v_fmac_f32 v81, v153, v128
  v_fmac_f32 v82, v154, v128
  v_fmac_f32 v83, v155, v128
  v_fmac_f32 v84, v156, v128
  v_fmac_f32 v85, v157, v128
  v_fmac_f32 v86, v158, v128
  v_fmac_f32 v87, v159, v128
  v_mul_f32 v80, v80, v130
  v_mul_f32 v81, v81, v130
  v_mul_f32 v82, v82, v130
  v_mul_f32 v83, v83, v130
  v_mul_f32 v84, v84, v130
  v_mul_f32 v85, v85, v130
  v_mul_f32 v86, v86, v130
  v_mul_f32 v87, v87, v130
  v_cvt_pk_bf16_f32 v80, v80, v81
  v_cvt_pk_bf16_f32 v81, v82, v83
  v_cvt_pk_bf16_f32 v82, v84, v85
  v_cvt_pk_bf16_f32 v83, v86, v87
  v_add_u32 v17, v15, v8
  v_add_u32 v18, v15, v20
  v_permlane32_swap_b32 v80, v82
  v_permlane32_swap_b32 v81, v83
  s_andn2_b64 exec, exec, s[48:49]
  buffer_store_dwordx4 v[80:83], v17, s[16:19], s60 offen sc1
  s_mov_b64 exec, s[48:49]
  s_cbranch_execz L_qk_ns_7
  buffer_store_dwordx2 v[80:81], v18, s[16:19], s60 offen sc1
  buffer_store_dwordx2 v[82:83], v18, s[16:19], s62 offen sc1
L_qk_ns_7:
  s_mov_b64 exec, -1
  v_fmac_f32 v112, v152, v129
  v_fmac_f32 v113, v153, v129
  v_fmac_f32 v114, v154, v129
  v_fmac_f32 v115, v155, v129
  v_fmac_f32 v116, v156, v129
  v_fmac_f32 v117, v157, v129
  v_fmac_f32 v118, v158, v129
  v_fmac_f32 v119, v159, v129
  v_mul_f32 v112, v112, v131
  v_mul_f32 v113, v113, v131
  v_mul_f32 v114, v114, v131
  v_mul_f32 v115, v115, v131
  v_mul_f32 v116, v116, v131
  v_mul_f32 v117, v117, v131
  v_mul_f32 v118, v118, v131
  v_mul_f32 v119, v119, v131
  v_cvt_pk_bf16_f32 v112, v112, v113
  v_cvt_pk_bf16_f32 v113, v114, v115
  v_cvt_pk_bf16_f32 v114, v116, v117
  v_cvt_pk_bf16_f32 v115, v118, v119
  v_add_u32 v17, v15, v9
  v_add_u32 v18, v15, v21
  v_permlane32_swap_b32 v112, v114
  v_permlane32_swap_b32 v113, v115
  s_andn2_b64 exec, exec, s[48:49]
  buffer_store_dwordx4 v[112:115], v17, s[16:19], s60 offen sc1
  s_mov_b64 exec, s[48:49]
  s_cbranch_execz L_qk_ns_8
  buffer_store_dwordx2 v[112:113], v18, s[16:19], s60 offen sc1
  buffer_store_dwordx2 v[114:115], v18, s[16:19], s62 offen sc1
L_qk_ns_8:
  s_mov_b64 exec, -1
  v_add_u32 v14, 16, v13
  v_mul_u32_u24 v15, 1639, v14
  v_lshrrev_b32 v15, 16, v15
  v_mul_u32_u24 v16, 40, v15
  v_sub_u32 v16, v14, v16
  v_lshrrev_b32 v16, 3, v16
  v_cmp_lt_u32 vcc, 2, v16
  v_cmp_eq_u32 s[48:49], 2, v16
  v_lshlrev_b32 v15, 1, v15
  v_cndmask_b32 v14, 0, 1, vcc
  v_add_u32 v15, v15, v14
  v_mul_u32_u24 v14, 3, v14
  v_sub_u32 v16, v16, v14
  v_mul_lo_u32 v15, v15, s70
  v_lshl_add_u32 v15, v16, 11, v15
  v_fmac_f32 v88, v160, v128
  v_fmac_f32 v89, v161, v128
  v_fmac_f32 v90, v162, v128
  v_fmac_f32 v91, v163, v128
  v_fmac_f32 v92, v164, v128
  v_fmac_f32 v93, v165, v128
  v_fmac_f32 v94, v166, v128
  v_fmac_f32 v95, v167, v128
  v_mul_f32 v88, v88, v130
  v_mul_f32 v89, v89, v130
  v_mul_f32 v90, v90, v130
  v_mul_f32 v91, v91, v130
  v_mul_f32 v92, v92, v130
  v_mul_f32 v93, v93, v130
  v_mul_f32 v94, v94, v130
  v_mul_f32 v95, v95, v130
  v_cvt_pk_bf16_f32 v88, v88, v89
  v_cvt_pk_bf16_f32 v89, v90, v91
  v_cvt_pk_bf16_f32 v90, v92, v93
  v_cvt_pk_bf16_f32 v91, v94, v95
  v_add_u32 v17, v15, v8
  v_add_u32 v18, v15, v20
  v_permlane32_swap_b32 v88, v90
  v_permlane32_swap_b32 v89, v91
  s_andn2_b64 exec, exec, s[48:49]
  buffer_store_dwordx4 v[88:91], v17, s[16:19], s60 offen sc1
  s_mov_b64 exec, s[48:49]
  s_cbranch_execz L_qk_ns_9
  buffer_store_dwordx2 v[88:89], v18, s[16:19], s60 offen sc1
  buffer_store_dwordx2 v[90:91], v18, s[16:19], s62 offen sc1
L_qk_ns_9:
  s_mov_b64 exec, -1
  v_fmac_f32 v120, v160, v129
  v_fmac_f32 v121, v161, v129
  v_fmac_f32 v122, v162, v129
  v_fmac_f32 v123, v163, v129
  v_fmac_f32 v124, v164, v129
  v_fmac_f32 v125, v165, v129
  v_fmac_f32 v126, v166, v129
  v_fmac_f32 v127, v167, v129
  v_mul_f32 v120, v120, v131
  v_mul_f32 v121, v121, v131
  v_mul_f32 v122, v122, v131
  v_mul_f32 v123, v123, v131
  v_mul_f32 v124, v124, v131
  v_mul_f32 v125, v125, v131
  v_mul_f32 v126, v126, v131
  v_mul_f32 v127, v127, v131
  v_cvt_pk_bf16_f32 v120, v120, v121
  v_cvt_pk_bf16_f32 v121, v122, v123
  v_cvt_pk_bf16_f32 v122, v124, v125
  v_cvt_pk_bf16_f32 v123, v126, v127
  v_add_u32 v17, v15, v9
  v_add_u32 v18, v15, v21
  v_permlane32_swap_b32 v120, v122
  v_permlane32_swap_b32 v121, v123
  s_andn2_b64 exec, exec, s[48:49]
  buffer_store_dwordx4 v[120:123], v17, s[16:19], s60 offen sc1
  s_mov_b64 exec, s[48:49]
  s_cbranch_execz L_qk_ns_10
  buffer_store_dwordx2 v[120:121], v18, s[16:19], s60 offen sc1
  buffer_store_dwordx2 v[122:123], v18, s[16:19], s62 offen sc1
L_qk_ns_10:
  s_mov_b64 exec, -1
  s_lshl_b32 s60, s42, 2
  s_and_b32 s50, s41, 3
  s_add_u32 s60, s60, s50
  s_lshr_b32 s61, s41, 2
  s_mul_i32 s62, s60, 163840
  v_mov_b32 v12, -1
  v_mov_b32 v13, -1
  v_mov_b32 v14, -1
  v_mov_b32 v15, -1
  s_lshr_b32 s51, s60, 1
  s_mul_i32 s51, s51, 1280
  s_add_u32 s51, s51, 10485760
  s_lshl_b32 s53, s61, 4
  s_lshl_b32 s54, s38, 2
  s_add_u32 s53, s53, s54
  s_mul_i32 s53, s53, 20480
  s_add_u32 s51, s51, s53
  s_and_b32 s53, s60, 1
  s_mul_i32 s52, s53, 768
  s_add_u32 s52, s52, s51
  s_lshl_b32 s53, s53, 3
  s_add_u32 s51, s51, s53
  v_lshrrev_b32 v9, 4, v2
  v_mul_u32_u24 v9, 20480, v9
  v_and_b32 v10, 15, v2
  v_lshl_add_u32 v9, v10, 4, v9
  buffer_store_dwordx4 v[12:15], v9, s[16:19], s52 offen sc1
  buffer_store_dwordx4 v[12:15], v9, s[16:19], s52 offen offset:256 sc1
  buffer_store_dwordx2 v[12:13], v9, s[16:19], s51 offen offset:512 sc1
  s_barrier
  s_branch L_A_ld
L_p1_vtype:
  s_barrier
  ds_read_b128 v[8:11], v40 offset:0
  ds_read_b64_tr_b16 v[24:25], v56 offset:0
  ds_read_b64_tr_b16 v[26:27], v56 offset:1024
  ds_read_b64_tr_b16 v[28:29], v57 offset:0
  ds_read_b64_tr_b16 v[30:31], v57 offset:1024
  ds_read_b128 v[12:15], v44 offset:0
  s_waitcnt lgkmcnt(3)
  v_mfma_f32_32x32x16_bf16 v[64:79], v[8:11], v[24:27], v[64:79]
  ds_read_b128 v[16:19], v41 offset:0
  ds_read_b64_tr_b16 v[32:33], v56 offset:4096
  s_waitcnt lgkmcnt(3)
  v_mfma_f32_32x32x16_bf16 v[80:95], v[8:11], v[28:31], v[80:95]
  ds_read_b64_tr_b16 v[34:35], v56 offset:5120
  ds_read_b64_tr_b16 v[36:37], v57 offset:4096
  s_waitcnt lgkmcnt(4)
  v_mfma_f32_32x32x16_bf16 v[96:111], v[12:15], v[24:27], v[96:111]
  ds_read_b64_tr_b16 v[38:39], v57 offset:5120
  ds_read_b128 v[20:23], v45 offset:0
  v_mfma_f32_16x16x32_bf16 v[172:175], v[168:171], v[24:27], v[172:175]
  v_mfma_f32_32x32x16_bf16 v[112:127], v[12:15], v[28:31], v[112:127]
  v_mfma_f32_16x16x32_bf16 v[60:63], v[168:171], v[8:11], v[60:63]
  s_waitcnt lgkmcnt(3)
  v_mfma_f32_32x32x16_bf16 v[64:79], v[16:19], v[32:35], v[64:79]
  ds_read_b128 v[8:11], v42 offset:0
  ds_read_b64_tr_b16 v[24:25], v56 offset:8192
  s_waitcnt lgkmcnt(3)
  v_mfma_f32_32x32x16_bf16 v[80:95], v[16:19], v[36:39], v[80:95]
  ds_read_b64_tr_b16 v[26:27], v56 offset:9216
  ds_read_b64_tr_b16 v[28:29], v57 offset:8192
  s_waitcnt lgkmcnt(4)
  v_mfma_f32_32x32x16_bf16 v[96:111], v[20:23], v[32:35], v[96:111]
  ds_read_b64_tr_b16 v[30:31], v57 offset:9216
  ds_read_b128 v[12:15], v46 offset:0
  v_mfma_f32_16x16x32_bf16 v[172:175], v[168:171], v[32:35], v[172:175]
  v_mfma_f32_32x32x16_bf16 v[112:127], v[20:23], v[36:39], v[112:127]
  v_mfma_f32_16x16x32_bf16 v[60:63], v[168:171], v[16:19], v[60:63]
  s_waitcnt lgkmcnt(3)
  v_mfma_f32_32x32x16_bf16 v[64:79], v[8:11], v[24:27], v[64:79]
  ds_read_b128 v[16:19], v43 offset:0
  ds_read_b64_tr_b16 v[32:33], v56 offset:12288
  s_waitcnt lgkmcnt(3)
  v_mfma_f32_32x32x16_bf16 v[80:95], v[8:11], v[28:31], v[80:95]
  ds_read_b64_tr_b16 v[34:35], v56 offset:13312
  ds_read_b64_tr_b16 v[36:37], v57 offset:12288
  s_waitcnt lgkmcnt(4)
  v_mfma_f32_32x32x16_bf16 v[96:111], v[12:15], v[24:27], v[96:111]
  ds_read_b64_tr_b16 v[38:39], v57 offset:13312
  ds_read_b128 v[20:23], v47 offset:0
  v_mfma_f32_16x16x32_bf16 v[172:175], v[168:171], v[24:27], v[172:175]
  v_mfma_f32_32x32x16_bf16 v[112:127], v[12:15], v[28:31], v[112:127]
  v_mfma_f32_16x16x32_bf16 v[60:63], v[168:171], v[8:11], v[60:63]
  s_waitcnt lgkmcnt(0)
  s_barrier
  v_mfma_f32_32x32x16_bf16 v[64:79], v[16:19], v[32:35], v[64:79]
  ds_read_b128 v[8:11], v40 offset:16384
  ds_read_b64_tr_b16 v[24:25], v56 offset:16384
  v_mfma_f32_32x32x16_bf16 v[80:95], v[16:19], v[36:39], v[80:95]
  ds_read_b64_tr_b16 v[26:27], v56 offset:17408
  ds_read_b64_tr_b16 v[28:29], v57 offset:16384
  v_mfma_f32_32x32x16_bf16 v[96:111], v[20:23], v[32:35], v[96:111]
  ds_read_b64_tr_b16 v[30:31], v57 offset:17408
  ds_read_b128 v[12:15], v44 offset:16384
  v_mfma_f32_16x16x32_bf16 v[172:175], v[168:171], v[32:35], v[172:175]
  v_mfma_f32_32x32x16_bf16 v[112:127], v[20:23], v[36:39], v[112:127]
  v_mfma_f32_16x16x32_bf16 v[60:63], v[168:171], v[16:19], v[60:63]
  s_waitcnt lgkmcnt(3)
  v_mfma_f32_32x32x16_bf16 v[64:79], v[8:11], v[24:27], v[64:79]
  ds_read_b128 v[16:19], v41 offset:16384
  ds_read_b64_tr_b16 v[32:33], v56 offset:20480
  s_waitcnt lgkmcnt(3)
  v_mfma_f32_32x32x16_bf16 v[80:95], v[8:11], v[28:31], v[80:95]
  ds_read_b64_tr_b16 v[34:35], v56 offset:21504
  ds_read_b64_tr_b16 v[36:37], v57 offset:20480
  s_waitcnt lgkmcnt(4)
  v_mfma_f32_32x32x16_bf16 v[96:111], v[12:15], v[24:27], v[96:111]
  ds_read_b64_tr_b16 v[38:39], v57 offset:21504
  ds_read_b128 v[20:23], v45 offset:16384
  v_mfma_f32_16x16x32_bf16 v[172:175], v[168:171], v[24:27], v[172:175]
  v_mfma_f32_32x32x16_bf16 v[112:127], v[12:15], v[28:31], v[112:127]
  v_mfma_f32_16x16x32_bf16 v[60:63], v[168:171], v[8:11], v[60:63]
  s_waitcnt lgkmcnt(3)
  v_mfma_f32_32x32x16_bf16 v[64:79], v[16:19], v[32:35], v[64:79]
  ds_read_b128 v[8:11], v42 offset:16384
  ds_read_b64_tr_b16 v[24:25], v56 offset:24576
  s_waitcnt lgkmcnt(3)
  v_mfma_f32_32x32x16_bf16 v[80:95], v[16:19], v[36:39], v[80:95]
  ds_read_b64_tr_b16 v[26:27], v56 offset:25600
  ds_read_b64_tr_b16 v[28:29], v57 offset:24576
  s_waitcnt lgkmcnt(4)
  v_mfma_f32_32x32x16_bf16 v[96:111], v[20:23], v[32:35], v[96:111]
  ds_read_b64_tr_b16 v[30:31], v57 offset:25600
  ds_read_b128 v[12:15], v46 offset:16384
  v_mfma_f32_16x16x32_bf16 v[172:175], v[168:171], v[32:35], v[172:175]
  v_mfma_f32_32x32x16_bf16 v[112:127], v[20:23], v[36:39], v[112:127]
  v_mfma_f32_16x16x32_bf16 v[60:63], v[168:171], v[16:19], v[60:63]
  s_waitcnt lgkmcnt(3)
  v_mfma_f32_32x32x16_bf16 v[64:79], v[8:11], v[24:27], v[64:79]
  ds_read_b128 v[16:19], v43 offset:16384
  ds_read_b64_tr_b16 v[32:33], v56 offset:28672
  s_waitcnt lgkmcnt(3)
  v_mfma_f32_32x32x16_bf16 v[80:95], v[8:11], v[28:31], v[80:95]
  ds_read_b64_tr_b16 v[34:35], v56 offset:29696
  ds_read_b64_tr_b16 v[36:37], v57 offset:28672
  s_waitcnt lgkmcnt(4)
  v_mfma_f32_32x32x16_bf16 v[96:111], v[12:15], v[24:27], v[96:111]
  ds_read_b64_tr_b16 v[38:39], v57 offset:29696
  ds_read_b128 v[20:23], v47 offset:16384
  v_mfma_f32_16x16x32_bf16 v[172:175], v[168:171], v[24:27], v[172:175]
  v_mfma_f32_32x32x16_bf16 v[112:127], v[12:15], v[28:31], v[112:127]
  v_mfma_f32_16x16x32_bf16 v[60:63], v[168:171], v[8:11], v[60:63]
  s_waitcnt lgkmcnt(0)
  s_barrier
  v_mfma_f32_32x32x16_bf16 v[64:79], v[16:19], v[32:35], v[64:79]
  ds_read_b128 v[8:11], v40 offset:32768
  ds_read_b64_tr_b16 v[24:25], v56 offset:32768
  v_mfma_f32_32x32x16_bf16 v[80:95], v[16:19], v[36:39], v[80:95]
  ds_read_b64_tr_b16 v[26:27], v56 offset:33792
  ds_read_b64_tr_b16 v[28:29], v57 offset:32768
  v_mfma_f32_32x32x16_bf16 v[96:111], v[20:23], v[32:35], v[96:111]
  ds_read_b64_tr_b16 v[30:31], v57 offset:33792
  ds_read_b128 v[12:15], v44 offset:32768
  v_mfma_f32_16x16x32_bf16 v[172:175], v[168:171], v[32:35], v[172:175]
  v_mfma_f32_32x32x16_bf16 v[112:127], v[20:23], v[36:39], v[112:127]
  v_mfma_f32_16x16x32_bf16 v[60:63], v[168:171], v[16:19], v[60:63]
  s_waitcnt lgkmcnt(3)
  v_mfma_f32_32x32x16_bf16 v[64:79], v[8:11], v[24:27], v[64:79]
  ds_read_b128 v[16:19], v41 offset:32768
  ds_read_b64_tr_b16 v[32:33], v56 offset:36864
  s_waitcnt lgkmcnt(3)
  v_mfma_f32_32x32x16_bf16 v[80:95], v[8:11], v[28:31], v[80:95]
  ds_read_b64_tr_b16 v[34:35], v56 offset:37888
  ds_read_b64_tr_b16 v[36:37], v57 offset:36864
  s_waitcnt lgkmcnt(4)
  v_mfma_f32_32x32x16_bf16 v[96:111], v[12:15], v[24:27], v[96:111]
  ds_read_b64_tr_b16 v[38:39], v57 offset:37888
  ds_read_b128 v[20:23], v45 offset:32768
  v_mfma_f32_16x16x32_bf16 v[172:175], v[168:171], v[24:27], v[172:175]
  v_mfma_f32_32x32x16_bf16 v[112:127], v[12:15], v[28:31], v[112:127]
  v_mfma_f32_16x16x32_bf16 v[60:63], v[168:171], v[8:11], v[60:63]
  s_waitcnt lgkmcnt(3)
  v_mfma_f32_32x32x16_bf16 v[64:79], v[16:19], v[32:35], v[64:79]
  ds_read_b128 v[8:11], v42 offset:32768
  ds_read_b64_tr_b16 v[24:25], v56 offset:40960
  s_waitcnt lgkmcnt(3)
  v_mfma_f32_32x32x16_bf16 v[80:95], v[16:19], v[36:39], v[80:95]
  ds_read_b64_tr_b16 v[26:27], v56 offset:41984
  ds_read_b64_tr_b16 v[28:29], v57 offset:40960
  s_waitcnt lgkmcnt(4)
  v_mfma_f32_32x32x16_bf16 v[96:111], v[20:23], v[32:35], v[96:111]
  ds_read_b64_tr_b16 v[30:31], v57 offset:41984
  ds_read_b128 v[12:15], v46 offset:32768
  v_mfma_f32_16x16x32_bf16 v[172:175], v[168:171], v[32:35], v[172:175]
  v_mfma_f32_32x32x16_bf16 v[112:127], v[20:23], v[36:39], v[112:127]
  v_mfma_f32_16x16x32_bf16 v[60:63], v[168:171], v[16:19], v[60:63]
  s_waitcnt lgkmcnt(3)
  v_mfma_f32_32x32x16_bf16 v[64:79], v[8:11], v[24:27], v[64:79]
  ds_read_b128 v[16:19], v43 offset:32768
  ds_read_b64_tr_b16 v[32:33], v56 offset:45056
  s_waitcnt lgkmcnt(3)
  v_mfma_f32_32x32x16_bf16 v[80:95], v[8:11], v[28:31], v[80:95]
  ds_read_b64_tr_b16 v[34:35], v56 offset:46080
  ds_read_b64_tr_b16 v[36:37], v57 offset:45056
  s_waitcnt lgkmcnt(4)
  v_mfma_f32_32x32x16_bf16 v[96:111], v[12:15], v[24:27], v[96:111]
  ds_read_b64_tr_b16 v[38:39], v57 offset:46080
  ds_read_b128 v[20:23], v47 offset:32768
  v_mfma_f32_16x16x32_bf16 v[172:175], v[168:171], v[24:27], v[172:175]
  v_mfma_f32_32x32x16_bf16 v[112:127], v[12:15], v[28:31], v[112:127]
  v_mfma_f32_16x16x32_bf16 v[60:63], v[168:171], v[8:11], v[60:63]
  s_waitcnt lgkmcnt(0)
  s_barrier
  v_mfma_f32_32x32x16_bf16 v[64:79], v[16:19], v[32:35], v[64:79]
  ds_read_b128 v[8:11], v40 offset:49152
  ds_read_b64_tr_b16 v[24:25], v56 offset:49152
  v_mfma_f32_32x32x16_bf16 v[80:95], v[16:19], v[36:39], v[80:95]
  ds_read_b64_tr_b16 v[26:27], v56 offset:50176
  ds_read_b64_tr_b16 v[28:29], v57 offset:49152
  v_mfma_f32_32x32x16_bf16 v[96:111], v[20:23], v[32:35], v[96:111]
  ds_read_b64_tr_b16 v[30:31], v57 offset:50176
  ds_read_b128 v[12:15], v44 offset:49152
  v_mfma_f32_16x16x32_bf16 v[172:175], v[168:171], v[32:35], v[172:175]
  v_mfma_f32_32x32x16_bf16 v[112:127], v[20:23], v[36:39], v[112:127]
  v_mfma_f32_16x16x32_bf16 v[60:63], v[168:171], v[16:19], v[60:63]
  s_waitcnt lgkmcnt(3)
  v_mfma_f32_32x32x16_bf16 v[64:79], v[8:11], v[24:27], v[64:79]
  ds_read_b128 v[16:19], v41 offset:49152
  ds_read_b64_tr_b16 v[32:33], v56 offset:53248
  s_waitcnt lgkmcnt(3)
  v_mfma_f32_32x32x16_bf16 v[80:95], v[8:11], v[28:31], v[80:95]
  ds_read_b64_tr_b16 v[34:35], v56 offset:54272
  ds_read_b64_tr_b16 v[36:37], v57 offset:53248
  s_waitcnt lgkmcnt(4)
  v_mfma_f32_32x32x16_bf16 v[96:111], v[12:15], v[24:27], v[96:111]
  ds_read_b64_tr_b16 v[38:39], v57 offset:54272
  ds_read_b128 v[20:23], v45 offset:49152
  v_mfma_f32_16x16x32_bf16 v[172:175], v[168:171], v[24:27], v[172:175]
  v_mfma_f32_32x32x16_bf16 v[112:127], v[12:15], v[28:31], v[112:127]
  v_mfma_f32_16x16x32_bf16 v[60:63], v[168:171], v[8:11], v[60:63]
  s_waitcnt lgkmcnt(3)
  v_mfma_f32_32x32x16_bf16 v[64:79], v[16:19], v[32:35], v[64:79]
  ds_read_b128 v[8:11], v42 offset:49152
  ds_read_b64_tr_b16 v[24:25], v56 offset:57344
  s_waitcnt lgkmcnt(3)
  v_mfma_f32_32x32x16_bf16 v[80:95], v[16:19], v[36:39], v[80:95]
  ds_read_b64_tr_b16 v[26:27], v56 offset:58368
  ds_read_b64_tr_b16 v[28:29], v57 offset:57344
  s_waitcnt lgkmcnt(4)
  v_mfma_f32_32x32x16_bf16 v[96:111], v[20:23], v[32:35], v[96:111]
  ds_read_b64_tr_b16 v[30:31], v57 offset:58368
  ds_read_b128 v[12:15], v46 offset:49152
  v_mfma_f32_16x16x32_bf16 v[172:175], v[168:171], v[32:35], v[172:175]
  v_mfma_f32_32x32x16_bf16 v[112:127], v[20:23], v[36:39], v[112:127]
  s_add_u32 s50, s3, 1572864
  buffer_load_dwordx4 v[216:219], v214, s[4:7], s50 offen offset:0
  v_mfma_f32_16x16x32_bf16 v[60:63], v[168:171], v[16:19], v[60:63]
  s_waitcnt lgkmcnt(3)
  v_mfma_f32_32x32x16_bf16 v[64:79], v[8:11], v[24:27], v[64:79]
  ds_read_b128 v[16:19], v43 offset:49152
  ds_read_b64_tr_b16 v[32:33], v56 offset:61440
  s_waitcnt lgkmcnt(3)
  v_mfma_f32_32x32x16_bf16 v[80:95], v[8:11], v[28:31], v[80:95]
  ds_read_b64_tr_b16 v[34:35], v56 offset:62464
  ds_read_b64_tr_b16 v[36:37], v57 offset:61440
  s_waitcnt lgkmcnt(4)
  v_mfma_f32_32x32x16_bf16 v[96:111], v[12:15], v[24:27], v[96:111]
  ds_read_b64_tr_b16 v[38:39], v57 offset:62464
  ds_read_b128 v[20:23], v47 offset:49152
  v_mfma_f32_16x16x32_bf16 v[172:175], v[168:171], v[24:27], v[172:175]
  v_mfma_f32_32x32x16_bf16 v[112:127], v[12:15], v[28:31], v[112:127]
  v_mfma_f32_16x16x32_bf16 v[60:63], v[168:171], v[8:11], v[60:63]
  s_waitcnt lgkmcnt(0)
  s_barrier
  v_mfma_f32_32x32x16_bf16 v[64:79], v[16:19], v[32:35], v[64:79]
  ds_read_b128 v[8:11], v40 offset:0
  ds_read_b64_tr_b16 v[24:25], v56 offset:0
  v_mfma_f32_32x32x16_bf16 v[80:95], v[16:19], v[36:39], v[80:95]
  ds_read_b64_tr_b16 v[26:27], v56 offset:1024
  ds_read_b64_tr_b16 v[28:29], v57 offset:0
  v_mfma_f32_32x32x16_bf16 v[96:111], v[20:23], v[32:35], v[96:111]
  ds_read_b64_tr_b16 v[30:31], v57 offset:1024
  ds_read_b128 v[12:15], v44 offset:0
  v_mfma_f32_16x16x32_bf16 v[172:175], v[168:171], v[32:35], v[172:175]
  v_mfma_f32_32x32x16_bf16 v[112:127], v[20:23], v[36:39], v[112:127]
  s_add_u32 s50, s3, 1572864
  buffer_load_dwordx4 v[216:219], v214, s[4:7], s50 offen offset:256
  v_mfma_f32_16x16x32_bf16 v[60:63], v[168:171], v[16:19], v[60:63]
  s_waitcnt lgkmcnt(3)
  v_mfma_f32_32x32x16_bf16 v[64:79], v[8:11], v[24:27], v[64:79]
  ds_read_b128 v[16:19], v41 offset:0
  ds_read_b64_tr_b16 v[32:33], v56 offset:4096
  s_waitcnt lgkmcnt(3)
  v_mfma_f32_32x32x16_bf16 v[80:95], v[8:11], v[28:31], v[80:95]
  ds_read_b64_tr_b16 v[34:35], v56 offset:5120
  ds_read_b64_tr_b16 v[36:37], v57 offset:4096
  s_waitcnt lgkmcnt(4)
  v_mfma_f32_32x32x16_bf16 v[96:111], v[12:15], v[24:27], v[96:111]
  ds_read_b64_tr_b16 v[38:39], v57 offset:5120
  ds_read_b128 v[20:23], v45 offset:0
  v_mfma_f32_16x16x32_bf16 v[172:175], v[168:171], v[24:27], v[172:175]
  v_mfma_f32_32x32x16_bf16 v[112:127], v[12:15], v[28:31], v[112:127]
  v_mfma_f32_16x16x32_bf16 v[60:63], v[168:171], v[8:11], v[60:63]
  s_waitcnt lgkmcnt(3)
  v_mfma_f32_32x32x16_bf16 v[64:79], v[16:19], v[32:35], v[64:79]
  ds_read_b128 v[8:11], v42 offset:0
  ds_read_b64_tr_b16 v[24:25], v56 offset:8192
  s_waitcnt lgkmcnt(3)
  v_mfma_f32_32x32x16_bf16 v[80:95], v[16:19], v[36:39], v[80:95]
  ds_read_b64_tr_b16 v[26:27], v56 offset:9216
  ds_read_b64_tr_b16 v[28:29], v57 offset:8192
  s_waitcnt lgkmcnt(4)
  v_mfma_f32_32x32x16_bf16 v[96:111], v[20:23], v[32:35], v[96:111]
  ds_read_b64_tr_b16 v[30:31], v57 offset:9216
  ds_read_b128 v[12:15], v46 offset:0
  v_mfma_f32_16x16x32_bf16 v[172:175], v[168:171], v[32:35], v[172:175]
  v_mfma_f32_32x32x16_bf16 v[112:127], v[20:23], v[36:39], v[112:127]
  s_add_u32 s50, s3, 1572864
  buffer_load_dwordx4 v[216:219], v214, s[4:7], s50 offen offset:512
  v_mfma_f32_16x16x32_bf16 v[60:63], v[168:171], v[16:19], v[60:63]
  s_waitcnt lgkmcnt(3)
  v_mfma_f32_32x32x16_bf16 v[64:79], v[8:11], v[24:27], v[64:79]
  ds_read_b128 v[16:19], v43 offset:0
  ds_read_b64_tr_b16 v[32:33], v56 offset:12288
  s_waitcnt lgkmcnt(3)
  v_mfma_f32_32x32x16_bf16 v[80:95], v[8:11], v[28:31], v[80:95]
  ds_read_b64_tr_b16 v[34:35], v56 offset:13312
  ds_read_b64_tr_b16 v[36:37], v57 offset:12288
  s_waitcnt lgkmcnt(4)
  v_mfma_f32_32x32x16_bf16 v[96:111], v[12:15], v[24:27], v[96:111]
  ds_read_b64_tr_b16 v[38:39], v57 offset:13312
  ds_read_b128 v[20:23], v47 offset:0
  v_mfma_f32_16x16x32_bf16 v[172:175], v[168:171], v[24:27], v[172:175]
  v_mfma_f32_32x32x16_bf16 v[112:127], v[12:15], v[28:31], v[112:127]
  v_mfma_f32_16x16x32_bf16 v[60:63], v[168:171], v[8:11], v[60:63]
  s_waitcnt lgkmcnt(0)
  s_barrier
  v_mfma_f32_32x32x16_bf16 v[64:79], v[16:19], v[32:35], v[64:79]
  ds_read_b128 v[8:11], v40 offset:16384
  ds_read_b64_tr_b16 v[24:25], v56 offset:16384
  v_mfma_f32_32x32x16_bf16 v[80:95], v[16:19], v[36:39], v[80:95]
  ds_read_b64_tr_b16 v[26:27], v56 offset:17408
  ds_read_b64_tr_b16 v[28:29], v57 offset:16384
  v_mfma_f32_32x32x16_bf16 v[96:111], v[20:23], v[32:35], v[96:111]
  ds_read_b64_tr_b16 v[30:31], v57 offset:17408
  ds_read_b128 v[12:15], v44 offset:16384
  v_mfma_f32_16x16x32_bf16 v[172:175], v[168:171], v[32:35], v[172:175]
  v_mfma_f32_32x32x16_bf16 v[112:127], v[20:23], v[36:39], v[112:127]
  s_add_u32 s50, s3, 786432
  buffer_load_dwordx4 v[216:219], v214, s[4:7], s50 offen offset:0
  v_mfma_f32_16x16x32_bf16 v[60:63], v[168:171], v[16:19], v[60:63]
  s_waitcnt lgkmcnt(3)
  v_mfma_f32_32x32x16_bf16 v[64:79], v[8:11], v[24:27], v[64:79]
  ds_read_b128 v[16:19], v41 offset:16384
  ds_read_b64_tr_b16 v[32:33], v56 offset:20480
  s_waitcnt lgkmcnt(3)
  v_mfma_f32_32x32x16_bf16 v[80:95], v[8:11], v[28:31], v[80:95]
  ds_read_b64_tr_b16 v[34:35], v56 offset:21504
  ds_read_b64_tr_b16 v[36:37], v57 offset:20480
  s_waitcnt lgkmcnt(4)
  v_mfma_f32_32x32x16_bf16 v[96:111], v[12:15], v[24:27], v[96:111]
  ds_read_b64_tr_b16 v[38:39], v57 offset:21504
  ds_read_b128 v[20:23], v45 offset:16384
  v_mfma_f32_16x16x32_bf16 v[172:175], v[168:171], v[24:27], v[172:175]
  v_mfma_f32_32x32x16_bf16 v[112:127], v[12:15], v[28:31], v[112:127]
  v_mfma_f32_16x16x32_bf16 v[60:63], v[168:171], v[8:11], v[60:63]
  s_waitcnt lgkmcnt(3)
  v_mfma_f32_32x32x16_bf16 v[64:79], v[16:19], v[32:35], v[64:79]
  ds_read_b128 v[8:11], v42 offset:16384
  ds_read_b64_tr_b16 v[24:25], v56 offset:24576
  s_waitcnt lgkmcnt(3)
  v_mfma_f32_32x32x16_bf16 v[80:95], v[16:19], v[36:39], v[80:95]
  ds_read_b64_tr_b16 v[26:27], v56 offset:25600
  ds_read_b64_tr_b16 v[28:29], v57 offset:24576
  s_waitcnt lgkmcnt(4)
  v_mfma_f32_32x32x16_bf16 v[96:111], v[20:23], v[32:35], v[96:111]
  ds_read_b64_tr_b16 v[30:31], v57 offset:25600
  ds_read_b128 v[12:15], v46 offset:16384
  v_mfma_f32_16x16x32_bf16 v[172:175], v[168:171], v[32:35], v[172:175]
  v_mfma_f32_32x32x16_bf16 v[112:127], v[20:23], v[36:39], v[112:127]
  s_add_u32 s50, s3, 786432
  buffer_load_dwordx4 v[216:219], v214, s[4:7], s50 offen offset:256
  v_mfma_f32_16x16x32_bf16 v[60:63], v[168:171], v[16:19], v[60:63]
  s_waitcnt lgkmcnt(3)
  v_mfma_f32_32x32x16_bf16 v[64:79], v[8:11], v[24:27], v[64:79]
  ds_read_b128 v[16:19], v43 offset:16384
  ds_read_b64_tr_b16 v[32:33], v56 offset:28672
  s_waitcnt lgkmcnt(3)
  v_mfma_f32_32x32x16_bf16 v[80:95], v[8:11], v[28:31], v[80:95]
  ds_read_b64_tr_b16 v[34:35], v56 offset:29696
  ds_read_b64_tr_b16 v[36:37], v57 offset:28672
  s_waitcnt lgkmcnt(4)
  v_mfma_f32_32x32x16_bf16 v[96:111], v[12:15], v[24:27], v[96:111]
  ds_read_b64_tr_b16 v[38:39], v57 offset:29696
  ds_read_b128 v[20:23], v47 offset:16384
  v_mfma_f32_16x16x32_bf16 v[172:175], v[168:171], v[24:27], v[172:175]
  v_mfma_f32_32x32x16_bf16 v[112:127], v[12:15], v[28:31], v[112:127]
  v_mfma_f32_16x16x32_bf16 v[60:63], v[168:171], v[8:11], v[60:63]
  s_waitcnt lgkmcnt(0)
  s_barrier
  v_mfma_f32_32x32x16_bf16 v[64:79], v[16:19], v[32:35], v[64:79]
  ds_read_b128 v[8:11], v40 offset:32768
  ds_read_b64_tr_b16 v[24:25], v56 offset:32768
  v_mfma_f32_32x32x16_bf16 v[80:95], v[16:19], v[36:39], v[80:95]
  ds_read_b64_tr_b16 v[26:27], v56 offset:33792
  ds_read_b64_tr_b16 v[28:29], v57 offset:32768
  v_mfma_f32_32x32x16_bf16 v[96:111], v[20:23], v[32:35], v[96:111]
  ds_read_b64_tr_b16 v[30:31], v57 offset:33792
  ds_read_b128 v[12:15], v44 offset:32768
  v_mfma_f32_16x16x32_bf16 v[172:175], v[168:171], v[32:35], v[172:175]
  v_mfma_f32_32x32x16_bf16 v[112:127], v[20:23], v[36:39], v[112:127]
  s_add_u32 s50, s3, 786432
  buffer_load_dwordx4 v[216:219], v214, s[4:7], s50 offen offset:512
  v_mfma_f32_16x16x32_bf16 v[60:63], v[168:171], v[16:19], v[60:63]
  s_waitcnt lgkmcnt(3)
  v_mfma_f32_32x32x16_bf16 v[64:79], v[8:11], v[24:27], v[64:79]
  ds_read_b128 v[16:19], v41 offset:32768
  ds_read_b64_tr_b16 v[32:33], v56 offset:36864
  s_waitcnt lgkmcnt(3)
  v_mfma_f32_32x32x16_bf16 v[80:95], v[8:11], v[28:31], v[80:95]
  ds_read_b64_tr_b16 v[34:35], v56 offset:37888
  ds_read_b64_tr_b16 v[36:37], v57 offset:36864
  s_waitcnt lgkmcnt(4)
  v_mfma_f32_32x32x16_bf16 v[96:111], v[12:15], v[24:27], v[96:111]
  ds_read_b64_tr_b16 v[38:39], v57 offset:37888
  ds_read_b128 v[20:23], v45 offset:32768
  v_mfma_f32_16x16x32_bf16 v[172:175], v[168:171], v[24:27], v[172:175]
  v_mfma_f32_32x32x16_bf16 v[112:127], v[12:15], v[28:31], v[112:127]
  v_mfma_f32_16x16x32_bf16 v[60:63], v[168:171], v[8:11], v[60:63]
  s_waitcnt lgkmcnt(3)
  v_mfma_f32_32x32x16_bf16 v[64:79], v[16:19], v[32:35], v[64:79]
  ds_read_b128 v[8:11], v42 offset:32768
  ds_read_b64_tr_b16 v[24:25], v56 offset:40960
  s_waitcnt lgkmcnt(3)
  v_mfma_f32_32x32x16_bf16 v[80:95], v[16:19], v[36:39], v[80:95]
  ds_read_b64_tr_b16 v[26:27], v56 offset:41984
  ds_read_b64_tr_b16 v[28:29], v57 offset:40960
  s_waitcnt lgkmcnt(4)
  v_mfma_f32_32x32x16_bf16 v[96:111], v[20:23], v[32:35], v[96:111]
  ds_read_b64_tr_b16 v[30:31], v57 offset:41984
  ds_read_b128 v[12:15], v46 offset:32768
  v_mfma_f32_16x16x32_bf16 v[172:175], v[168:171], v[32:35], v[172:175]
  v_mfma_f32_32x32x16_bf16 v[112:127], v[20:23], v[36:39], v[112:127]
  s_add_u32 s50, s3, 0
  buffer_load_dwordx4 v[216:219], v214, s[4:7], s50 offen offset:0
  v_mfma_f32_16x16x32_bf16 v[60:63], v[168:171], v[16:19], v[60:63]
  s_waitcnt lgkmcnt(3)
  v_mfma_f32_32x32x16_bf16 v[64:79], v[8:11], v[24:27], v[64:79]
  ds_read_b128 v[16:19], v43 offset:32768
  ds_read_b64_tr_b16 v[32:33], v56 offset:45056
  s_waitcnt lgkmcnt(3)
  v_mfma_f32_32x32x16_bf16 v[80:95], v[8:11], v[28:31], v[80:95]
  ds_read_b64_tr_b16 v[34:35], v56 offset:46080
  ds_read_b64_tr_b16 v[36:37], v57 offset:45056
  s_waitcnt lgkmcnt(4)
  v_mfma_f32_32x32x16_bf16 v[96:111], v[12:15], v[24:27], v[96:111]
  ds_read_b64_tr_b16 v[38:39], v57 offset:46080
  ds_read_b128 v[20:23], v47 offset:32768
  v_mfma_f32_16x16x32_bf16 v[172:175], v[168:171], v[24:27], v[172:175]
  v_mfma_f32_32x32x16_bf16 v[112:127], v[12:15], v[28:31], v[112:127]
  v_mfma_f32_16x16x32_bf16 v[60:63], v[168:171], v[8:11], v[60:63]
  s_waitcnt lgkmcnt(0)
  s_barrier
  v_mfma_f32_32x32x16_bf16 v[64:79], v[16:19], v[32:35], v[64:79]
  ds_read_b128 v[8:11], v40 offset:49152
  ds_read_b64_tr_b16 v[24:25], v56 offset:49152
  v_mfma_f32_32x32x16_bf16 v[80:95], v[16:19], v[36:39], v[80:95]
  ds_read_b64_tr_b16 v[26:27], v56 offset:50176
  ds_read_b64_tr_b16 v[28:29], v57 offset:49152
  v_mfma_f32_32x32x16_bf16 v[96:111], v[20:23], v[32:35], v[96:111]
  ds_read_b64_tr_b16 v[30:31], v57 offset:50176
  ds_read_b128 v[12:15], v44 offset:49152
  v_mfma_f32_16x16x32_bf16 v[172:175], v[168:171], v[32:35], v[172:175]
  v_mfma_f32_32x32x16_bf16 v[112:127], v[20:23], v[36:39], v[112:127]
  s_add_u32 s50, s3, 0
  buffer_load_dwordx4 v[216:219], v214, s[4:7], s50 offen offset:256
  v_mfma_f32_16x16x32_bf16 v[60:63], v[168:171], v[16:19], v[60:63]
  s_waitcnt lgkmcnt(3)
  v_mfma_f32_32x32x16_bf16 v[64:79], v[8:11], v[24:27], v[64:79]
  ds_read_b128 v[16:19], v41 offset:49152
  ds_read_b64_tr_b16 v[32:33], v56 offset:53248
  s_waitcnt lgkmcnt(3)
  v_mfma_f32_32x32x16_bf16 v[80:95], v[8:11], v[28:31], v[80:95]
  ds_read_b64_tr_b16 v[34:35], v56 offset:54272
  ds_read_b64_tr_b16 v[36:37], v57 offset:53248
  s_waitcnt lgkmcnt(4)
  v_mfma_f32_32x32x16_bf16 v[96:111], v[12:15], v[24:27], v[96:111]
  ds_read_b64_tr_b16 v[38:39], v57 offset:54272
  ds_read_b128 v[20:23], v45 offset:49152
  v_mfma_f32_16x16x32_bf16 v[172:175], v[168:171], v[24:27], v[172:175]
  v_mfma_f32_32x32x16_bf16 v[112:127], v[12:15], v[28:31], v[112:127]
  v_mfma_f32_16x16x32_bf16 v[60:63], v[168:171], v[8:11], v[60:63]
  s_waitcnt lgkmcnt(3)
  v_mfma_f32_32x32x16_bf16 v[64:79], v[16:19], v[32:35], v[64:79]
  ds_read_b128 v[8:11], v42 offset:49152
  ds_read_b64_tr_b16 v[24:25], v56 offset:57344
  s_waitcnt lgkmcnt(3)
  v_mfma_f32_32x32x16_bf16 v[80:95], v[16:19], v[36:39], v[80:95]
  ds_read_b64_tr_b16 v[26:27], v56 offset:58368
  ds_read_b64_tr_b16 v[28:29], v57 offset:57344
  s_waitcnt lgkmcnt(4)
  v_mfma_f32_32x32x16_bf16 v[96:111], v[20:23], v[32:35], v[96:111]
  ds_read_b64_tr_b16 v[30:31], v57 offset:58368
  ds_read_b128 v[12:15], v46 offset:49152
  v_mfma_f32_16x16x32_bf16 v[172:175], v[168:171], v[32:35], v[172:175]
  v_mfma_f32_32x32x16_bf16 v[112:127], v[20:23], v[36:39], v[112:127]
  s_add_u32 s50, s3, 0
  buffer_load_dwordx4 v[216:219], v214, s[4:7], s50 offen offset:512
  v_mfma_f32_16x16x32_bf16 v[60:63], v[168:171], v[16:19], v[60:63]
  s_waitcnt lgkmcnt(3)
  v_mfma_f32_32x32x16_bf16 v[64:79], v[8:11], v[24:27], v[64:79]
  ds_read_b128 v[16:19], v43 offset:49152
  ds_read_b64_tr_b16 v[32:33], v56 offset:61440
  s_waitcnt lgkmcnt(3)
  v_mfma_f32_32x32x16_bf16 v[80:95], v[8:11], v[28:31], v[80:95]
  ds_read_b64_tr_b16 v[34:35], v56 offset:62464
  ds_read_b64_tr_b16 v[36:37], v57 offset:61440
  s_waitcnt lgkmcnt(4)
  v_mfma_f32_32x32x16_bf16 v[96:111], v[12:15], v[24:27], v[96:111]
  ds_read_b64_tr_b16 v[38:39], v57 offset:62464
  ds_read_b128 v[20:23], v47 offset:49152
  v_mfma_f32_16x16x32_bf16 v[172:175], v[168:171], v[24:27], v[172:175]
  v_mfma_f32_32x32x16_bf16 v[112:127], v[12:15], v[28:31], v[112:127]
  v_mfma_f32_16x16x32_bf16 v[60:63], v[168:171], v[8:11], v[60:63]
  s_waitcnt lgkmcnt(0)
  s_barrier
  v_mfma_f32_32x32x16_bf16 v[64:79], v[16:19], v[32:35], v[64:79]
  ds_read_b128 v[8:11], v40 offset:0
  ds_read_b64_tr_b16 v[24:25], v56 offset:0
  v_mfma_f32_32x32x16_bf16 v[80:95], v[16:19], v[36:39], v[80:95]
  ds_read_b64_tr_b16 v[26:27], v56 offset:1024
  ds_read_b64_tr_b16 v[28:29], v57 offset:0
  v_mfma_f32_32x32x16_bf16 v[96:111], v[20:23], v[32:35], v[96:111]
  ds_read_b64_tr_b16 v[30:31], v57 offset:1024
  ds_read_b128 v[12:15], v44 offset:0
  v_mfma_f32_16x16x32_bf16 v[172:175], v[168:171], v[32:35], v[172:175]
  v_mfma_f32_32x32x16_bf16 v[112:127], v[20:23], v[36:39], v[112:127]
  v_mfma_f32_16x16x32_bf16 v[60:63], v[168:171], v[16:19], v[60:63]
  s_waitcnt lgkmcnt(3)
  v_mfma_f32_32x32x16_bf16 v[64:79], v[8:11], v[24:27], v[64:79]
  ds_read_b128 v[16:19], v41 offset:0
  ds_read_b64_tr_b16 v[32:33], v56 offset:4096
  s_waitcnt lgkmcnt(3)
  v_mfma_f32_32x32x16_bf16 v[80:95], v[8:11], v[28:31], v[80:95]
  ds_read_b64_tr_b16 v[34:35], v56 offset:5120
  ds_read_b64_tr_b16 v[36:37], v57 offset:4096
  s_waitcnt lgkmcnt(4)
  v_mfma_f32_32x32x16_bf16 v[96:111], v[12:15], v[24:27], v[96:111]
  ds_read_b64_tr_b16 v[38:39], v57 offset:5120
  ds_read_b128 v[20:23], v45 offset:0
  v_mfma_f32_16x16x32_bf16 v[172:175], v[168:171], v[24:27], v[172:175]
  v_mfma_f32_32x32x16_bf16 v[112:127], v[12:15], v[28:31], v[112:127]
  v_mfma_f32_16x16x32_bf16 v[60:63], v[168:171], v[8:11], v[60:63]
  s_waitcnt lgkmcnt(3)
  v_mfma_f32_32x32x16_bf16 v[64:79], v[16:19], v[32:35], v[64:79]
  ds_read_b128 v[8:11], v42 offset:0
  ds_read_b64_tr_b16 v[24:25], v56 offset:8192
  s_waitcnt lgkmcnt(3)
  v_mfma_f32_32x32x16_bf16 v[80:95], v[16:19], v[36:39], v[80:95]
  ds_read_b64_tr_b16 v[26:27], v56 offset:9216
  ds_read_b64_tr_b16 v[28:29], v57 offset:8192
  s_waitcnt lgkmcnt(4)
  v_mfma_f32_32x32x16_bf16 v[96:111], v[20:23], v[32:35], v[96:111]
  ds_read_b64_tr_b16 v[30:31], v57 offset:9216
  ds_read_b128 v[12:15], v46 offset:0
  v_mfma_f32_16x16x32_bf16 v[172:175], v[168:171], v[32:35], v[172:175]
  v_mfma_f32_32x32x16_bf16 v[112:127], v[20:23], v[36:39], v[112:127]
  v_mov_b32 v215, 0
  global_load_dword v215, v215, s[36:37] sc1
  v_mfma_f32_16x16x32_bf16 v[60:63], v[168:171], v[16:19], v[60:63]
  s_waitcnt lgkmcnt(3)
  v_mfma_f32_32x32x16_bf16 v[64:79], v[8:11], v[24:27], v[64:79]
  ds_read_b128 v[16:19], v43 offset:0
  ds_read_b64_tr_b16 v[32:33], v56 offset:12288
  s_waitcnt lgkmcnt(3)
  v_mfma_f32_32x32x16_bf16 v[80:95], v[8:11], v[28:31], v[80:95]
  ds_read_b64_tr_b16 v[34:35], v56 offset:13312
  ds_read_b64_tr_b16 v[36:37], v57 offset:12288
  s_waitcnt lgkmcnt(4)
  v_mfma_f32_32x32x16_bf16 v[96:111], v[12:15], v[24:27], v[96:111]
  ds_read_b64_tr_b16 v[38:39], v57 offset:13312
  ds_read_b128 v[20:23], v47 offset:0
  v_mfma_f32_16x16x32_bf16 v[172:175], v[168:171], v[24:27], v[172:175]
  v_mfma_f32_32x32x16_bf16 v[112:127], v[12:15], v[28:31], v[112:127]
  v_mfma_f32_16x16x32_bf16 v[60:63], v[168:171], v[8:11], v[60:63]
  s_waitcnt lgkmcnt(0)
  s_barrier
  v_mfma_f32_32x32x16_bf16 v[64:79], v[16:19], v[32:35], v[64:79]
  ds_read_b128 v[8:11], v40 offset:16384
  ds_read_b64_tr_b16 v[24:25], v56 offset:16384
  v_mfma_f32_32x32x16_bf16 v[80:95], v[16:19], v[36:39], v[80:95]
  ds_read_b64_tr_b16 v[26:27], v56 offset:17408
  ds_read_b64_tr_b16 v[28:29], v57 offset:16384
  v_mfma_f32_32x32x16_bf16 v[96:111], v[20:23], v[32:35], v[96:111]
  ds_read_b64_tr_b16 v[30:31], v57 offset:17408
  ds_read_b128 v[12:15], v44 offset:16384
  v_mfma_f32_16x16x32_bf16 v[172:175], v[168:171], v[32:35], v[172:175]
  v_mfma_f32_32x32x16_bf16 v[112:127], v[20:23], v[36:39], v[112:127]
  v_mfma_f32_16x16x32_bf16 v[60:63], v[168:171], v[16:19], v[60:63]
  s_waitcnt lgkmcnt(3)
  v_mfma_f32_32x32x16_bf16 v[64:79], v[8:11], v[24:27], v[64:79]
  ds_read_b128 v[16:19], v41 offset:16384
  ds_read_b64_tr_b16 v[32:33], v56 offset:20480
  s_waitcnt lgkmcnt(3)
  v_mfma_f32_32x32x16_bf16 v[80:95], v[8:11], v[28:31], v[80:95]
  ds_read_b64_tr_b16 v[34:35], v56 offset:21504
  ds_read_b64_tr_b16 v[36:37], v57 offset:20480
  s_waitcnt lgkmcnt(4)
  v_mfma_f32_32x32x16_bf16 v[96:111], v[12:15], v[24:27], v[96:111]
  ds_read_b64_tr_b16 v[38:39], v57 offset:21504
  ds_read_b128 v[20:23], v45 offset:16384
  v_mfma_f32_16x16x32_bf16 v[172:175], v[168:171], v[24:27], v[172:175]
  v_mfma_f32_32x32x16_bf16 v[112:127], v[12:15], v[28:31], v[112:127]
  v_mfma_f32_16x16x32_bf16 v[60:63], v[168:171], v[8:11], v[60:63]
  s_waitcnt lgkmcnt(3)
  v_mfma_f32_32x32x16_bf16 v[64:79], v[16:19], v[32:35], v[64:79]
  ds_read_b128 v[8:11], v42 offset:16384
  ds_read_b64_tr_b16 v[24:25], v56 offset:24576
  s_waitcnt lgkmcnt(3)
  v_mfma_f32_32x32x16_bf16 v[80:95], v[16:19], v[36:39], v[80:95]
  ds_read_b64_tr_b16 v[26:27], v56 offset:25600
  ds_read_b64_tr_b16 v[28:29], v57 offset:24576
  s_waitcnt lgkmcnt(4)
  v_mfma_f32_32x32x16_bf16 v[96:111], v[20:23], v[32:35], v[96:111]
  ds_read_b64_tr_b16 v[30:31], v57 offset:25600
  ds_read_b128 v[12:15], v46 offset:16384
  v_mfma_f32_16x16x32_bf16 v[172:175], v[168:171], v[32:35], v[172:175]
  v_mfma_f32_32x32x16_bf16 v[112:127], v[20:23], v[36:39], v[112:127]
  v_mfma_f32_16x16x32_bf16 v[60:63], v[168:171], v[16:19], v[60:63]
  s_waitcnt lgkmcnt(3)
  v_mfma_f32_32x32x16_bf16 v[64:79], v[8:11], v[24:27], v[64:79]
  ds_read_b128 v[16:19], v43 offset:16384
  ds_read_b64_tr_b16 v[32:33], v56 offset:28672
  s_waitcnt lgkmcnt(3)
  v_mfma_f32_32x32x16_bf16 v[80:95], v[8:11], v[28:31], v[80:95]
  ds_read_b64_tr_b16 v[34:35], v56 offset:29696
  ds_read_b64_tr_b16 v[36:37], v57 offset:28672
  s_waitcnt lgkmcnt(4)
  v_mfma_f32_32x32x16_bf16 v[96:111], v[12:15], v[24:27], v[96:111]
  ds_read_b64_tr_b16 v[38:39], v57 offset:29696
  ds_read_b128 v[20:23], v47 offset:16384
  v_mfma_f32_16x16x32_bf16 v[172:175], v[168:171], v[24:27], v[172:175]
  v_mfma_f32_32x32x16_bf16 v[112:127], v[12:15], v[28:31], v[112:127]
  v_mfma_f32_16x16x32_bf16 v[60:63], v[168:171], v[8:11], v[60:63]
  s_waitcnt lgkmcnt(3)
  v_mfma_f32_32x32x16_bf16 v[64:79], v[16:19], v[32:35], v[64:79]
  s_waitcnt lgkmcnt(1)
  v_mfma_f32_32x32x16_bf16 v[80:95], v[16:19], v[36:39], v[80:95]
  s_waitcnt lgkmcnt(0)
  v_mfma_f32_32x32x16_bf16 v[96:111], v[20:23], v[32:35], v[96:111]
  v_mfma_f32_16x16x32_bf16 v[172:175], v[168:171], v[32:35], v[172:175]
  v_mfma_f32_32x32x16_bf16 v[112:127], v[20:23], v[36:39], v[112:127]
  v_mfma_f32_16x16x32_bf16 v[60:63], v[168:171], v[16:19], v[60:63]
  s_lshl_b32 s50, s69, 1
  s_add_u32 s50, s50, s68
  s_lshl_b32 s50, s50, 7
  s_add_u32 s50, s50, 70656
  v_lshl_add_u32 v176, v3, 2, s50
  s_lshl_b32 s50, s68, 1
  s_add_u32 s50, s50, s69
  s_lshl_b32 s50, s50, 7
  s_add_u32 s50, s50, 65536
  v_lshl_add_u32 v177, v3, 2, s50
  s_nop 1
  s_mov_b64 exec, 0xffff
  ds_write_b32 v176, v172
  ds_write_b32 v176, v173 offset:64
  ds_write_b32 v177, v60 offset:5632
  ds_write_b32 v177, v61 offset:5696
  s_mov_b64 exec, -1
  s_waitcnt lgkmcnt(0)
  s_barrier
  s_waitcnt vmcnt(0)
  s_mov_b32 s51, 0
L_non_11:
  v_readfirstlane_b32 s58, v215
  s_add_u32 s51, s51, 1
  s_cmp_lg_u32 s58, 0
  s_cbranch_scc1 L_non_11_ok
  s_cmp_ge_u32 s51, 0x20000
  s_cbranch_scc1 L_non_11_ok
  s_sleep 8
  v_mov_b32 v215, 0
  global_load_dword v215, v215, s[36:37] sc1
  s_waitcnt vmcnt(0)
  s_branch L_non_11
L_non_11_ok:
  s_cmp_eq_u32 s43, 15
  s_cbranch_scc1 L_A_dummy
  s_sub_u32 s62, s40, 10
  s_lshl_b32 s62, s62, 7
  s_mov_b32 s61, 163840
  s_xor_b32 s60, s68, 0
  s_lshl_b32 s57, s69, 1
  s_add_u32 s60, s60, s57
  s_lshl_b32 s60, s60, 5
  v_add_u32 v44, s60, v3
  v_lshlrev_b32 v45, 2, v44
  v_add_u32 v45, 65536, v45
  ds_read_b32 v40, v45 offset:5120
  v_add_u32 v44, s62, v44
  v_mul_u32_u24 v45, 3277, v44
  v_lshrrev_b32 v45, 16, v45
  v_mul_u32_u24 v46, 20, v45
  v_sub_u32 v46, v44, v46
  v_mul_lo_u32 v45, v45, s61
  v_lshl_add_u32 v45, v46, 4, v45
  v_mul_u32_u24 v46, 320, v4
  v_add_u32 v42, v45, v46
  s_xor_b32 s60, s68, 1
  s_lshl_b32 s57, s69, 1
  s_add_u32 s60, s60, s57
  s_lshl_b32 s60, s60, 5
  v_add_u32 v44, s60, v3
  v_lshlrev_b32 v45, 2, v44
  v_add_u32 v45, 65536, v45
  ds_read_b32 v41, v45 offset:5120
  v_add_u32 v44, s62, v44
  v_mul_u32_u24 v45, 3277, v44
  v_lshrrev_b32 v45, 16, v45
  v_mul_u32_u24 v46, 20, v45
  v_sub_u32 v46, v44, v46
  v_mul_lo_u32 v45, v45, s61
  v_lshl_add_u32 v45, v46, 4, v45
  v_mul_u32_u24 v46, 320, v4
  v_add_u32 v43, v45, v46
  s_xor_b32 s60, s69, 0
  s_lshl_b32 s57, s68, 1
  s_add_u32 s60, s60, s57
  s_lshl_b32 s50, s60, 7
  s_add_u32 s50, s50, 65536
  v_lshl_add_u32 v47, v4, 4, s50
  s_mul_i32 s60, s60, 1280
  s_mul_i32 s50, s39, 10240
  s_add_u32 s60, s60, s50
  s_add_u32 s61, s60, 5248000
  s_xor_b32 s60, s69, 1
  s_lshl_b32 s57, s68, 1
  s_add_u32 s60, s60, s57
  s_lshl_b32 s50, s60, 7
  s_add_u32 s50, s50, 65536
  v_lshl_add_u32 v48, v4, 4, s50
  s_mul_i32 s60, s60, 1280
  s_mul_i32 s50, s39, 10240
  s_add_u32 s60, s60, s50
  s_add_u32 s62, s60, 5248000
  s_barrier
  ds_read_b128 v[136:139], v47 offset:2048
  ds_read_b128 v[152:155], v47 offset:2560
  ds_read_b128 v[140:143], v47 offset:2080
  ds_read_b128 v[156:159], v47 offset:2592
  ds_read_b128 v[144:147], v47 offset:2112
  ds_read_b128 v[160:163], v47 offset:2624
  ds_read_b128 v[148:151], v47 offset:2144
  ds_read_b128 v[164:167], v47 offset:2656
  s_waitcnt lgkmcnt(7)
  ds_read_b128 v[8:11], v48 offset:2048
  ds_read_b128 v[24:27], v48 offset:2560
  ds_read_b128 v[12:15], v48 offset:2080
  ds_read_b128 v[28:31], v48 offset:2592
  ds_read_b128 v[16:19], v48 offset:2112
  ds_read_b128 v[32:35], v48 offset:2624
  ds_read_b128 v[20:23], v48 offset:2144
  ds_read_b128 v[36:39], v48 offset:2656
  s_waitcnt lgkmcnt(8)
  v_fmac_f32 v64, v136, v40
  v_fmac_f32 v65, v137, v40
  v_fmac_f32 v66, v138, v40
  v_fmac_f32 v67, v139, v40
  v_fmac_f32 v68, v140, v40
  v_fmac_f32 v69, v141, v40
  v_fmac_f32 v70, v142, v40
  v_fmac_f32 v71, v143, v40
  v_mul_f32 v64, v64, v152
  v_mul_f32 v65, v65, v153
  v_mul_f32 v66, v66, v154
  v_mul_f32 v67, v67, v155
  v_mul_f32 v68, v68, v156
  v_mul_f32 v69, v69, v157
  v_mul_f32 v70, v70, v158
  v_mul_f32 v71, v71, v159
  v_cvt_pk_bf16_f32 v64, v64, v65
  v_cvt_pk_bf16_f32 v65, v66, v67
  v_cvt_pk_bf16_f32 v66, v68, v69
  v_cvt_pk_bf16_f32 v67, v70, v71
  s_nop 1
  v_permlane32_swap_b32 v64, v66
  v_permlane32_swap_b32 v65, v67
  buffer_store_dwordx4 v[64:67], v42, s[16:19], s61 offen offset:0 sc1
  v_fmac_f32 v72, v144, v40
  v_fmac_f32 v73, v145, v40
  v_fmac_f32 v74, v146, v40
  v_fmac_f32 v75, v147, v40
  v_fmac_f32 v76, v148, v40
  v_fmac_f32 v77, v149, v40
  v_fmac_f32 v78, v150, v40
  v_fmac_f32 v79, v151, v40
  v_mul_f32 v72, v72, v160
  v_mul_f32 v73, v73, v161
  v_mul_f32 v74, v74, v162
  v_mul_f32 v75, v75, v163
  v_mul_f32 v76, v76, v164
  v_mul_f32 v77, v77, v165
  v_mul_f32 v78, v78, v166
  v_mul_f32 v79, v79, v167
  v_cvt_pk_bf16_f32 v72, v72, v73
  v_cvt_pk_bf16_f32 v73, v74, v75
  v_cvt_pk_bf16_f32 v74, v76, v77
  v_cvt_pk_bf16_f32 v75, v78, v79
  s_nop 1
  v_permlane32_swap_b32 v72, v74
  v_permlane32_swap_b32 v73, v75
  buffer_store_dwordx4 v[72:75], v42, s[16:19], s61 offen offset:640 sc1
  v_fmac_f32 v80, v136, v41
  v_fmac_f32 v81, v137, v41
  v_fmac_f32 v82, v138, v41
  v_fmac_f32 v83, v139, v41
  v_fmac_f32 v84, v140, v41
  v_fmac_f32 v85, v141, v41
  v_fmac_f32 v86, v142, v41
  v_fmac_f32 v87, v143, v41
  v_mul_f32 v80, v80, v152
  v_mul_f32 v81, v81, v153
  v_mul_f32 v82, v82, v154
  v_mul_f32 v83, v83, v155
  v_mul_f32 v84, v84, v156
  v_mul_f32 v85, v85, v157
  v_mul_f32 v86, v86, v158
  v_mul_f32 v87, v87, v159
  v_cvt_pk_bf16_f32 v80, v80, v81
  v_cvt_pk_bf16_f32 v81, v82, v83
  v_cvt_pk_bf16_f32 v82, v84, v85
  v_cvt_pk_bf16_f32 v83, v86, v87
  s_nop 1
  v_permlane32_swap_b32 v80, v82
  v_permlane32_swap_b32 v81, v83
  buffer_store_dwordx4 v[80:83], v43, s[16:19], s61 offen offset:0 sc1
  v_fmac_f32 v88, v144, v41
  v_fmac_f32 v89, v145, v41
  v_fmac_f32 v90, v146, v41
  v_fmac_f32 v91, v147, v41
  v_fmac_f32 v92, v148, v41
  v_fmac_f32 v93, v149, v41
  v_fmac_f32 v94, v150, v41
  v_fmac_f32 v95, v151, v41
  v_mul_f32 v88, v88, v160
  v_mul_f32 v89, v89, v161
  v_mul_f32 v90, v90, v162
  v_mul_f32 v91, v91, v163
  v_mul_f32 v92, v92, v164
  v_mul_f32 v93, v93, v165
  v_mul_f32 v94, v94, v166
  v_mul_f32 v95, v95, v167
  v_cvt_pk_bf16_f32 v88, v88, v89
  v_cvt_pk_bf16_f32 v89, v90, v91
  v_cvt_pk_bf16_f32 v90, v92, v93
  v_cvt_pk_bf16_f32 v91, v94, v95
  s_nop 1
  v_permlane32_swap_b32 v88, v90
  v_permlane32_swap_b32 v89, v91
  buffer_store_dwordx4 v[88:91], v43, s[16:19], s61 offen offset:640 sc1
  s_waitcnt lgkmcnt(0)
  v_fmac_f32 v96, v8, v40
  v_fmac_f32 v97, v9, v40
  v_fmac_f32 v98, v10, v40
  v_fmac_f32 v99, v11, v40
  v_fmac_f32 v100, v12, v40
  v_fmac_f32 v101, v13, v40
  v_fmac_f32 v102, v14, v40
  v_fmac_f32 v103, v15, v40
  v_mul_f32 v96, v96, v24
  v_mul_f32 v97, v97, v25
  v_mul_f32 v98, v98, v26
  v_mul_f32 v99, v99, v27
  v_mul_f32 v100, v100, v28
  v_mul_f32 v101, v101, v29
  s_waitcnt lgkmcnt(0)
  s_barrier
  v_mul_f32 v102, v102, v30
  v_mul_f32 v103, v103, v31
  v_cvt_pk_bf16_f32 v96, v96, v97
  v_cvt_pk_bf16_f32 v97, v98, v99
  v_cvt_pk_bf16_f32 v98, v100, v101
  v_cvt_pk_bf16_f32 v99, v102, v103
  s_nop 1
  v_permlane32_swap_b32 v96, v98
  v_permlane32_swap_b32 v97, v99
  buffer_store_dwordx4 v[96:99], v42, s[16:19], s62 offen offset:0 sc1
  v_fmac_f32 v104, v16, v40
  v_fmac_f32 v105, v17, v40
  v_fmac_f32 v106, v18, v40
  v_fmac_f32 v107, v19, v40
  v_fmac_f32 v108, v20, v40
  v_fmac_f32 v109, v21, v40
  v_fmac_f32 v110, v22, v40
  v_fmac_f32 v111, v23, v40
  v_mul_f32 v104, v104, v32
  v_mul_f32 v105, v105, v33
  v_mul_f32 v106, v106, v34
  v_mul_f32 v107, v107, v35
  v_mul_f32 v108, v108, v36
  v_mul_f32 v109, v109, v37
  v_mul_f32 v110, v110, v38
  v_mul_f32 v111, v111, v39
  v_cvt_pk_bf16_f32 v104, v104, v105
  v_cvt_pk_bf16_f32 v105, v106, v107
  v_cvt_pk_bf16_f32 v106, v108, v109
  v_cvt_pk_bf16_f32 v107, v110, v111
  s_nop 1
  v_permlane32_swap_b32 v104, v106
  v_permlane32_swap_b32 v105, v107
  buffer_store_dwordx4 v[104:107], v42, s[16:19], s62 offen offset:640 sc1
  v_fmac_f32 v112, v8, v41
  v_fmac_f32 v113, v9, v41
  v_fmac_f32 v114, v10, v41
  v_fmac_f32 v115, v11, v41
  v_fmac_f32 v116, v12, v41
  v_fmac_f32 v117, v13, v41
  v_fmac_f32 v118, v14, v41
  v_fmac_f32 v119, v15, v41
  v_mul_f32 v112, v112, v24
  v_mul_f32 v113, v113, v25
  v_mul_f32 v114, v114, v26
  v_mul_f32 v115, v115, v27
  v_mul_f32 v116, v116, v28
  v_mul_f32 v117, v117, v29
  v_mul_f32 v118, v118, v30
  v_mul_f32 v119, v119, v31
  v_cvt_pk_bf16_f32 v112, v112, v113
  v_cvt_pk_bf16_f32 v113, v114, v115
  v_cvt_pk_bf16_f32 v114, v116, v117
  v_cvt_pk_bf16_f32 v115, v118, v119
  s_nop 1
  v_permlane32_swap_b32 v112, v114
  v_permlane32_swap_b32 v113, v115
  buffer_store_dwordx4 v[112:115], v43, s[16:19], s62 offen offset:0 sc1
  v_fmac_f32 v120, v16, v41
  v_fmac_f32 v121, v17, v41
  v_fmac_f32 v122, v18, v41
  v_fmac_f32 v123, v19, v41
  v_fmac_f32 v124, v20, v41
  v_fmac_f32 v125, v21, v41
  v_fmac_f32 v126, v22, v41
  v_fmac_f32 v127, v23, v41
  v_mul_f32 v120, v120, v32
  v_mul_f32 v121, v121, v33
  v_mul_f32 v122, v122, v34
  v_mul_f32 v123, v123, v35
  v_mul_f32 v124, v124, v36
  v_mul_f32 v125, v125, v37
  v_mul_f32 v126, v126, v38
  v_mul_f32 v127, v127, v39
  v_cvt_pk_bf16_f32 v120, v120, v121
  v_cvt_pk_bf16_f32 v121, v122, v123
  v_cvt_pk_bf16_f32 v122, v124, v125
  v_cvt_pk_bf16_f32 v123, v126, v127
  s_nop 1
  v_permlane32_swap_b32 v120, v122
  v_permlane32_swap_b32 v121, v123
  buffer_store_dwordx4 v[120:123], v43, s[16:19], s62 offen offset:640 sc1
  s_lshl_b32 s60, s42, 2
  s_and_b32 s50, s41, 3
  s_add_u32 s60, s60, s50
  s_lshr_b32 s61, s41, 2
  s_mul_i32 s62, s60, 163840
  v_mov_b32 v12, -1
  v_mov_b32 v13, -1
  v_mov_b32 v14, -1
  v_mov_b32 v15, -1
  s_lshr_b32 s51, s60, 1
  s_mul_i32 s51, s51, 1280
  s_add_u32 s51, s51, 10485760
  s_lshl_b32 s53, s61, 4
  s_lshl_b32 s54, s38, 2
  s_add_u32 s53, s53, s54
  s_mul_i32 s53, s53, 20480
  s_add_u32 s51, s51, s53
  s_and_b32 s53, s60, 1
  s_mul_i32 s52, s53, 768
  s_add_u32 s52, s52, s51
  s_lshl_b32 s53, s53, 3
  s_add_u32 s51, s51, s53
  v_lshrrev_b32 v9, 4, v2
  v_mul_u32_u24 v9, 20480, v9
  v_and_b32 v10, 15, v2
  v_lshl_add_u32 v9, v10, 4, v9
  buffer_store_dwordx4 v[12:15], v9, s[16:19], s52 offen sc1
  buffer_store_dwordx4 v[12:15], v9, s[16:19], s52 offen offset:256 sc1
  buffer_store_dwordx2 v[12:13], v9, s[16:19], s51 offen offset:512 sc1
  s_barrier
  s_branch L_A_ld
L_A_dummy:
  s_barrier
  s_lshl_b32 s60, s42, 2
  s_and_b32 s50, s41, 3
  s_add_u32 s60, s60, s50
  s_lshr_b32 s61, s41, 2
  s_mul_i32 s62, s60, 163840
  v_mov_b32 v12, -1
  v_mov_b32 v13, -1
  v_mov_b32 v14, -1
  v_mov_b32 v15, -1
  s_lshr_b32 s51, s60, 1
  s_mul_i32 s51, s51, 1280
  s_add_u32 s51, s51, 10485760
  s_lshl_b32 s53, s61, 4
  s_lshl_b32 s54, s38, 2
  s_add_u32 s53, s53, s54
  s_mul_i32 s53, s53, 20480
  s_add_u32 s51, s51, s53
  s_and_b32 s53, s60, 1
  s_mul_i32 s52, s53, 768
  s_add_u32 s52, s52, s51
  s_lshl_b32 s53, s53, 3
  s_add_u32 s51, s51, s53
  v_lshrrev_b32 v9, 4, v2
  v_mul_u32_u24 v9, 20480, v9
  v_and_b32 v10, 15, v2
  v_lshl_add_u32 v9, v10, 4, v9
  buffer_store_dwordx4 v[12:15], v9, s[16:19], s52 offen sc1
  buffer_store_dwordx4 v[12:15], v9, s[16:19], s52 offen offset:256 sc1
  buffer_store_dwordx2 v[12:13], v9, s[16:19], s51 offen offset:512 sc1
  s_waitcnt lgkmcnt(0)
  s_barrier
  s_barrier
  s_branch L_A_ld
L_A_ld:
  v_lshlrev_b32 v8, 4, v2
  s_barrier
  s_add_u32 m0, s65, 49152
  s_add_u32 s50, s64, 384
  buffer_load_dwordx4 v220, s[8:11], s50 offen lds
  s_add_u32 m0, s65, 50176
  s_add_u32 s50, s64, 10624
  buffer_load_dwordx4 v221, s[8:11], s50 offen lds
  s_add_u32 m0, s65, 51200
  s_add_u32 s50, s64, 20864
  buffer_load_dwordx4 v220, s[8:11], s50 offen lds
  s_add_u32 m0, s65, 52224
  s_add_u32 s50, s64, 31104
  buffer_load_dwordx4 v221, s[8:11], s50 offen lds
  s_add_u32 m0, s66, 90112
  s_add_u32 s50, s63, 589824
  buffer_load_dwordx4 v222, s[20:23], s50 offen lds
  s_add_u32 m0, s66, 91136
  s_add_u32 s50, s63, 589824
  buffer_load_dwordx4 v223, s[20:23], s50 offen lds
  s_add_u32 m0, s66, 92160
  s_add_u32 s50, s63, 589824
  buffer_load_dwordx4 v224, s[20:23], s50 offen lds
  s_add_u32 m0, s66, 102400
  s_add_u32 s50, s63, 589824
  buffer_load_dwordx4 v222, s[24:27], s50 offen lds
  s_add_u32 m0, s66, 103424
  s_add_u32 s50, s63, 589824
  buffer_load_dwordx4 v223, s[24:27], s50 offen lds
  s_add_u32 m0, s66, 104448
  s_add_u32 s50, s63, 589824
  buffer_load_dwordx4 v224, s[24:27], s50 offen lds
  buffer_load_dwordx4 v[216:219], v230, s[32:35], 0 offen
  buffer_load_dwordx4 v[216:219], v231, s[32:35], 0 offen
  s_waitcnt vmcnt(12)
  s_barrier
  s_cmp_lg_u32 s38, 0
  s_cbranch_scc1 L_f1add_12
  s_lshl_b32 s50, s2, 7
  s_add_u32 s50, s50, 28377088
  v_mov_b32 v9, 0
  v_mov_b32 v10, s58
  s_mov_b64 exec, 1
  buffer_store_dword v10, v9, s[16:19], s50 offen sc1
  s_mov_b64 exec, -1
L_f1add_12:
  s_add_u32 m0, s65, 32768
  s_add_u32 s50, s64, 256
  buffer_load_dwordx4 v220, s[8:11], s50 offen lds
  s_add_u32 m0, s65, 33792
  s_add_u32 s50, s64, 10496
  buffer_load_dwordx4 v221, s[8:11], s50 offen lds
  s_add_u32 m0, s65, 34816
  s_add_u32 s50, s64, 20736
  buffer_load_dwordx4 v220, s[8:11], s50 offen lds
  s_add_u32 m0, s65, 35840
  s_add_u32 s50, s64, 30976
  buffer_load_dwordx4 v221, s[8:11], s50 offen lds
  s_add_u32 m0, s66, 65536
  s_add_u32 s50, s63, 393216
  buffer_load_dwordx4 v222, s[20:23], s50 offen lds
  s_add_u32 m0, s66, 66560
  s_add_u32 s50, s63, 393216
  buffer_load_dwordx4 v223, s[20:23], s50 offen lds
  s_add_u32 m0, s66, 67584
  s_add_u32 s50, s63, 393216
  buffer_load_dwordx4 v224, s[20:23], s50 offen lds
  s_add_u32 m0, s66, 77824
  s_add_u32 s50, s63, 393216
  buffer_load_dwordx4 v222, s[24:27], s50 offen lds
  s_add_u32 m0, s66, 78848
  s_add_u32 s50, s63, 393216
  buffer_load_dwordx4 v223, s[24:27], s50 offen lds
  s_add_u32 m0, s66, 79872
  s_add_u32 s50, s63, 393216
  buffer_load_dwordx4 v224, s[24:27], s50 offen lds
  buffer_load_dwordx4 v[216:219], v232, s[32:35], 0 offen
  buffer_load_dwordx4 v[216:219], v233, s[32:35], 0 offen
  s_barrier
  s_add_u32 m0, s65, 16384
  s_add_u32 s50, s64, 128
  buffer_load_dwordx4 v220, s[8:11], s50 offen lds
  s_add_u32 m0, s65, 17408
  s_add_u32 s50, s64, 10368
  buffer_load_dwordx4 v221, s[8:11], s50 offen lds
  s_add_u32 m0, s65, 18432
  s_add_u32 s50, s64, 20608
  buffer_load_dwordx4 v220, s[8:11], s50 offen lds
  s_add_u32 m0, s65, 19456
  s_add_u32 s50, s64, 30848
  buffer_load_dwordx4 v221, s[8:11], s50 offen lds
  s_add_u32 m0, s66, 139264
  s_add_u32 s50, s63, 196608
  buffer_load_dwordx4 v222, s[20:23], s50 offen lds
  s_add_u32 m0, s66, 140288
  s_add_u32 s50, s63, 196608
  buffer_load_dwordx4 v223, s[20:23], s50 offen lds
  s_add_u32 m0, s66, 141312
  s_add_u32 s50, s63, 196608
  buffer_load_dwordx4 v224, s[20:23], s50 offen lds
  s_add_u32 m0, s66, 151552
  s_add_u32 s50, s63, 196608
  buffer_load_dwordx4 v222, s[24:27], s50 offen lds
  s_add_u32 m0, s66, 152576
  s_add_u32 s50, s63, 196608
  buffer_load_dwordx4 v223, s[24:27], s50 offen lds
  s_add_u32 m0, s66, 153600
  s_add_u32 s50, s63, 196608
  buffer_load_dwordx4 v224, s[24:27], s50 offen lds
  s_waitcnt vmcnt(24)
  s_barrier
  s_add_u32 m0, s65, 0
  s_add_u32 s50, s64, 0
  buffer_load_dwordx4 v220, s[8:11], s50 offen lds
  s_add_u32 m0, s65, 1024
  s_add_u32 s50, s64, 10240
  buffer_load_dwordx4 v221, s[8:11], s50 offen lds
  s_add_u32 m0, s65, 2048
  s_add_u32 s50, s64, 20480
  buffer_load_dwordx4 v220, s[8:11], s50 offen lds
  s_add_u32 m0, s65, 3072
  s_add_u32 s50, s64, 30720
  buffer_load_dwordx4 v221, s[8:11], s50 offen lds
  s_add_u32 m0, s66, 114688
  s_add_u32 s50, s63, 0
  buffer_load_dwordx4 v222, s[20:23], s50 offen lds
  s_add_u32 m0, s66, 115712
  s_add_u32 s50, s63, 0
  buffer_load_dwordx4 v223, s[20:23], s50 offen lds
  s_add_u32 m0, s66, 116736
  s_add_u32 s50, s63, 0
  buffer_load_dwordx4 v224, s[20:23], s50 offen lds
  s_add_u32 m0, s66, 126976
  s_add_u32 s50, s63, 0
  buffer_load_dwordx4 v222, s[24:27], s50 offen lds
  s_add_u32 m0, s66, 128000
  s_add_u32 s50, s63, 0
  buffer_load_dwordx4 v223, s[24:27], s50 offen lds
  s_add_u32 m0, s66, 129024
  s_add_u32 s50, s63, 0
  buffer_load_dwordx4 v224, s[24:27], s50 offen lds
  s_waitcnt vmcnt(22)
  s_barrier
  s_lshl_b32 s3, s39, 4
  s_add_u32 s3, s3, s43
  s_mul_i32 s3, s3, 3
  s_add_u32 s3, s3, s38
  s_lshl_b32 s71, s38, 12
  s_add_u32 s71, s71, 90112
  s_add_u32 m0, s71, 0
  s_nop 0
  buffer_load_dwordx4 v230, s[32:35], 0 offen lds
  s_add_u32 m0, s71, 1024
  s_nop 0
  buffer_load_dwordx4 v231, s[32:35], 0 offen lds
  s_add_u32 m0, s71, 2048
  s_nop 0
  buffer_load_dwordx4 v232, s[32:35], 0 offen lds
  s_add_u32 m0, s71, 3072
  s_nop 0
  buffer_load_dwordx4 v233, s[32:35], 0 offen lds
  v_lshlrev_b32 v120, 4, v2
  s_lshl_b32 s50, s61, 8
  s_lshl_b32 s51, s38, 5
  s_add_u32 s50, s50, s51
  v_add_u32 v5, s50, v3
  v_lshrrev_b32 v6, 4, v5
  v_mul_u32_u24 v118, 20480, v6
  v_and_b32 v6, 15, v5
  v_lshl_add_u32 v118, v6, 4, v118
  v_lshl_add_u32 v119, v4, 8, v118
  s_lshr_b32 s50, s38, 2
  s_mul_i32 s50, s50, 5120
  s_add_u32 s50, s50, 153600
  v_and_b32 v5, 127, v5
  v_lshl_add_u32 v6, v5, 4, s50
  v_lshl_add_u32 v6, v4, 11, v6
  v_lshl_add_u32 v7, v5, 3, s50
  v_and_b32 v5, 0x13, v3
  v_and_b32 v113, 4, v3
  v_lshl_or_b32 v5, v113, 1, v5
  v_and_b32 v113, 8, v3
  v_lshrrev_b32 v113, 1, v113
  v_or_b32 v5, v5, v113
  v_lshlrev_b32 v104, 4, v5
  v_lshl_add_u32 v104, v4, 11, v104
  v_lshlrev_b32 v105, 3, v5
  v_add_u32 v105, 4096, v105
  v_mul_u32_u24 v106, 320, v4
  v_lshl_add_u32 v106, v3, 4, v106
  v_add_u32 v106, 5120, v106
  v_add_u32 v107, 61440, v104
  v_add_u32 v108, 61440, v105
  v_add_u32 v109, 61440, v106
  v_add_u32 v110, 122880, v104
  v_add_u32 v111, 122880, v105
  v_add_u32 v112, 122880, v106
  v_mov_b32 v12, 0
  v_mov_b32 v13, 0
  v_mov_b32 v14, 0
  v_mov_b32 v15, 0
  v_mov_b32 v56, 0
  v_mov_b32 v57, 0
  v_mov_b32 v58, 0
  v_mov_b32 v59, 0
  v_mov_b32 v60, 0
  v_mov_b32 v61, 0
  v_mov_b32 v62, 0
  v_mov_b32 v63, 0
  v_mov_b32 v64, 0
  v_mov_b32 v65, 0
  v_mov_b32 v66, 0
  v_mov_b32 v67, 0
  v_mov_b32 v68, 0
  v_mov_b32 v69, 0
  v_mov_b32 v70, 0
  v_mov_b32 v71, 0
  v_cmp_eq_u32 vcc, 20, v3
  v_mov_b32 v113, 0x3f803f80
  s_nop 0
  v_cndmask_b32 v114, 0, v113, vcc
  v_mov_b32 v82, 0x3f80
  v_mov_b32 v83, 0
  v_mov_b32 v88, v114
  v_mov_b32 v89, v114
  v_mov_b32 v90, v114
  v_mov_b32 v91, v114
  v_mov_b32 v92, v114
  v_mov_b32 v93, v114
  v_mov_b32 v94, v114
  v_mov_b32 v95, v114
  v_mov_b32 v86, 0x3f80
  v_mov_b32 v87, 0
  v_mov_b32 v96, v114
  v_mov_b32 v97, v114
  v_mov_b32 v98, v114
  v_mov_b32 v99, v114
  v_mov_b32 v100, v114
  v_mov_b32 v101, v114
  v_mov_b32 v102, v114
  v_mov_b32 v103, v114
  v_mov_b32 v48, 0
  v_mov_b32 v49, 0
  v_mov_b32 v50, 0
  v_mov_b32 v51, 0
  v_mov_b32 v52, 0
  v_mov_b32 v53, 0
  v_mov_b32 v54, 0
  v_mov_b32 v55, 0
  v_mov_b32 v124, 0
  v_mov_b32 v125, 0
  v_mov_b32 v126, 0
  v_mov_b32 v127, 0
  v_mov_b32 v128, 0
  v_mov_b32 v129, 0
  v_mov_b32 v130, 0
  v_mov_b32 v131, 0
  v_mov_b32 v132, 0
  v_mov_b32 v133, 0
  v_mov_b32 v134, 0
  v_mov_b32 v135, 0
  v_mov_b32 v136, 0
  v_mov_b32 v137, 0
  v_mov_b32 v138, 0
  v_mov_b32 v139, 0
  v_mov_b32 v140, 0
  v_mov_b32 v141, 0
  v_mov_b32 v142, 0
  v_mov_b32 v143, 0
  v_mov_b32 v144, 0
  v_mov_b32 v145, 0
  v_mov_b32 v146, 0
  v_mov_b32 v147, 0
  v_mov_b32 v148, 0
  v_mov_b32 v149, 0
  v_mov_b32 v150, 0
  v_mov_b32 v151, 0
  v_mov_b32 v152, 0
  v_mov_b32 v153, 0
  v_mov_b32 v154, 0
  v_mov_b32 v155, 0
  v_mov_b32 v156, 0
  v_mov_b32 v157, 0
  v_mov_b32 v158, 0
  v_mov_b32 v159, 0
  v_mov_b32 v160, 0
  v_mov_b32 v161, 0
  v_mov_b32 v162, 0
  v_mov_b32 v163, 0
  s_and_b32 s50, s42, 3
  s_lshl_b32 s51, s61, 2
  s_add_u32 s50, s50, s51
  s_lshl_b32 s54, s50, 1
  s_lshl_b32 s50, s50, 2
  s_lshr_b32 s52, s42, 2
  s_lshl_b32 s52, s52, 2
  s_and_b32 s53, s41, 3
  s_add_u32 s52, s52, s53
  s_mul_i32 s68, s50, 20480
  s_mul_i32 s53, s52, 160
  s_add_u32 s68, s68, s53
  s_and_b32 s53, s38, 1
  s_add_u32 s54, s54, s53
  s_lshl_b32 s53, s53, 1
  s_add_u32 s50, s50, s53
  s_lshr_b32 s53, s38, 1
  s_lshl_b32 s55, s53, 10
  s_mul_i32 s64, s50, 49152
  s_add_u32 s64, s64, s55
  s_add_u32 s64, s64, 14680064
  s_mul_i32 s65, s50, 20480
  s_add_u32 s65, s65, s55
  s_add_u32 s65, s65, 10485760
  s_mul_i32 s66, s53, 40960
  s_mul_i32 s55, s52, 5120
  s_add_u32 s66, s66, s55
  s_add_u32 s66, s66, 25165824
  s_lshr_b32 s55, s54, 2
  s_lshl_b32 s55, s55, 3
  s_and_b32 s54, s54, 3
  s_add_u32 s55, s55, s54
  s_lshl_b32 s55, s55, 11
  s_add_u32 s70, s55, 28450816
  v_and_b32 v5, 15, v2
  v_lshlrev_b32 v121, 7, v5
  s_mul_i32 s55, s52, 5
  s_lshr_b32 s55, s55, 2
  v_lshrrev_b32 v5, 1, v2
  v_mul_u32_u24 v5, 10, v5
  v_and_b32 v122, 1, v2
  v_add3_u32 v122, v122, v5, s55
  v_lshlrev_b32 v122, 7, v122
  s_waitcnt vmcnt(14)
  s_barrier
  s_lshl_b32 s50, s38, 10
  s_add_u32 s50, s50, 0
  s_add_u32 m0, s50, 40960
  s_add_u32 s50, s50, s62
  s_add_u32 s50, s50, 5242880
  buffer_load_dwordx4 v8, s[16:19], s50 offen lds
  s_lshl_b32 s50, s38, 10
  s_add_u32 s50, s50, 4096
  s_add_u32 m0, s50, 40960
  s_add_u32 s50, s50, s62
  s_add_u32 s50, s50, 5242880
  buffer_load_dwordx4 v8, s[16:19], s50 offen lds
  s_lshl_b32 s50, s38, 10
  s_add_u32 s50, s50, 8192
  s_add_u32 m0, s50, 40960
  s_add_u32 s50, s50, s62
  s_add_u32 s50, s50, 5242880
  buffer_load_dwordx4 v8, s[16:19], s50 offen lds
  s_lshl_b32 s50, s38, 10
  s_add_u32 s50, s50, 12288
  s_add_u32 m0, s50, 40960
  s_add_u32 s50, s50, s62
  s_add_u32 s50, s50, 5242880
  buffer_load_dwordx4 v8, s[16:19], s50 offen lds
  s_lshl_b32 s50, s38, 10
  s_add_u32 s50, s50, 16384
  s_add_u32 m0, s50, 40960
  s_add_u32 s50, s50, s62
  s_add_u32 s50, s50, 5242880
  buffer_load_dwordx4 v8, s[16:19], s50 offen lds
  s_lshl_b32 s50, s38, 10
  s_add_u32 s50, s50, 20480
  s_add_u32 m0, s50, 40960
  s_add_u32 s50, s50, s62
  s_add_u32 s50, s50, 5242880
  buffer_load_dwordx4 v8, s[16:19], s50 offen lds
  s_lshl_b32 s50, s38, 10
  s_add_u32 s50, s50, 24576
  s_add_u32 m0, s50, 40960
  s_add_u32 s50, s50, s62
  s_add_u32 s50, s50, 5242880
  buffer_load_dwordx4 v8, s[16:19], s50 offen lds
  s_lshl_b32 s50, s38, 10
  s_add_u32 s50, s50, 28672
  s_add_u32 m0, s50, 40960
  s_add_u32 s50, s50, s62
  s_add_u32 s50, s50, 5242880
  buffer_load_dwordx4 v8, s[16:19], s50 offen lds
  s_lshl_b32 s50, s38, 10
  s_add_u32 s50, s50, 32768
  s_add_u32 m0, s50, 40960
  s_add_u32 s50, s50, s62
  s_add_u32 s50, s50, 5242880
  buffer_load_dwordx4 v8, s[16:19], s50 offen lds
  s_lshl_b32 s50, s38, 10
  s_add_u32 s50, s50, 36864
  s_add_u32 m0, s50, 40960
  s_add_u32 s50, s50, s62
  s_add_u32 s50, s50, 5242880
  buffer_load_dwordx4 v8, s[16:19], s50 offen lds
  s_waitcnt vmcnt(14)
  s_barrier
  s_add_u32 s50, s38, 0
  s_min_u32 s50, s50, 9
  s_lshl_b32 s51, s50, 10
  s_add_u32 m0, s51, 153600
  s_cmp_ge_u32 s50, 5
  s_cselect_b32 s50, 5120, 0
  s_add_u32 s50, s50, s51
  s_mul_i32 s51, s61, 20480
  s_add_u32 s50, s50, s51
  s_add_u32 s50, s50, s62
  s_add_u32 s50, s50, 0
  buffer_load_dwordx4 v8, s[16:19], s50 offen lds
  s_add_u32 s50, s38, 4
  s_min_u32 s50, s50, 9
  s_lshl_b32 s51, s50, 10
  s_add_u32 m0, s51, 153600
  s_cmp_ge_u32 s50, 5
  s_cselect_b32 s50, 5120, 0
  s_add_u32 s50, s50, s51
  s_mul_i32 s51, s61, 20480
  s_add_u32 s50, s50, s51
  s_add_u32 s50, s50, s62
  s_add_u32 s50, s50, 0
  buffer_load_dwordx4 v8, s[16:19], s50 offen lds
  s_add_u32 s50, s38, 8
  s_min_u32 s50, s50, 9
  s_lshl_b32 s51, s50, 10
  s_add_u32 m0, s51, 153600
  s_cmp_ge_u32 s50, 5
  s_cselect_b32 s50, 5120, 0
  s_add_u32 s50, s50, s51
  s_mul_i32 s51, s61, 20480
  s_add_u32 s50, s50, s51
  s_add_u32 s50, s50, s62
  s_add_u32 s50, s50, 0
  buffer_load_dwordx4 v8, s[16:19], s50 offen lds
  s_lshl_b32 s51, s3, 12
  s_add_u32 s51, s51, 25165824
  s_cmp_eq_u32 s38, 3
  s_cselect_b32 s51, 29360128, s51
  s_cmp_ge_u32 s3, 680
  s_cselect_b32 s51, 29360128, s51
  s_waitcnt vmcnt(13)
  ds_read_b64_tr_b16 v[16:17], v234 offset:0
  ds_read_b64_tr_b16 v[18:19], v234 offset:512
  ds_read_b64_tr_b16 v[20:21], v234 offset:32
  ds_read_b64_tr_b16 v[22:23], v234 offset:544
  ds_read_b64_tr_b16 v[24:25], v234 offset:64
  ds_read_b64_tr_b16 v[26:27], v234 offset:576
  ds_read_b64_tr_b16 v[28:29], v234 offset:96
  ds_read_b64_tr_b16 v[30:31], v234 offset:608
  s_waitcnt lgkmcnt(0)
  buffer_store_dwordx4 v[16:19], v8, s[16:19], s51 offen offset:0 sc1
  buffer_store_dwordx4 v[20:23], v8, s[16:19], s51 offen offset:1024 sc1
  buffer_store_dwordx4 v[24:27], v8, s[16:19], s51 offen offset:2048 sc1
  buffer_store_dwordx4 v[28:31], v8, s[16:19], s51 offen offset:3072 sc1
  s_lshl_b32 s67, s3, 7
  s_add_u32 s67, s67, 28704768
  s_cmp_eq_u32 s38, 3
  s_cselect_b32 s67, 29360128, s67
  s_waitcnt vmcnt(4)
  s_barrier
  s_branch L_p3_go
L_B:
  s_add_u32 s69, s69, s3
  s_add_u32 s69, s69, s3
  s_add_u32 s70, s70, s3
  s_add_u32 s70, s70, s3
  s_add_u32 s71, s71, s3
  s_add_u32 s71, s71, s3
  v_lshrrev_b32 v9, 4, v2
  v_mul_u32_u24 v7, 3840, v9
  v_lshrrev_b32 v10, 2, v2
  v_and_b32 v10, 3, v10
  v_xor_b32 v10, v10, v9
  v_lshl_add_u32 v7, v10, 6, v7
  v_and_b32 v10, 3, v2
  v_lshl_add_u32 v7, v10, 4, v7
  s_mul_i32 s68, s59, 61440
  s_lshl_b32 s50, s40, 8
  s_add_u32 s68, s68, s50
  v_lshrrev_b32 v9, 1, v3
  v_and_b32 v9, 7, v9
  v_lshl_add_u32 v10, v3, 7, s65
  v_or_b32 v11, 0, v4
  v_xor_b32 v11, v11, v9
  v_lshl_add_u32 v184, v11, 4, v10
  v_or_b32 v11, 2, v4
  v_xor_b32 v11, v11, v9
  v_lshl_add_u32 v185, v11, 4, v10
  v_or_b32 v11, 4, v4
  v_xor_b32 v11, v11, v9
  v_lshl_add_u32 v186, v11, 4, v10
  v_or_b32 v11, 6, v4
  v_xor_b32 v11, v11, v9
  v_lshl_add_u32 v187, v11, 4, v10
  v_lshlrev_b32 v11, 2, v4
  v_xor_b32 v9, v9, v11
  v_xor_b32 v11, 0, v9
  v_lshl_add_u32 v12, v11, 4, v10
  v_xor_b32 v11, 1, v9
  v_lshl_add_u32 v13, v11, 4, v10
  v_xor_b32 v11, 2, v9
  v_lshl_add_u32 v14, v11, 4, v10
  v_xor_b32 v11, 3, v9
  v_lshl_add_u32 v15, v11, 4, v10
  v_mov_b32 v36, 0
  v_mov_b32 v37, 0
  v_add_u32 v10, 0, v2
  v_mul_u32_u24 v11, 5462, v10
  v_lshrrev_b32 v11, 16, v11
  v_mul_u32_u24 v9, 12, v11
  v_sub_u32 v9, v10, v9
  v_mul_u32_u24 v11, 3072, v11
  v_lshl_add_u32 v222, v9, 4, v11
  v_add_u32 v10, 64, v2
  v_mul_u32_u24 v11, 5462, v10
  v_lshrrev_b32 v11, 16, v11
  v_mul_u32_u24 v9, 12, v11
  v_sub_u32 v9, v10, v9
  v_mul_u32_u24 v11, 3072, v11
  v_lshl_add_u32 v223, v9, 4, v11
  v_add_u32 v10, 128, v2
  v_mul_u32_u24 v11, 5462, v10
  v_lshrrev_b32 v11, 16, v11
  v_mul_u32_u24 v9, 12, v11
  v_sub_u32 v9, v10, v9
  v_mul_u32_u24 v11, 3072, v11
  v_lshl_add_u32 v224, v9, 4, v11
  v_lshrrev_b32 v9, 4, v2
  v_and_b32 v9, 1, v9
  v_and_b32 v10, 15, v2
  v_cmp_eq_u32 vcc, v10, v9
  v_mov_b32 v10, 0x3f803f80
  s_nop 0
  v_cndmask_b32 v168, 0, v10, vcc
  v_cndmask_b32 v169, 0, v10, vcc
  v_cndmask_b32 v170, 0, v10, vcc
  v_cndmask_b32 v171, 0, v10, vcc
  v_lshrrev_b32 v5, 2, v2
  v_and_b32 v5, 3, v5
  v_lshl_add_u32 v5, v4, 3, v5
  v_mul_u32_u24 v5, 192, v5
  v_lshrrev_b32 v6, 4, v2
  v_and_b32 v6, 1, v6
  v_lshl_add_u32 v5, v6, 5, v5
  v_and_b32 v6, 3, v2
  v_lshl_add_u32 v5, v6, 3, v5
  s_add_u32 s60, s59, 0
  s_cmp_ge_u32 s60, 3
  s_cselect_b32 s50, 3, 0
  s_sub_u32 s60, s60, s50
  s_cmp_ge_u32 s60, 3
  s_cselect_b32 s50, 3, 0
  s_sub_u32 s60, s60, s50
  s_lshl_b32 s50, s60, 6
  s_add_u32 s50, s50, 65536
  v_add_u32 v200, s50, v5
  v_add_u32 v203, 49152, v200
  s_add_u32 s61, s59, 1
  s_cmp_ge_u32 s61, 3
  s_cselect_b32 s50, 3, 0
  s_sub_u32 s61, s61, s50
  s_cmp_ge_u32 s61, 3
  s_cselect_b32 s50, 3, 0
  s_sub_u32 s61, s61, s50
  s_lshl_b32 s50, s61, 6
  s_add_u32 s50, s50, 65536
  v_add_u32 v201, s50, v5
  v_add_u32 v204, 49152, v201
  s_add_u32 s62, s59, 2
  s_cmp_ge_u32 s62, 3
  s_cselect_b32 s50, 3, 0
  s_sub_u32 s62, s62, s50
  s_cmp_ge_u32 s62, 3
  s_cselect_b32 s50, 3, 0
  s_sub_u32 s62, s62, s50
  s_lshl_b32 s50, s62, 6
  s_add_u32 s50, s50, 65536
  v_add_u32 v202, s50, v5
  v_add_u32 v205, 49152, v202
  v_mov_b32 v64, 0
  v_mov_b32 v65, 0
  v_mov_b32 v66, 0
  v_mov_b32 v67, 0
  v_mov_b32 v68, 0
  v_mov_b32 v69, 0
  v_mov_b32 v70, 0
  v_mov_b32 v71, 0
  v_mov_b32 v72, 0
  v_mov_b32 v73, 0
  v_mov_b32 v74, 0
  v_mov_b32 v75, 0
  v_mov_b32 v76, 0
  v_mov_b32 v77, 0
  v_mov_b32 v78, 0
  v_mov_b32 v79, 0
  v_mov_b32 v80, 0
  v_mov_b32 v81, 0
  v_mov_b32 v82, 0
  v_mov_b32 v83, 0
  v_mov_b32 v84, 0
  v_mov_b32 v85, 0
  v_mov_b32 v86, 0
  v_mov_b32 v87, 0
  v_mov_b32 v88, 0
  v_mov_b32 v89, 0
  v_mov_b32 v90, 0
  v_mov_b32 v91, 0
  v_mov_b32 v92, 0
  v_mov_b32 v93, 0
  v_mov_b32 v94, 0
  v_mov_b32 v95, 0
  v_mov_b32 v96, 0
  v_mov_b32 v97, 0
  v_mov_b32 v98, 0
  v_mov_b32 v99, 0
  v_mov_b32 v100, 0
  v_mov_b32 v101, 0
  v_mov_b32 v102, 0
  v_mov_b32 v103, 0
  v_mov_b32 v104, 0
  v_mov_b32 v105, 0
  v_mov_b32 v106, 0
  v_mov_b32 v107, 0
  v_mov_b32 v108, 0
  v_mov_b32 v109, 0
  v_mov_b32 v110, 0
  v_mov_b32 v111, 0
  v_mov_b32 v112, 0
  v_mov_b32 v113, 0
  v_mov_b32 v114, 0
  v_mov_b32 v115, 0
  v_mov_b32 v116, 0
  v_mov_b32 v117, 0
  v_mov_b32 v118, 0
  v_mov_b32 v119, 0
  v_mov_b32 v120, 0
  v_mov_b32 v121, 0
  v_mov_b32 v122, 0
  v_mov_b32 v123, 0
  v_mov_b32 v124, 0
  v_mov_b32 v125, 0
  v_mov_b32 v126, 0
  v_mov_b32 v127, 0
  v_mov_b32 v128, 0
  v_mov_b32 v129, 0
  v_mov_b32 v130, 0
  v_mov_b32 v131, 0
  v_mov_b32 v132, 0
  v_mov_b32 v133, 0
  v_mov_b32 v134, 0
  v_mov_b32 v135, 0
  v_mov_b32 v136, 0
  v_mov_b32 v137, 0
  v_mov_b32 v138, 0
  v_mov_b32 v139, 0
  v_mov_b32 v140, 0
  v_mov_b32 v141, 0
  v_mov_b32 v142, 0
  v_mov_b32 v143, 0
  v_mov_b32 v144, 0
  v_mov_b32 v145, 0
  v_mov_b32 v146, 0
  v_mov_b32 v147, 0
  v_mov_b32 v148, 0
  v_mov_b32 v149, 0
  v_mov_b32 v150, 0
  v_mov_b32 v151, 0
  v_mov_b32 v152, 0
  v_mov_b32 v153, 0
  v_mov_b32 v154, 0
  v_mov_b32 v155, 0
  v_mov_b32 v156, 0
  v_mov_b32 v157, 0
  v_mov_b32 v158, 0
  v_mov_b32 v159, 0
  v_mov_b32 v160, 0
  v_mov_b32 v161, 0
  v_mov_b32 v162, 0
  v_mov_b32 v163, 0
  v_mov_b32 v164, 0
  v_mov_b32 v165, 0
  v_mov_b32 v166, 0
  v_mov_b32 v167, 0
  v_lshlrev_b32 v229, 7, v2
  s_waitcnt vmcnt(0)
  s_add_u32 m0, s65, 0
  s_add_u32 s50, s64, 0
  buffer_load_dwordx4 v220, s[8:11], s50 offen lds
  s_add_u32 m0, s65, 65536
  s_add_u32 s50, s68, 0
  buffer_load_dwordx4 v7, s[12:15], s50 offen lds
  s_add_u32 m0, s65, 1024
  s_add_u32 s50, s64, 10240
  buffer_load_dwordx4 v221, s[8:11], s50 offen lds
  s_add_u32 m0, s65, 66560
  s_add_u32 s50, s68, 15360
  buffer_load_dwordx4 v7, s[12:15], s50 offen lds
  s_add_u32 m0, s65, 2048
  s_add_u32 s50, s64, 20480
  buffer_load_dwordx4 v220, s[8:11], s50 offen lds
  s_add_u32 m0, s65, 67584
  s_add_u32 s50, s68, 30720
  buffer_load_dwordx4 v7, s[12:15], s50 offen lds
  s_add_u32 m0, s65, 3072
  s_add_u32 s50, s64, 30720
  buffer_load_dwordx4 v221, s[8:11], s50 offen lds
  s_add_u32 m0, s65, 68608
  s_add_u32 s50, s68, 46080
  buffer_load_dwordx4 v7, s[12:15], s50 offen lds
  s_add_u32 m0, s65, 16384
  s_add_u32 s50, s64, 128
  buffer_load_dwordx4 v220, s[8:11], s50 offen lds
  s_add_u32 m0, s65, 81920
  s_add_u32 s50, s68, 245760
  buffer_load_dwordx4 v7, s[12:15], s50 offen lds
  s_add_u32 m0, s65, 17408
  s_add_u32 s50, s64, 10368
  buffer_load_dwordx4 v221, s[8:11], s50 offen lds
  s_add_u32 m0, s65, 82944
  s_add_u32 s50, s68, 261120
  buffer_load_dwordx4 v7, s[12:15], s50 offen lds
  s_add_u32 m0, s65, 18432
  s_add_u32 s50, s64, 20608
  buffer_load_dwordx4 v220, s[8:11], s50 offen lds
  s_add_u32 m0, s65, 83968
  s_add_u32 s50, s68, 276480
  buffer_load_dwordx4 v7, s[12:15], s50 offen lds
  s_add_u32 m0, s65, 19456
  s_add_u32 s50, s64, 30848
  buffer_load_dwordx4 v221, s[8:11], s50 offen lds
  s_add_u32 m0, s65, 84992
  s_add_u32 s50, s68, 291840
  buffer_load_dwordx4 v7, s[12:15], s50 offen lds
  s_waitcnt vmcnt(8)
  s_barrier
  ds_read_b128 v[20:23], v12 offset:0
  ds_read_b128 v[24:27], v13 offset:0
  ds_read_b128 v[28:31], v14 offset:0
  ds_read_b128 v[32:35], v15 offset:0
  s_add_u32 m0, s65, 32768
  s_add_u32 s50, s64, 256
  buffer_load_dwordx4 v220, s[8:11], s50 offen lds
  s_add_u32 m0, s65, 98304
  s_add_u32 s50, s68, 491520
  buffer_load_dwordx4 v7, s[12:15], s50 offen lds
  s_waitcnt lgkmcnt(3)
  v_lshlrev_b32 v40, 16, v20
  v_and_b32 v41, 0xffff0000, v20
  v_fmac_f32 v36, v40, v40
  v_fmac_f32 v37, v41, v41
  s_add_u32 m0, s65, 33792
  s_add_u32 s50, s64, 10496
  buffer_load_dwordx4 v221, s[8:11], s50 offen lds
  v_lshlrev_b32 v42, 16, v21
  v_and_b32 v43, 0xffff0000, v21
  v_fmac_f32 v36, v42, v42
  v_fmac_f32 v37, v43, v43
  v_lshlrev_b32 v40, 16, v22
  s_add_u32 m0, s65, 99328
  s_add_u32 s50, s68, 506880
  buffer_load_dwordx4 v7, s[12:15], s50 offen lds
  v_and_b32 v41, 0xffff0000, v22
  v_fmac_f32 v36, v40, v40
  v_fmac_f32 v37, v41, v41
  v_lshlrev_b32 v42, 16, v23
  v_and_b32 v43, 0xffff0000, v23
  s_add_u32 m0, s65, 34816
  s_add_u32 s50, s64, 20736
  buffer_load_dwordx4 v220, s[8:11], s50 offen lds
  v_fmac_f32 v36, v42, v42
  v_fmac_f32 v37, v43, v43
  s_waitcnt lgkmcnt(2)
  v_lshlrev_b32 v40, 16, v24
  v_and_b32 v41, 0xffff0000, v24
  s_add_u32 m0, s65, 100352
  s_add_u32 s50, s68, 522240
  buffer_load_dwordx4 v7, s[12:15], s50 offen lds
  v_fmac_f32 v36, v40, v40
  v_fmac_f32 v37, v41, v41
  v_lshlrev_b32 v42, 16, v25
  v_and_b32 v43, 0xffff0000, v25
  v_fmac_f32 v36, v42, v42
  s_add_u32 m0, s65, 35840
  s_add_u32 s50, s64, 30976
  buffer_load_dwordx4 v221, s[8:11], s50 offen lds
  v_fmac_f32 v37, v43, v43
  v_lshlrev_b32 v40, 16, v26
  v_and_b32 v41, 0xffff0000, v26
  v_fmac_f32 v36, v40, v40
  v_fmac_f32 v37, v41, v41
  s_add_u32 m0, s65, 101376
  s_add_u32 s50, s68, 537600
  buffer_load_dwordx4 v7, s[12:15], s50 offen lds
  v_lshlrev_b32 v42, 16, v27
  v_and_b32 v43, 0xffff0000, v27
  v_fmac_f32 v36, v42, v42
  v_fmac_f32 v37, v43, v43
  s_waitcnt lgkmcnt(1)
  s_add_u32 m0, s65, 49152
  s_add_u32 s50, s64, 384
  buffer_load_dwordx4 v220, s[8:11], s50 offen lds
  v_lshlrev_b32 v40, 16, v28
  v_and_b32 v41, 0xffff0000, v28
  v_fmac_f32 v36, v40, v40
  v_fmac_f32 v37, v41, v41
  v_lshlrev_b32 v42, 16, v29
  s_add_u32 m0, s65, 114688
  s_add_u32 s50, s68, 737280
  buffer_load_dwordx4 v7, s[12:15], s50 offen lds
  v_and_b32 v43, 0xffff0000, v29
  v_fmac_f32 v36, v42, v42
  v_fmac_f32 v37, v43, v43
  v_lshlrev_b32 v40, 16, v30
  v_and_b32 v41, 0xffff0000, v30
  s_add_u32 m0, s65, 50176
  s_add_u32 s50, s64, 10624
  buffer_load_dwordx4 v221, s[8:11], s50 offen lds
  v_fmac_f32 v36, v40, v40
  v_fmac_f32 v37, v41, v41
  v_lshlrev_b32 v42, 16, v31
  v_and_b32 v43, 0xffff0000, v31
  v_fmac_f32 v36, v42, v42
  s_add_u32 m0, s65, 115712
  s_add_u32 s50, s68, 752640
  buffer_load_dwordx4 v7, s[12:15], s50 offen lds
  v_fmac_f32 v37, v43, v43
  s_waitcnt lgkmcnt(0)
  v_lshlrev_b32 v40, 16, v32
  v_and_b32 v41, 0xffff0000, v32
  v_fmac_f32 v36, v40, v40
  s_add_u32 m0, s65, 51200
  s_add_u32 s50, s64, 20864
  buffer_load_dwordx4 v220, s[8:11], s50 offen lds
  v_fmac_f32 v37, v41, v41
  v_lshlrev_b32 v42, 16, v33
  v_and_b32 v43, 0xffff0000, v33
  v_fmac_f32 v36, v42, v42
  v_fmac_f32 v37, v43, v43
  s_add_u32 m0, s65, 116736
  s_add_u32 s50, s68, 768000
  buffer_load_dwordx4 v7, s[12:15], s50 offen lds
  v_lshlrev_b32 v40, 16, v34
  v_and_b32 v41, 0xffff0000, v34
  v_fmac_f32 v36, v40, v40
  v_fmac_f32 v37, v41, v41
  v_lshlrev_b32 v42, 16, v35
  s_add_u32 m0, s65, 52224
  s_add_u32 s50, s64, 31104
  buffer_load_dwordx4 v221, s[8:11], s50 offen lds
  v_and_b32 v43, 0xffff0000, v35
  v_fmac_f32 v36, v42, v42
  v_fmac_f32 v37, v43, v43
  s_add_u32 m0, s65, 117760
  s_add_u32 s50, s68, 783360
  buffer_load_dwordx4 v7, s[12:15], s50 offen lds
  s_waitcnt vmcnt(16)
  s_barrier
  ds_read_b128 v[20:23], v12 offset:16384
  ds_read_b128 v[24:27], v13 offset:16384
  ds_read_b128 v[28:31], v14 offset:16384
  ds_read_b128 v[32:35], v15 offset:16384
  s_add_u32 m0, s65, 0
  s_add_u32 s50, s64, 512
  buffer_load_dwordx4 v220, s[8:11], s50 offen lds
  s_add_u32 m0, s65, 65536
  s_add_u32 s50, s68, 983040
  buffer_load_dwordx4 v7, s[12:15], s50 offen lds
  s_waitcnt lgkmcnt(3)
  v_lshlrev_b32 v40, 16, v20
  v_and_b32 v41, 0xffff0000, v20
  v_fmac_f32 v36, v40, v40
  v_fmac_f32 v37, v41, v41
  v_lshlrev_b32 v42, 16, v21
  v_and_b32 v43, 0xffff0000, v21
  v_fmac_f32 v36, v42, v42
  v_fmac_f32 v37, v43, v43
  v_lshlrev_b32 v40, 16, v22
  s_add_u32 m0, s65, 1024
  s_add_u32 s50, s64, 10752
  buffer_load_dwordx4 v221, s[8:11], s50 offen lds
  v_and_b32 v41, 0xffff0000, v22
  v_fmac_f32 v36, v40, v40
  v_fmac_f32 v37, v41, v41
  v_lshlrev_b32 v42, 16, v23
  v_and_b32 v43, 0xffff0000, v23
  v_fmac_f32 v36, v42, v42
  v_fmac_f32 v37, v43, v43
  s_waitcnt lgkmcnt(2)
  v_lshlrev_b32 v40, 16, v24
  v_and_b32 v41, 0xffff0000, v24
  s_add_u32 m0, s65, 66560
  s_add_u32 s50, s68, 998400
  buffer_load_dwordx4 v7, s[12:15], s50 offen lds
  v_fmac_f32 v36, v40, v40
  v_fmac_f32 v37, v41, v41
  v_lshlrev_b32 v42, 16, v25
  v_and_b32 v43, 0xffff0000, v25
  v_fmac_f32 v36, v42, v42
  v_fmac_f32 v37, v43, v43
  v_lshlrev_b32 v40, 16, v26
  v_and_b32 v41, 0xffff0000, v26
  v_fmac_f32 v36, v40, v40
  v_fmac_f32 v37, v41, v41
  s_add_u32 m0, s65, 2048
  s_add_u32 s50, s64, 20992
  buffer_load_dwordx4 v220, s[8:11], s50 offen lds
  v_lshlrev_b32 v42, 16, v27
  v_and_b32 v43, 0xffff0000, v27
  v_fmac_f32 v36, v42, v42
  v_fmac_f32 v37, v43, v43
  s_waitcnt lgkmcnt(1)
  v_lshlrev_b32 v40, 16, v28
  v_and_b32 v41, 0xffff0000, v28
  v_fmac_f32 v36, v40, v40
  v_fmac_f32 v37, v41, v41
  v_lshlrev_b32 v42, 16, v29
  s_add_u32 m0, s65, 67584
  s_add_u32 s50, s68, 1013760
  buffer_load_dwordx4 v7, s[12:15], s50 offen lds
  v_and_b32 v43, 0xffff0000, v29
  v_fmac_f32 v36, v42, v42
  v_fmac_f32 v37, v43, v43
  v_lshlrev_b32 v40, 16, v30
  v_and_b32 v41, 0xffff0000, v30
  v_fmac_f32 v36, v40, v40
  v_fmac_f32 v37, v41, v41
  v_lshlrev_b32 v42, 16, v31
  v_and_b32 v43, 0xffff0000, v31
  v_fmac_f32 v36, v42, v42
  s_add_u32 m0, s65, 3072
  s_add_u32 s50, s64, 31232
  buffer_load_dwordx4 v221, s[8:11], s50 offen lds
  v_fmac_f32 v37, v43, v43
  s_waitcnt lgkmcnt(0)
  v_lshlrev_b32 v40, 16, v32
  v_and_b32 v41, 0xffff0000, v32
  v_fmac_f32 v36, v40, v40
  v_fmac_f32 v37, v41, v41
  v_lshlrev_b32 v42, 16, v33
  v_and_b32 v43, 0xffff0000, v33
  v_fmac_f32 v36, v42, v42
  v_fmac_f32 v37, v43, v43
  s_add_u32 m0, s65, 68608
  s_add_u32 s50, s68, 1029120
  buffer_load_dwordx4 v7, s[12:15], s50 offen lds
  v_lshlrev_b32 v40, 16, v34
  v_and_b32 v41, 0xffff0000, v34
  v_fmac_f32 v36, v40, v40
  v_fmac_f32 v37, v41, v41
  v_lshlrev_b32 v42, 16, v35
  v_and_b32 v43, 0xffff0000, v35
  v_fmac_f32 v36, v42, v42
  v_fmac_f32 v37, v43, v43
  s_waitcnt vmcnt(16)
  s_barrier
  ds_read_b128 v[20:23], v12 offset:32768
  ds_read_b128 v[24:27], v13 offset:32768
  ds_read_b128 v[28:31], v14 offset:32768
  ds_read_b128 v[32:35], v15 offset:32768
  s_add_u32 m0, s65, 16384
  s_add_u32 s50, s64, 640
  buffer_load_dwordx4 v220, s[8:11], s50 offen lds
  s_add_u32 m0, s65, 81920
  s_add_u32 s50, s68, 1228800
  buffer_load_dwordx4 v7, s[12:15], s50 offen lds
  s_waitcnt lgkmcnt(3)
  v_lshlrev_b32 v40, 16, v20
  v_and_b32 v41, 0xffff0000, v20
  v_fmac_f32 v36, v40, v40
  v_fmac_f32 v37, v41, v41
  v_lshlrev_b32 v42, 16, v21
  s_add_u32 m0, s65, 17408
  s_add_u32 s50, s64, 10880
  buffer_load_dwordx4 v221, s[8:11], s50 offen lds
  v_and_b32 v43, 0xffff0000, v21
  v_fmac_f32 v36, v42, v42
  v_fmac_f32 v37, v43, v43
  v_lshlrev_b32 v40, 16, v22
  v_and_b32 v41, 0xffff0000, v22
  v_fmac_f32 v36, v40, v40
  s_add_u32 m0, s65, 82944
  s_add_u32 s50, s68, 1244160
  buffer_load_dwordx4 v7, s[12:15], s50 offen lds
  v_fmac_f32 v37, v41, v41
  v_lshlrev_b32 v42, 16, v23
  v_and_b32 v43, 0xffff0000, v23
  v_fmac_f32 v36, v42, v42
  v_fmac_f32 v37, v43, v43
  s_waitcnt lgkmcnt(2)
  s_add_u32 m0, s65, 18432
  s_add_u32 s50, s64, 21120
  buffer_load_dwordx4 v220, s[8:11], s50 offen lds
  v_lshlrev_b32 v40, 16, v24
  v_and_b32 v41, 0xffff0000, v24
  v_fmac_f32 v36, v40, v40
  v_fmac_f32 v37, v41, v41
  v_lshlrev_b32 v42, 16, v25
  v_and_b32 v43, 0xffff0000, v25
  s_add_u32 m0, s65, 83968
  s_add_u32 s50, s68, 1259520
  buffer_load_dwordx4 v7, s[12:15], s50 offen lds
  v_fmac_f32 v36, v42, v42
  v_fmac_f32 v37, v43, v43
  v_lshlrev_b32 v40, 16, v26
  v_and_b32 v41, 0xffff0000, v26
  v_fmac_f32 v36, v40, v40
  v_fmac_f32 v37, v41, v41
  s_add_u32 m0, s65, 19456
  s_add_u32 s50, s64, 31360
  buffer_load_dwordx4 v221, s[8:11], s50 offen lds
  v_lshlrev_b32 v42, 16, v27
  v_and_b32 v43, 0xffff0000, v27
  v_fmac_f32 v36, v42, v42
  v_fmac_f32 v37, v43, v43
  s_waitcnt lgkmcnt(1)
  v_lshlrev_b32 v40, 16, v28
  s_add_u32 m0, s65, 84992
  s_add_u32 s50, s68, 1274880
  buffer_load_dwordx4 v7, s[12:15], s50 offen lds
  v_and_b32 v41, 0xffff0000, v28
  v_fmac_f32 v36, v40, v40
  v_fmac_f32 v37, v41, v41
  v_lshlrev_b32 v42, 16, v29
  v_and_b32 v43, 0xffff0000, v29
  v_fmac_f32 v36, v42, v42
  buffer_load_dwordx4 v[216:219], v214, s[4:7], s69 offen
  v_fmac_f32 v37, v43, v43
  v_lshlrev_b32 v40, 16, v30
  v_and_b32 v41, 0xffff0000, v30
  v_fmac_f32 v36, v40, v40
  v_fmac_f32 v37, v41, v41
  v_lshlrev_b32 v42, 16, v31
  s_add_u32 s69, s69, s3
  buffer_load_dwordx4 v[216:219], v214, s[4:7], s70 offen
  v_and_b32 v43, 0xffff0000, v31
  v_fmac_f32 v36, v42, v42
  v_fmac_f32 v37, v43, v43
  s_waitcnt lgkmcnt(0)
  v_lshlrev_b32 v40, 16, v32
  v_and_b32 v41, 0xffff0000, v32
  s_add_u32 s70, s70, s3
  buffer_load_dwordx4 v[216:219], v214, s[4:7], s71 offen
  v_fmac_f32 v36, v40, v40
  v_fmac_f32 v37, v41, v41
  v_lshlrev_b32 v42, 16, v33
  v_and_b32 v43, 0xffff0000, v33
  v_fmac_f32 v36, v42, v42
  v_fmac_f32 v37, v43, v43
  s_add_u32 s71, s71, s3
  buffer_load_dwordx4 v[216:219], v214, s[4:7], s69 offen
  v_lshlrev_b32 v40, 16, v34
  v_and_b32 v41, 0xffff0000, v34
  v_fmac_f32 v36, v40, v40
  v_fmac_f32 v37, v41, v41
  v_lshlrev_b32 v42, 16, v35
  v_and_b32 v43, 0xffff0000, v35
  buffer_load_dwordx4 v[216:219], v214, s[4:7], s70 offen
  v_fmac_f32 v36, v42, v42
  v_fmac_f32 v37, v43, v43
  buffer_load_dwordx4 v[216:219], v214, s[4:7], s71 offen
  s_waitcnt vmcnt(22)
  s_barrier
  ds_read_b128 v[20:23], v12 offset:49152
  ds_read_b128 v[24:27], v13 offset:49152
  ds_read_b128 v[28:31], v14 offset:49152
  ds_read_b128 v[32:35], v15 offset:49152
  s_add_u32 m0, s65, 32768
  s_add_u32 s50, s64, 768
  buffer_load_dwordx4 v220, s[8:11], s50 offen lds
  s_add_u32 m0, s65, 98304
  s_add_u32 s50, s68, 1474560
  buffer_load_dwordx4 v7, s[12:15], s50 offen lds
  s_waitcnt lgkmcnt(3)
  v_lshlrev_b32 v40, 16, v20
  v_and_b32 v41, 0xffff0000, v20
  v_fmac_f32 v36, v40, v40
  v_fmac_f32 v37, v41, v41
  v_lshlrev_b32 v42, 16, v21
  v_and_b32 v43, 0xffff0000, v21
  v_fmac_f32 v36, v42, v42
  v_fmac_f32 v37, v43, v43
  v_lshlrev_b32 v40, 16, v22
  s_add_u32 m0, s65, 33792
  s_add_u32 s50, s64, 11008
  buffer_load_dwordx4 v221, s[8:11], s50 offen lds
  v_and_b32 v41, 0xffff0000, v22
  v_fmac_f32 v36, v40, v40
  v_fmac_f32 v37, v41, v41
  v_lshlrev_b32 v42, 16, v23
  v_and_b32 v43, 0xffff0000, v23
  v_fmac_f32 v36, v42, v42
  v_fmac_f32 v37, v43, v43
  s_waitcnt lgkmcnt(2)
  v_lshlrev_b32 v40, 16, v24
  v_and_b32 v41, 0xffff0000, v24
  s_add_u32 m0, s65, 99328
  s_add_u32 s50, s68, 1489920
  buffer_load_dwordx4 v7, s[12:15], s50 offen lds
  v_fmac_f32 v36, v40, v40
  v_fmac_f32 v37, v41, v41
  v_lshlrev_b32 v42, 16, v25
  v_and_b32 v43, 0xffff0000, v25
  v_fmac_f32 v36, v42, v42
  v_fmac_f32 v37, v43, v43
  v_lshlrev_b32 v40, 16, v26
  v_and_b32 v41, 0xffff0000, v26
  v_fmac_f32 v36, v40, v40
  v_fmac_f32 v37, v41, v41
  s_add_u32 m0, s65, 34816
  s_add_u32 s50, s64, 21248
  buffer_load_dwordx4 v220, s[8:11], s50 offen lds
  v_lshlrev_b32 v42, 16, v27
  v_and_b32 v43, 0xffff0000, v27
  v_fmac_f32 v36, v42, v42
  v_fmac_f32 v37, v43, v43
  s_waitcnt lgkmcnt(1)
  v_lshlrev_b32 v40, 16, v28
  v_and_b32 v41, 0xffff0000, v28
  v_fmac_f32 v36, v40, v40
  v_fmac_f32 v37, v41, v41
  v_lshlrev_b32 v42, 16, v29
  s_add_u32 m0, s65, 100352
  s_add_u32 s50, s68, 1505280
  buffer_load_dwordx4 v7, s[12:15], s50 offen lds
  v_and_b32 v43, 0xffff0000, v29
  v_fmac_f32 v36, v42, v42
  v_fmac_f32 v37, v43, v43
  v_lshlrev_b32 v40, 16, v30
  v_and_b32 v41, 0xffff0000, v30
  v_fmac_f32 v36, v40, v40
  v_fmac_f32 v37, v41, v41
  v_lshlrev_b32 v42, 16, v31
  v_and_b32 v43, 0xffff0000, v31
  v_fmac_f32 v36, v42, v42
  s_add_u32 m0, s65, 35840
  s_add_u32 s50, s64, 31488
  buffer_load_dwordx4 v221, s[8:11], s50 offen lds
  v_fmac_f32 v37, v43, v43
  s_waitcnt lgkmcnt(0)
  v_lshlrev_b32 v40, 16, v32
  v_and_b32 v41, 0xffff0000, v32
  v_fmac_f32 v36, v40, v40
  v_fmac_f32 v37, v41, v41
  v_lshlrev_b32 v42, 16, v33
  v_and_b32 v43, 0xffff0000, v33
  v_fmac_f32 v36, v42, v42
  v_fmac_f32 v37, v43, v43
  s_add_u32 m0, s65, 101376
  s_add_u32 s50, s68, 1520640
  buffer_load_dwordx4 v7, s[12:15], s50 offen lds
  v_lshlrev_b32 v40, 16, v34
  v_and_b32 v41, 0xffff0000, v34
  v_fmac_f32 v36, v40, v40
  v_fmac_f32 v37, v41, v41
  v_lshlrev_b32 v42, 16, v35
  v_and_b32 v43, 0xffff0000, v35
  v_fmac_f32 v36, v42, v42
  v_fmac_f32 v37, v43, v43
  s_waitcnt vmcnt(22)
  s_barrier
  ds_read_b128 v[20:23], v12 offset:0
  ds_read_b128 v[24:27], v13 offset:0
  ds_read_b128 v[28:31], v14 offset:0
  ds_read_b128 v[32:35], v15 offset:0
  s_add_u32 m0, s65, 49152
  s_add_u32 s50, s64, 896
  buffer_load_dwordx4 v220, s[8:11], s50 offen lds
  s_add_u32 m0, s65, 114688
  s_add_u32 s50, s68, 1720320
  buffer_load_dwordx4 v7, s[12:15], s50 offen lds
  s_waitcnt lgkmcnt(3)
  v_lshlrev_b32 v40, 16, v20
  v_and_b32 v41, 0xffff0000, v20
  v_fmac_f32 v36, v40, v40
  v_fmac_f32 v37, v41, v41
  v_lshlrev_b32 v42, 16, v21
  v_and_b32 v43, 0xffff0000, v21
  v_fmac_f32 v36, v42, v42
  v_fmac_f32 v37, v43, v43
  v_lshlrev_b32 v40, 16, v22
  s_add_u32 m0, s65, 50176
  s_add_u32 s50, s64, 11136
  buffer_load_dwordx4 v221, s[8:11], s50 offen lds
  v_and_b32 v41, 0xffff0000, v22
  v_fmac_f32 v36, v40, v40
  v_fmac_f32 v37, v41, v41
  v_lshlrev_b32 v42, 16, v23
  v_and_b32 v43, 0xffff0000, v23
  v_fmac_f32 v36, v42, v42
  v_fmac_f32 v37, v43, v43
  s_waitcnt lgkmcnt(2)
  v_lshlrev_b32 v40, 16, v24
  v_and_b32 v41, 0xffff0000, v24
  s_add_u32 m0, s65, 115712
  s_add_u32 s50, s68, 1735680
  buffer_load_dwordx4 v7, s[12:15], s50 offen lds
  v_fmac_f32 v36, v40, v40
  v_fmac_f32 v37, v41, v41
  v_lshlrev_b32 v42, 16, v25
  v_and_b32 v43, 0xffff0000, v25
  v_fmac_f32 v36, v42, v42
  v_fmac_f32 v37, v43, v43
  v_lshlrev_b32 v40, 16, v26
  v_and_b32 v41, 0xffff0000, v26
  v_fmac_f32 v36, v40, v40
  v_fmac_f32 v37, v41, v41
  s_add_u32 m0, s65, 51200
  s_add_u32 s50, s64, 21376
  buffer_load_dwordx4 v220, s[8:11], s50 offen lds
  v_lshlrev_b32 v42, 16, v27
  v_and_b32 v43, 0xffff0000, v27
  v_fmac_f32 v36, v42, v42
  v_fmac_f32 v37, v43, v43
  s_waitcnt lgkmcnt(1)
  v_lshlrev_b32 v40, 16, v28
  v_and_b32 v41, 0xffff0000, v28
  v_fmac_f32 v36, v40, v40
  v_fmac_f32 v37, v41, v41
  v_lshlrev_b32 v42, 16, v29
  s_add_u32 m0, s65, 116736
  s_add_u32 s50, s68, 1751040
  buffer_load_dwordx4 v7, s[12:15], s50 offen lds
  v_and_b32 v43, 0xffff0000, v29
  v_fmac_f32 v36, v42, v42
  v_fmac_f32 v37, v43, v43
  v_lshlrev_b32 v40, 16, v30
  v_and_b32 v41, 0xffff0000, v30
  v_fmac_f32 v36, v40, v40
  v_fmac_f32 v37, v41, v41
  v_lshlrev_b32 v42, 16, v31
  v_and_b32 v43, 0xffff0000, v31
  v_fmac_f32 v36, v42, v42
  s_add_u32 m0, s65, 52224
  s_add_u32 s50, s64, 31616
  buffer_load_dwordx4 v221, s[8:11], s50 offen lds
  v_fmac_f32 v37, v43, v43
  s_waitcnt lgkmcnt(0)
  v_lshlrev_b32 v40, 16, v32
  v_and_b32 v41, 0xffff0000, v32
  v_fmac_f32 v36, v40, v40
  v_fmac_f32 v37, v41, v41
  v_lshlrev_b32 v42, 16, v33
  v_and_b32 v43, 0xffff0000, v33
  v_fmac_f32 v36, v42, v42
  v_fmac_f32 v37, v43, v43
  s_add_u32 m0, s65, 117760
  s_add_u32 s50, s68, 1766400
  buffer_load_dwordx4 v7, s[12:15], s50 offen lds
  v_lshlrev_b32 v40, 16, v34
  v_and_b32 v41, 0xffff0000, v34
  v_fmac_f32 v36, v40, v40
  v_fmac_f32 v37, v41, v41
  v_lshlrev_b32 v42, 16, v35
  v_and_b32 v43, 0xffff0000, v35
  v_fmac_f32 v36, v42, v42
  v_fmac_f32 v37, v43, v43
  s_waitcnt vmcnt(22)
  s_barrier
  ds_read_b128 v[20:23], v12 offset:16384
  ds_read_b128 v[24:27], v13 offset:16384
  ds_read_b128 v[28:31], v14 offset:16384
  ds_read_b128 v[32:35], v15 offset:16384
  s_add_u32 m0, s65, 0
  s_add_u32 s50, s64, 1024
  buffer_load_dwordx4 v220, s[8:11], s50 offen lds
  s_add_u32 m0, s65, 65536
  s_add_u32 s50, s68, 1966080
  buffer_load_dwordx4 v7, s[12:15], s50 offen lds
  s_waitcnt lgkmcnt(3)
  v_lshlrev_b32 v40, 16, v20
  v_and_b32 v41, 0xffff0000, v20
  v_fmac_f32 v36, v40, v40
  v_fmac_f32 v37, v41, v41
  v_lshlrev_b32 v42, 16, v21
  v_and_b32 v43, 0xffff0000, v21
  v_fmac_f32 v36, v42, v42
  v_fmac_f32 v37, v43, v43
  v_lshlrev_b32 v40, 16, v22
  s_add_u32 m0, s65, 1024
  s_add_u32 s50, s64, 11264
  buffer_load_dwordx4 v221, s[8:11], s50 offen lds
  v_and_b32 v41, 0xffff0000, v22
  v_fmac_f32 v36, v40, v40
  v_fmac_f32 v37, v41, v41
  v_lshlrev_b32 v42, 16, v23
  v_and_b32 v43, 0xffff0000, v23
  v_fmac_f32 v36, v42, v42
  v_fmac_f32 v37, v43, v43
  s_waitcnt lgkmcnt(2)
  v_lshlrev_b32 v40, 16, v24
  v_and_b32 v41, 0xffff0000, v24
  s_add_u32 m0, s65, 66560
  s_add_u32 s50, s68, 1981440
  buffer_load_dwordx4 v7, s[12:15], s50 offen lds
  v_fmac_f32 v36, v40, v40
  v_fmac_f32 v37, v41, v41
  v_lshlrev_b32 v42, 16, v25
  v_and_b32 v43, 0xffff0000, v25
  v_fmac_f32 v36, v42, v42
  v_fmac_f32 v37, v43, v43
  v_lshlrev_b32 v40, 16, v26
  v_and_b32 v41, 0xffff0000, v26
  v_fmac_f32 v36, v40, v40
  v_fmac_f32 v37, v41, v41
  s_add_u32 m0, s65, 2048
  s_add_u32 s50, s64, 21504
  buffer_load_dwordx4 v220, s[8:11], s50 offen lds
  v_lshlrev_b32 v42, 16, v27
  v_and_b32 v43, 0xffff0000, v27
  v_fmac_f32 v36, v42, v42
  v_fmac_f32 v37, v43, v43
  s_waitcnt lgkmcnt(1)
  v_lshlrev_b32 v40, 16, v28
  v_and_b32 v41, 0xffff0000, v28
  v_fmac_f32 v36, v40, v40
  v_fmac_f32 v37, v41, v41
  v_lshlrev_b32 v42, 16, v29
  s_add_u32 m0, s65, 67584
  s_add_u32 s50, s68, 1996800
  buffer_load_dwordx4 v7, s[12:15], s50 offen lds
  v_and_b32 v43, 0xffff0000, v29
  v_fmac_f32 v36, v42, v42
  v_fmac_f32 v37, v43, v43
  v_lshlrev_b32 v40, 16, v30
  v_and_b32 v41, 0xffff0000, v30
  v_fmac_f32 v36, v40, v40
  v_fmac_f32 v37, v41, v41
  v_lshlrev_b32 v42, 16, v31
  v_and_b32 v43, 0xffff0000, v31
  v_fmac_f32 v36, v42, v42
  s_add_u32 m0, s65, 3072
  s_add_u32 s50, s64, 31744
  buffer_load_dwordx4 v221, s[8:11], s50 offen lds
  v_fmac_f32 v37, v43, v43
  s_waitcnt lgkmcnt(0)
  v_lshlrev_b32 v40, 16, v32
  v_and_b32 v41, 0xffff0000, v32
  v_fmac_f32 v36, v40, v40
  v_fmac_f32 v37, v41, v41
  v_lshlrev_b32 v42, 16, v33
  v_and_b32 v43, 0xffff0000, v33
  v_fmac_f32 v36, v42, v42
  v_fmac_f32 v37, v43, v43
  s_add_u32 m0, s65, 68608
  s_add_u32 s50, s68, 2012160
  buffer_load_dwordx4 v7, s[12:15], s50 offen lds
  v_lshlrev_b32 v40, 16, v34
  v_and_b32 v41, 0xffff0000, v34
  v_fmac_f32 v36, v40, v40
  v_fmac_f32 v37, v41, v41
  v_lshlrev_b32 v42, 16, v35
  v_and_b32 v43, 0xffff0000, v35
  v_fmac_f32 v36, v42, v42
  v_fmac_f32 v37, v43, v43
  s_waitcnt vmcnt(16)
  s_barrier
  ds_read_b128 v[20:23], v12 offset:32768
  ds_read_b128 v[24:27], v13 offset:32768
  ds_read_b128 v[28:31], v14 offset:32768
  ds_read_b128 v[32:35], v15 offset:32768
  s_add_u32 m0, s65, 16384
  s_add_u32 s50, s64, 1152
  buffer_load_dwordx4 v220, s[8:11], s50 offen lds
  s_add_u32 m0, s65, 81920
  s_add_u32 s50, s68, 2211840
  buffer_load_dwordx4 v7, s[12:15], s50 offen lds
  s_waitcnt lgkmcnt(3)
  v_lshlrev_b32 v40, 16, v20
  v_and_b32 v41, 0xffff0000, v20
  v_fmac_f32 v36, v40, v40
  v_fmac_f32 v37, v41, v41
  v_lshlrev_b32 v42, 16, v21
  v_and_b32 v43, 0xffff0000, v21
  v_fmac_f32 v36, v42, v42
  v_fmac_f32 v37, v43, v43
  v_lshlrev_b32 v40, 16, v22
  s_add_u32 m0, s65, 17408
  s_add_u32 s50, s64, 11392
  buffer_load_dwordx4 v221, s[8:11], s50 offen lds
  v_and_b32 v41, 0xffff0000, v22
  v_fmac_f32 v36, v40, v40
  v_fmac_f32 v37, v41, v41
  v_lshlrev_b32 v42, 16, v23
  v_and_b32 v43, 0xffff0000, v23
  v_fmac_f32 v36, v42, v42
  v_fmac_f32 v37, v43, v43
  s_waitcnt lgkmcnt(2)
  v_lshlrev_b32 v40, 16, v24
  v_and_b32 v41, 0xffff0000, v24
  s_add_u32 m0, s65, 82944
  s_add_u32 s50, s68, 2227200
  buffer_load_dwordx4 v7, s[12:15], s50 offen lds
  v_fmac_f32 v36, v40, v40
  v_fmac_f32 v37, v41, v41
  v_lshlrev_b32 v42, 16, v25
  v_and_b32 v43, 0xffff0000, v25
  v_fmac_f32 v36, v42, v42
  v_fmac_f32 v37, v43, v43
  v_lshlrev_b32 v40, 16, v26
  v_and_b32 v41, 0xffff0000, v26
  v_fmac_f32 v36, v40, v40
  v_fmac_f32 v37, v41, v41
  s_add_u32 m0, s65, 18432
  s_add_u32 s50, s64, 21632
  buffer_load_dwordx4 v220, s[8:11], s50 offen lds
  v_lshlrev_b32 v42, 16, v27
  v_and_b32 v43, 0xffff0000, v27
  v_fmac_f32 v36, v42, v42
  v_fmac_f32 v37, v43, v43
  s_waitcnt lgkmcnt(1)
  v_lshlrev_b32 v40, 16, v28
  v_and_b32 v41, 0xffff0000, v28
  v_fmac_f32 v36, v40, v40
  v_fmac_f32 v37, v41, v41
  v_lshlrev_b32 v42, 16, v29
  s_add_u32 m0, s65, 83968
  s_add_u32 s50, s68, 2242560
  buffer_load_dwordx4 v7, s[12:15], s50 offen lds
  v_and_b32 v43, 0xffff0000, v29
  v_fmac_f32 v36, v42, v42
  v_fmac_f32 v37, v43, v43
  v_lshlrev_b32 v40, 16, v30
  v_and_b32 v41, 0xffff0000, v30
  v_fmac_f32 v36, v40, v40
  v_fmac_f32 v37, v41, v41
  v_lshlrev_b32 v42, 16, v31
  v_and_b32 v43, 0xffff0000, v31
  v_fmac_f32 v36, v42, v42
  s_add_u32 m0, s65, 19456
  s_add_u32 s50, s64, 31872
  buffer_load_dwordx4 v221, s[8:11], s50 offen lds
  v_fmac_f32 v37, v43, v43
  s_waitcnt lgkmcnt(0)
  v_lshlrev_b32 v40, 16, v32
  v_and_b32 v41, 0xffff0000, v32
  v_fmac_f32 v36, v40, v40
  v_fmac_f32 v37, v41, v41
  v_lshlrev_b32 v42, 16, v33
  v_and_b32 v43, 0xffff0000, v33
  v_fmac_f32 v36, v42, v42
  v_fmac_f32 v37, v43, v43
  s_add_u32 m0, s65, 84992
  s_add_u32 s50, s68, 2257920
  buffer_load_dwordx4 v7, s[12:15], s50 offen lds
  v_lshlrev_b32 v40, 16, v34
  v_and_b32 v41, 0xffff0000, v34
  v_fmac_f32 v36, v40, v40
  v_fmac_f32 v37, v41, v41
  v_lshlrev_b32 v42, 16, v35
  v_and_b32 v43, 0xffff0000, v35
  v_fmac_f32 v36, v42, v42
  v_fmac_f32 v37, v43, v43
  s_waitcnt vmcnt(16)
  s_barrier
  ds_read_b128 v[20:23], v12 offset:49152
  ds_read_b128 v[24:27], v13 offset:49152
  ds_read_b128 v[28:31], v14 offset:49152
  ds_read_b128 v[32:35], v15 offset:49152
  v_mov_b32 v215, 0
  global_load_dword v215, v215, s[36:37] sc1
  s_add_u32 m0, s66, 139264
  s_add_u32 s50, s63, 1769472
  buffer_load_dwordx4 v222, s[20:23], s50 offen lds
  s_add_u32 m0, s66, 140288
  s_add_u32 s50, s63, 1769472
  buffer_load_dwordx4 v223, s[20:23], s50 offen lds
  s_waitcnt lgkmcnt(3)
  v_lshlrev_b32 v40, 16, v20
  v_and_b32 v41, 0xffff0000, v20
  v_fmac_f32 v36, v40, v40
  v_fmac_f32 v37, v41, v41
  v_lshlrev_b32 v42, 16, v21
  v_and_b32 v43, 0xffff0000, v21
  v_fmac_f32 v36, v42, v42
  v_fmac_f32 v37, v43, v43
  v_lshlrev_b32 v40, 16, v22
  v_and_b32 v41, 0xffff0000, v22
  v_fmac_f32 v36, v40, v40
  v_fmac_f32 v37, v41, v41
  v_lshlrev_b32 v42, 16, v23
  s_add_u32 m0, s66, 141312
  s_add_u32 s50, s63, 1769472
  buffer_load_dwordx4 v224, s[20:23], s50 offen lds
  v_and_b32 v43, 0xffff0000, v23
  v_fmac_f32 v36, v42, v42
  v_fmac_f32 v37, v43, v43
  s_waitcnt lgkmcnt(2)
  v_lshlrev_b32 v40, 16, v24
  v_and_b32 v41, 0xffff0000, v24
  v_fmac_f32 v36, v40, v40
  v_fmac_f32 v37, v41, v41
  v_lshlrev_b32 v42, 16, v25
  v_and_b32 v43, 0xffff0000, v25
  v_fmac_f32 v36, v42, v42
  v_fmac_f32 v37, v43, v43
  v_lshlrev_b32 v40, 16, v26
  v_and_b32 v41, 0xffff0000, v26
  s_add_u32 m0, s66, 151552
  s_add_u32 s50, s63, 1769472
  buffer_load_dwordx4 v222, s[24:27], s50 offen lds
  v_fmac_f32 v36, v40, v40
  v_fmac_f32 v37, v41, v41
  v_lshlrev_b32 v42, 16, v27
  v_and_b32 v43, 0xffff0000, v27
  v_fmac_f32 v36, v42, v42
  v_fmac_f32 v37, v43, v43
  s_waitcnt lgkmcnt(1)
  v_lshlrev_b32 v40, 16, v28
  v_and_b32 v41, 0xffff0000, v28
  v_fmac_f32 v36, v40, v40
  v_fmac_f32 v37, v41, v41
  v_lshlrev_b32 v42, 16, v29
  v_and_b32 v43, 0xffff0000, v29
  v_fmac_f32 v36, v42, v42
  s_add_u32 m0, s66, 152576
  s_add_u32 s50, s63, 1769472
  buffer_load_dwordx4 v223, s[24:27], s50 offen lds
  v_fmac_f32 v37, v43, v43
  v_lshlrev_b32 v40, 16, v30
  v_and_b32 v41, 0xffff0000, v30
  v_fmac_f32 v36, v40, v40
  v_fmac_f32 v37, v41, v41
  v_lshlrev_b32 v42, 16, v31
  v_and_b32 v43, 0xffff0000, v31
  v_fmac_f32 v36, v42, v42
  v_fmac_f32 v37, v43, v43
  s_waitcnt lgkmcnt(0)
  v_lshlrev_b32 v40, 16, v32
  v_and_b32 v41, 0xffff0000, v32
  v_fmac_f32 v36, v40, v40
  v_fmac_f32 v37, v41, v41
  s_add_u32 m0, s66, 153600
  s_add_u32 s50, s63, 1769472
  buffer_load_dwordx4 v224, s[24:27], s50 offen lds
  v_lshlrev_b32 v42, 16, v33
  v_and_b32 v43, 0xffff0000, v33
  v_fmac_f32 v36, v42, v42
  v_fmac_f32 v37, v43, v43
  v_lshlrev_b32 v40, 16, v34
  v_and_b32 v41, 0xffff0000, v34
  v_fmac_f32 v36, v40, v40
  v_fmac_f32 v37, v41, v41
  v_lshlrev_b32 v42, 16, v35
  v_and_b32 v43, 0xffff0000, v35
  v_fmac_f32 v36, v42, v42
  v_fmac_f32 v37, v43, v43
  s_waitcnt vmcnt(15)
  s_barrier
  ds_read_b128 v[20:23], v12 offset:0
  ds_read_b128 v[24:27], v13 offset:0
  ds_read_b128 v[28:31], v14 offset:0
  ds_read_b128 v[32:35], v15 offset:0
  s_add_u32 m0, s66, 114688
  s_add_u32 s50, s63, 1572864
  buffer_load_dwordx4 v222, s[20:23], s50 offen lds
  s_add_u32 m0, s66, 115712
  s_add_u32 s50, s63, 1572864
  buffer_load_dwordx4 v223, s[20:23], s50 offen lds
  s_waitcnt lgkmcnt(3)
  v_lshlrev_b32 v40, 16, v20
  v_and_b32 v41, 0xffff0000, v20
  v_fmac_f32 v36, v40, v40
  v_fmac_f32 v37, v41, v41
  v_lshlrev_b32 v42, 16, v21
  v_and_b32 v43, 0xffff0000, v21
  v_fmac_f32 v36, v42, v42
  v_fmac_f32 v37, v43, v43
  v_lshlrev_b32 v40, 16, v22
  v_and_b32 v41, 0xffff0000, v22
  v_fmac_f32 v36, v40, v40
  v_fmac_f32 v37, v41, v41
  v_lshlrev_b32 v42, 16, v23
  s_add_u32 m0, s66, 116736
  s_add_u32 s50, s63, 1572864
  buffer_load_dwordx4 v224, s[20:23], s50 offen lds
  v_and_b32 v43, 0xffff0000, v23
  v_fmac_f32 v36, v42, v42
  v_fmac_f32 v37, v43, v43
  s_waitcnt lgkmcnt(2)
  v_lshlrev_b32 v40, 16, v24
  v_and_b32 v41, 0xffff0000, v24
  v_fmac_f32 v36, v40, v40
  v_fmac_f32 v37, v41, v41
  v_lshlrev_b32 v42, 16, v25
  v_and_b32 v43, 0xffff0000, v25
  v_fmac_f32 v36, v42, v42
  v_fmac_f32 v37, v43, v43
  v_lshlrev_b32 v40, 16, v26
  v_and_b32 v41, 0xffff0000, v26
  s_add_u32 m0, s66, 126976
  s_add_u32 s50, s63, 1572864
  buffer_load_dwordx4 v222, s[24:27], s50 offen lds
  v_fmac_f32 v36, v40, v40
  v_fmac_f32 v37, v41, v41
  v_lshlrev_b32 v42, 16, v27
  v_and_b32 v43, 0xffff0000, v27
  v_fmac_f32 v36, v42, v42
  v_fmac_f32 v37, v43, v43
  s_waitcnt lgkmcnt(1)
  v_lshlrev_b32 v40, 16, v28
  v_and_b32 v41, 0xffff0000, v28
  v_fmac_f32 v36, v40, v40
  v_fmac_f32 v37, v41, v41
  v_lshlrev_b32 v42, 16, v29
  v_and_b32 v43, 0xffff0000, v29
  v_fmac_f32 v36, v42, v42
  s_add_u32 m0, s66, 128000
  s_add_u32 s50, s63, 1572864
  buffer_load_dwordx4 v223, s[24:27], s50 offen lds
  v_fmac_f32 v37, v43, v43
  v_lshlrev_b32 v40, 16, v30
  v_and_b32 v41, 0xffff0000, v30
  v_fmac_f32 v36, v40, v40
  v_fmac_f32 v37, v41, v41
  v_lshlrev_b32 v42, 16, v31
  v_and_b32 v43, 0xffff0000, v31
  v_fmac_f32 v36, v42, v42
  v_fmac_f32 v37, v43, v43
  s_waitcnt lgkmcnt(0)
  v_lshlrev_b32 v40, 16, v32
  v_and_b32 v41, 0xffff0000, v32
  v_fmac_f32 v36, v40, v40
  v_fmac_f32 v37, v41, v41
  s_add_u32 m0, s66, 129024
  s_add_u32 s50, s63, 1572864
  buffer_load_dwordx4 v224, s[24:27], s50 offen lds
  v_lshlrev_b32 v42, 16, v33
  v_and_b32 v43, 0xffff0000, v33
  v_fmac_f32 v36, v42, v42
  v_fmac_f32 v37, v43, v43
  v_lshlrev_b32 v40, 16, v34
  v_and_b32 v41, 0xffff0000, v34
  v_fmac_f32 v36, v40, v40
  v_fmac_f32 v37, v41, v41
  v_lshlrev_b32 v42, 16, v35
  v_and_b32 v43, 0xffff0000, v35
  v_fmac_f32 v36, v42, v42
  v_fmac_f32 v37, v43, v43
  s_waitcnt vmcnt(12)
  s_mov_b32 s51, 0
L_non_13:
  v_readfirstlane_b32 s58, v215
  s_add_u32 s51, s51, 1
  s_cmp_lg_u32 s58, 0
  s_cbranch_scc1 L_non_13_ok
  s_cmp_ge_u32 s51, 0x20000
  s_cbranch_scc1 L_non_13_ok
  s_sleep 8
  v_mov_b32 v215, 0
  global_load_dword v215, v215, s[36:37] sc1
  s_waitcnt vmcnt(0)
  s_branch L_non_13
L_non_13_ok:
  s_barrier
  ds_read_b128 v[20:23], v12 offset:16384
  ds_read_b128 v[24:27], v13 offset:16384
  ds_read_b128 v[28:31], v14 offset:16384
  ds_read_b128 v[32:35], v15 offset:16384
  s_waitcnt lgkmcnt(3)
  v_lshlrev_b32 v40, 16, v20
  v_and_b32 v41, 0xffff0000, v20
  v_fmac_f32 v36, v40, v40
  v_fmac_f32 v37, v41, v41
  v_lshlrev_b32 v42, 16, v21
  v_and_b32 v43, 0xffff0000, v21
  v_fmac_f32 v36, v42, v42
  v_fmac_f32 v37, v43, v43
  v_lshlrev_b32 v40, 16, v22
  v_and_b32 v41, 0xffff0000, v22
  v_fmac_f32 v36, v40, v40
  v_fmac_f32 v37, v41, v41
  v_lshlrev_b32 v42, 16, v23
  v_and_b32 v43, 0xffff0000, v23
  v_fmac_f32 v36, v42, v42
  v_fmac_f32 v37, v43, v43
  s_waitcnt lgkmcnt(2)
  v_lshlrev_b32 v40, 16, v24
  v_and_b32 v41, 0xffff0000, v24
  v_fmac_f32 v36, v40, v40
  v_fmac_f32 v37, v41, v41
  v_lshlrev_b32 v42, 16, v25
  v_and_b32 v43, 0xffff0000, v25
  v_fmac_f32 v36, v42, v42
  v_fmac_f32 v37, v43, v43
  v_lshlrev_b32 v40, 16, v26
  v_and_b32 v41, 0xffff0000, v26
  v_fmac_f32 v36, v40, v40
  v_fmac_f32 v37, v41, v41
  v_lshlrev_b32 v42, 16, v27
  v_and_b32 v43, 0xffff0000, v27
  v_fmac_f32 v36, v42, v42
  v_fmac_f32 v37, v43, v43
  s_waitcnt lgkmcnt(1)
  v_lshlrev_b32 v40, 16, v28
  v_and_b32 v41, 0xffff0000, v28
  v_fmac_f32 v36, v40, v40
  v_fmac_f32 v37, v41, v41
  v_lshlrev_b32 v42, 16, v29
  v_and_b32 v43, 0xffff0000, v29
  v_fmac_f32 v36, v42, v42
  v_fmac_f32 v37, v43, v43
  v_lshlrev_b32 v40, 16, v30
  v_and_b32 v41, 0xffff0000, v30
  v_fmac_f32 v36, v40, v40
  v_fmac_f32 v37, v41, v41
  v_lshlrev_b32 v42, 16, v31
  v_and_b32 v43, 0xffff0000, v31
  v_fmac_f32 v36, v42, v42
  v_fmac_f32 v37, v43, v43
  s_waitcnt lgkmcnt(0)
  v_lshlrev_b32 v40, 16, v32
  v_and_b32 v41, 0xffff0000, v32
  v_fmac_f32 v36, v40, v40
  v_fmac_f32 v37, v41, v41
  v_lshlrev_b32 v42, 16, v33
  v_and_b32 v43, 0xffff0000, v33
  v_fmac_f32 v36, v42, v42
  v_fmac_f32 v37, v43, v43
  v_lshlrev_b32 v40, 16, v34
  v_and_b32 v41, 0xffff0000, v34
  v_fmac_f32 v36, v40, v40
  v_fmac_f32 v37, v41, v41
  v_lshlrev_b32 v42, 16, v35
  v_and_b32 v43, 0xffff0000, v35
  v_fmac_f32 v36, v42, v42
  v_fmac_f32 v37, v43, v43
  v_add_f32 v181, v36, v37
  v_mov_b32 v37, v181
  s_lshl_b32 s50, s59, 7
  s_add_u32 s50, s50, 65536
  v_lshl_add_u32 v10, v3, 2, s50
  v_permlane32_swap_b32 v181, v37
  v_add_f32 v181, v181, v37
  s_barrier
  ds_read_b32 v180, v10 offset:5632
  s_waitcnt lgkmcnt(0)
  s_mov_b32 s50, 0x3acccccd
  v_mul_f32 v180, s50, v180
  v_mul_f32 v181, s50, v181
  v_fma_f32 v181, -v180, v180, v181
  v_max_f32 v181, 0, v181
  v_cvt_pk_bf16_f32 v41, v180, v181
  v_lshlrev_b32 v180, 16, v41
  v_and_b32 v181, 0xffff0000, v41
  v_add_f32 v181, 0x3727c5ac, v181
  v_cvt_pk_bf16_f32 v41, v181, v181
  v_and_b32 v181, 0xffff0000, v41
  v_sqrt_f32 v181, v181
  s_nop 0
  v_cvt_pk_bf16_f32 v41, v181, v181
  v_and_b32 v181, 0xffff0000, v41
  v_rcp_f32 v181, v181
  v_xor_b32 v180, 0x80000000, v180
  s_nop 0
  ds_write_b32 v10, v180 offset:2048
  ds_write_b32 v10, v181 offset:2560
  v_mul_f32 v181, v181, v181
  s_add_u32 m0, s66, 90112
  s_add_u32 s50, s63, 1376256
  buffer_load_dwordx4 v222, s[20:23], s50 offen lds
  s_add_u32 m0, s66, 91136
  s_add_u32 s50, s63, 1376256
  buffer_load_dwordx4 v223, s[20:23], s50 offen lds
  s_add_u32 m0, s66, 92160
  s_add_u32 s50, s63, 1376256
  buffer_load_dwordx4 v224, s[20:23], s50 offen lds
  s_add_u32 m0, s66, 102400
  s_add_u32 s50, s63, 1376256
  buffer_load_dwordx4 v222, s[24:27], s50 offen lds
  s_add_u32 m0, s66, 103424
  s_add_u32 s50, s63, 1376256
  buffer_load_dwordx4 v223, s[24:27], s50 offen lds
  s_add_u32 m0, s66, 104448
  s_add_u32 s50, s63, 1376256
  buffer_load_dwordx4 v224, s[24:27], s50 offen lds
  s_waitcnt vmcnt(12)
  s_waitcnt lgkmcnt(0)
  s_barrier
  s_setprio 2
  ds_read_b128 v[8:11], v184 offset:16384
  ds_read_b64_tr_b16 v[16:17], v203 offset:24576
  ds_read_b64_tr_b16 v[18:19], v203 offset:25344
  ds_read_b64_tr_b16 v[20:21], v203 offset:36864
  ds_read_b64_tr_b16 v[22:23], v203 offset:37632
  ds_read_b64_tr_b16 v[24:25], v204 offset:24576
  ds_read_b64_tr_b16 v[26:27], v204 offset:25344
  ds_read_b64_tr_b16 v[28:29], v204 offset:36864
  ds_read_b64_tr_b16 v[30:31], v204 offset:37632
  ds_read_b64_tr_b16 v[32:33], v205 offset:24576
  ds_read_b64_tr_b16 v[34:35], v205 offset:25344
  ds_read_b64_tr_b16 v[36:37], v205 offset:36864
  ds_read_b64_tr_b16 v[38:39], v205 offset:37632
  s_waitcnt lgkmcnt(10)
  v_mfma_f32_32x32x16_bf16 v[64:79], v[16:19], v[8:11], v[64:79]
  ds_read_b128 v[12:15], v185 offset:16384
  ds_read_b64_tr_b16 v[40:41], v203 offset:27648
  ds_read_b64_tr_b16 v[42:43], v203 offset:28416
  s_waitcnt lgkmcnt(11)
  v_mfma_f32_32x32x16_bf16 v[80:95], v[20:23], v[8:11], v[80:95]
  ds_read_b64_tr_b16 v[44:45], v203 offset:39936
  ds_read_b64_tr_b16 v[46:47], v203 offset:40704
  s_add_u32 m0, s66, 65536
  s_add_u32 s50, s63, 1179648
  buffer_load_dwordx4 v222, s[20:23], s50 offen lds
  s_waitcnt lgkmcnt(11)
  v_mfma_f32_32x32x16_bf16 v[96:111], v[24:27], v[8:11], v[96:111]
  ds_read_b64_tr_b16 v[48:49], v204 offset:27648
  ds_read_b64_tr_b16 v[50:51], v204 offset:28416
  s_waitcnt lgkmcnt(11)
  v_mfma_f32_32x32x16_bf16 v[112:127], v[28:31], v[8:11], v[112:127]
  ds_read_b64_tr_b16 v[52:53], v204 offset:39936
  ds_read_b64_tr_b16 v[54:55], v204 offset:40704
  s_add_u32 m0, s66, 66560
  s_add_u32 s50, s63, 1179648
  buffer_load_dwordx4 v223, s[20:23], s50 offen lds
  s_waitcnt lgkmcnt(11)
  v_mfma_f32_32x32x16_bf16 v[128:143], v[32:35], v[8:11], v[128:143]
  ds_read_b64_tr_b16 v[56:57], v205 offset:27648
  ds_read_b64_tr_b16 v[58:59], v205 offset:28416
  v_mfma_f32_16x16x32_bf16 v[160:163], v[168:171], v[16:19], v[160:163]
  s_waitcnt lgkmcnt(11)
  v_mfma_f32_32x32x16_bf16 v[144:159], v[36:39], v[8:11], v[144:159]
  ds_read_b64_tr_b16 v[60:61], v205 offset:39936
  ds_read_b64_tr_b16 v[62:63], v205 offset:40704
  s_add_u32 m0, s66, 77824
  s_add_u32 s50, s63, 1179648
  buffer_load_dwordx4 v222, s[24:27], s50 offen lds
  v_mfma_f32_16x16x32_bf16 v[164:167], v[168:171], v[20:23], v[164:167]
  s_waitcnt lgkmcnt(10)
  v_mfma_f32_32x32x16_bf16 v[64:79], v[40:43], v[12:15], v[64:79]
  ds_read_b128 v[8:11], v186 offset:16384
  ds_read_b64_tr_b16 v[16:17], v203 offset:30720
  ds_read_b64_tr_b16 v[18:19], v203 offset:31488
  s_waitcnt lgkmcnt(11)
  v_mfma_f32_32x32x16_bf16 v[80:95], v[44:47], v[12:15], v[80:95]
  ds_read_b64_tr_b16 v[20:21], v203 offset:43008
  ds_read_b64_tr_b16 v[22:23], v203 offset:43776
  s_add_u32 m0, s66, 78848
  s_add_u32 s50, s63, 1179648
  buffer_load_dwordx4 v223, s[24:27], s50 offen lds
  s_waitcnt lgkmcnt(11)
  v_mfma_f32_32x32x16_bf16 v[96:111], v[48:51], v[12:15], v[96:111]
  ds_read_b64_tr_b16 v[24:25], v204 offset:30720
  ds_read_b64_tr_b16 v[26:27], v204 offset:31488
  s_waitcnt lgkmcnt(11)
  v_mfma_f32_32x32x16_bf16 v[112:127], v[52:55], v[12:15], v[112:127]
  ds_read_b64_tr_b16 v[28:29], v204 offset:43008
  ds_read_b64_tr_b16 v[30:31], v204 offset:43776
  s_add_u32 m0, s66, 79872
  s_add_u32 s50, s63, 1179648
  buffer_load_dwordx4 v224, s[24:27], s50 offen lds
  s_waitcnt lgkmcnt(11)
  v_mfma_f32_32x32x16_bf16 v[128:143], v[56:59], v[12:15], v[128:143]
  ds_read_b64_tr_b16 v[32:33], v205 offset:30720
  ds_read_b64_tr_b16 v[34:35], v205 offset:31488
  v_mfma_f32_16x16x32_bf16 v[160:163], v[168:171], v[40:43], v[160:163]
  s_waitcnt lgkmcnt(11)
  v_mfma_f32_32x32x16_bf16 v[144:159], v[60:63], v[12:15], v[144:159]
  ds_read_b64_tr_b16 v[36:37], v205 offset:43008
  ds_read_b64_tr_b16 v[38:39], v205 offset:43776
  v_mfma_f32_16x16x32_bf16 v[164:167], v[168:171], v[44:47], v[164:167]
  s_waitcnt lgkmcnt(10)
  v_mfma_f32_32x32x16_bf16 v[64:79], v[16:19], v[8:11], v[64:79]
  ds_read_b128 v[12:15], v187 offset:16384
  ds_read_b64_tr_b16 v[40:41], v203 offset:33792
  ds_read_b64_tr_b16 v[42:43], v203 offset:34560
  s_waitcnt lgkmcnt(11)
  v_mfma_f32_32x32x16_bf16 v[80:95], v[20:23], v[8:11], v[80:95]
  ds_read_b64_tr_b16 v[44:45], v203 offset:46080
  ds_read_b64_tr_b16 v[46:47], v203 offset:46848
  s_waitcnt lgkmcnt(11)
  v_mfma_f32_32x32x16_bf16 v[96:111], v[24:27], v[8:11], v[96:111]
  ds_read_b64_tr_b16 v[48:49], v204 offset:33792
  ds_read_b64_tr_b16 v[50:51], v204 offset:34560
  s_waitcnt lgkmcnt(11)
  v_mfma_f32_32x32x16_bf16 v[112:127], v[28:31], v[8:11], v[112:127]
  ds_read_b64_tr_b16 v[52:53], v204 offset:46080
  ds_read_b64_tr_b16 v[54:55], v204 offset:46848
  s_waitcnt lgkmcnt(11)
  v_mfma_f32_32x32x16_bf16 v[128:143], v[32:35], v[8:11], v[128:143]
  ds_read_b64_tr_b16 v[56:57], v205 offset:33792
  ds_read_b64_tr_b16 v[58:59], v205 offset:34560
  v_mfma_f32_16x16x32_bf16 v[160:163], v[168:171], v[16:19], v[160:163]
  s_waitcnt lgkmcnt(11)
  v_mfma_f32_32x32x16_bf16 v[144:159], v[36:39], v[8:11], v[144:159]
  ds_read_b64_tr_b16 v[60:61], v205 offset:46080
  ds_read_b64_tr_b16 v[62:63], v205 offset:46848
  v_mfma_f32_16x16x32_bf16 v[164:167], v[168:171], v[20:23], v[164:167]
  s_waitcnt vmcnt(11)
  s_waitcnt lgkmcnt(0)
  s_barrier
  v_mfma_f32_32x32x16_bf16 v[64:79], v[40:43], v[12:15], v[64:79]
  ds_read_b128 v[8:11], v184 offset:0
  ds_read_b64_tr_b16 v[16:17], v203 offset:0
  ds_read_b64_tr_b16 v[18:19], v203 offset:768
  v_mfma_f32_32x32x16_bf16 v[80:95], v[44:47], v[12:15], v[80:95]
  ds_read_b64_tr_b16 v[20:21], v203 offset:12288
  ds_read_b64_tr_b16 v[22:23], v203 offset:13056
  s_add_u32 m0, s66, 67584
  s_add_u32 s50, s63, 1179648
  buffer_load_dwordx4 v224, s[20:23], s50 offen lds
  v_mfma_f32_32x32x16_bf16 v[96:111], v[48:51], v[12:15], v[96:111]
  ds_read_b64_tr_b16 v[24:25], v204 offset:0
  ds_read_b64_tr_b16 v[26:27], v204 offset:768
  v_mfma_f32_32x32x16_bf16 v[112:127], v[52:55], v[12:15], v[112:127]
  ds_read_b64_tr_b16 v[28:29], v204 offset:12288
  ds_read_b64_tr_b16 v[30:31], v204 offset:13056
  s_add_u32 m0, s65, 16384
  s_add_u32 s50, s64, 640
  buffer_load_dwordx4 v220, s[8:11], s50 offen lds
  v_mfma_f32_32x32x16_bf16 v[128:143], v[56:59], v[12:15], v[128:143]
  ds_read_b64_tr_b16 v[32:33], v205 offset:0
  ds_read_b64_tr_b16 v[34:35], v205 offset:768
  v_mfma_f32_16x16x32_bf16 v[160:163], v[168:171], v[40:43], v[160:163]
  v_mfma_f32_32x32x16_bf16 v[144:159], v[60:63], v[12:15], v[144:159]
  ds_read_b64_tr_b16 v[36:37], v205 offset:12288
  ds_read_b64_tr_b16 v[38:39], v205 offset:13056
  s_add_u32 m0, s65, 17408
  s_add_u32 s50, s64, 10880
  buffer_load_dwordx4 v221, s[8:11], s50 offen lds
  v_mfma_f32_16x16x32_bf16 v[164:167], v[168:171], v[44:47], v[164:167]
  s_waitcnt lgkmcnt(10)
  v_mfma_f32_32x32x16_bf16 v[64:79], v[16:19], v[8:11], v[64:79]
  ds_read_b128 v[12:15], v185 offset:0
  ds_read_b64_tr_b16 v[40:41], v203 offset:3072
  ds_read_b64_tr_b16 v[42:43], v203 offset:3840
  s_waitcnt lgkmcnt(11)
  v_mfma_f32_32x32x16_bf16 v[80:95], v[20:23], v[8:11], v[80:95]
  ds_read_b64_tr_b16 v[44:45], v203 offset:15360
  ds_read_b64_tr_b16 v[46:47], v203 offset:16128
  s_add_u32 m0, s65, 18432
  s_add_u32 s50, s64, 21120
  buffer_load_dwordx4 v220, s[8:11], s50 offen lds
  s_waitcnt lgkmcnt(11)
  v_mfma_f32_32x32x16_bf16 v[96:111], v[24:27], v[8:11], v[96:111]
  ds_read_b64_tr_b16 v[48:49], v204 offset:3072
  ds_read_b64_tr_b16 v[50:51], v204 offset:3840
  s_waitcnt lgkmcnt(11)
  v_mfma_f32_32x32x16_bf16 v[112:127], v[28:31], v[8:11], v[112:127]
  ds_read_b64_tr_b16 v[52:53], v204 offset:15360
  ds_read_b64_tr_b16 v[54:55], v204 offset:16128
  s_add_u32 m0, s65, 19456
  s_add_u32 s50, s64, 31360
  buffer_load_dwordx4 v221, s[8:11], s50 offen lds
  s_waitcnt lgkmcnt(11)
  v_mfma_f32_32x32x16_bf16 v[128:143], v[32:35], v[8:11], v[128:143]
  ds_read_b64_tr_b16 v[56:57], v205 offset:3072
  ds_read_b64_tr_b16 v[58:59], v205 offset:3840
  v_mfma_f32_16x16x32_bf16 v[160:163], v[168:171], v[16:19], v[160:163]
  s_waitcnt lgkmcnt(11)
  v_mfma_f32_32x32x16_bf16 v[144:159], v[36:39], v[8:11], v[144:159]
  ds_read_b64_tr_b16 v[60:61], v205 offset:15360
  ds_read_b64_tr_b16 v[62:63], v205 offset:16128
  s_add_u32 m0, s66, 139264
  s_add_u32 s50, s63, 983040
  buffer_load_dwordx4 v222, s[20:23], s50 offen lds
  v_mfma_f32_16x16x32_bf16 v[164:167], v[168:171], v[20:23], v[164:167]
  s_waitcnt lgkmcnt(10)
  v_mfma_f32_32x32x16_bf16 v[64:79], v[40:43], v[12:15], v[64:79]
  ds_read_b128 v[8:11], v186 offset:0
  ds_read_b64_tr_b16 v[16:17], v203 offset:6144
  ds_read_b64_tr_b16 v[18:19], v203 offset:6912
  s_waitcnt lgkmcnt(11)
  v_mfma_f32_32x32x16_bf16 v[80:95], v[44:47], v[12:15], v[80:95]
  ds_read_b64_tr_b16 v[20:21], v203 offset:18432
  ds_read_b64_tr_b16 v[22:23], v203 offset:19200
  s_add_u32 m0, s66, 140288
  s_add_u32 s50, s63, 983040
  buffer_load_dwordx4 v223, s[20:23], s50 offen lds
  s_waitcnt lgkmcnt(11)
  v_mfma_f32_32x32x16_bf16 v[96:111], v[48:51], v[12:15], v[96:111]
  ds_read_b64_tr_b16 v[24:25], v204 offset:6144
  ds_read_b64_tr_b16 v[26:27], v204 offset:6912
  s_waitcnt lgkmcnt(11)
  v_mfma_f32_32x32x16_bf16 v[112:127], v[52:55], v[12:15], v[112:127]
  ds_read_b64_tr_b16 v[28:29], v204 offset:18432
  ds_read_b64_tr_b16 v[30:31], v204 offset:19200
  s_add_u32 m0, s66, 141312
  s_add_u32 s50, s63, 983040
  buffer_load_dwordx4 v224, s[20:23], s50 offen lds
  s_waitcnt lgkmcnt(11)
  v_mfma_f32_32x32x16_bf16 v[128:143], v[56:59], v[12:15], v[128:143]
  ds_read_b64_tr_b16 v[32:33], v205 offset:6144
  ds_read_b64_tr_b16 v[34:35], v205 offset:6912
  v_mfma_f32_16x16x32_bf16 v[160:163], v[168:171], v[40:43], v[160:163]
  s_waitcnt lgkmcnt(11)
  v_mfma_f32_32x32x16_bf16 v[144:159], v[60:63], v[12:15], v[144:159]
  ds_read_b64_tr_b16 v[36:37], v205 offset:18432
  ds_read_b64_tr_b16 v[38:39], v205 offset:19200
  s_add_u32 m0, s66, 151552
  s_add_u32 s50, s63, 983040
  buffer_load_dwordx4 v222, s[24:27], s50 offen lds
  v_mfma_f32_16x16x32_bf16 v[164:167], v[168:171], v[44:47], v[164:167]
  s_waitcnt lgkmcnt(10)
  v_mfma_f32_32x32x16_bf16 v[64:79], v[16:19], v[8:11], v[64:79]
  ds_read_b128 v[12:15], v187 offset:0
  ds_read_b64_tr_b16 v[40:41], v203 offset:9216
  ds_read_b64_tr_b16 v[42:43], v203 offset:9984
  s_waitcnt lgkmcnt(11)
  v_mfma_f32_32x32x16_bf16 v[80:95], v[20:23], v[8:11], v[80:95]
  ds_read_b64_tr_b16 v[44:45], v203 offset:21504
  ds_read_b64_tr_b16 v[46:47], v203 offset:22272
  s_add_u32 m0, s66, 152576
  s_add_u32 s50, s63, 983040
  buffer_load_dwordx4 v223, s[24:27], s50 offen lds
  s_waitcnt lgkmcnt(11)
  v_mfma_f32_32x32x16_bf16 v[96:111], v[24:27], v[8:11], v[96:111]
  ds_read_b64_tr_b16 v[48:49], v204 offset:9216
  ds_read_b64_tr_b16 v[50:51], v204 offset:9984
  s_waitcnt lgkmcnt(11)
  v_mfma_f32_32x32x16_bf16 v[112:127], v[28:31], v[8:11], v[112:127]
  ds_read_b64_tr_b16 v[52:53], v204 offset:21504
  ds_read_b64_tr_b16 v[54:55], v204 offset:22272
  s_add_u32 m0, s66, 153600
  s_add_u32 s50, s63, 983040
  buffer_load_dwordx4 v224, s[24:27], s50 offen lds
  s_waitcnt lgkmcnt(11)
  v_mfma_f32_32x32x16_bf16 v[128:143], v[32:35], v[8:11], v[128:143]
  ds_read_b64_tr_b16 v[56:57], v205 offset:9216
  ds_read_b64_tr_b16 v[58:59], v205 offset:9984
  v_mfma_f32_16x16x32_bf16 v[160:163], v[168:171], v[16:19], v[160:163]
  s_waitcnt lgkmcnt(11)
  v_mfma_f32_32x32x16_bf16 v[144:159], v[36:39], v[8:11], v[144:159]
  ds_read_b64_tr_b16 v[60:61], v205 offset:21504
  ds_read_b64_tr_b16 v[62:63], v205 offset:22272
  v_mfma_f32_16x16x32_bf16 v[164:167], v[168:171], v[20:23], v[164:167]
  s_waitcnt vmcnt(16)
  s_waitcnt lgkmcnt(0)
  s_barrier
  v_mfma_f32_32x32x16_bf16 v[64:79], v[40:43], v[12:15], v[64:79]
  ds_read_b128 v[8:11], v184 offset:49152
  ds_read_b64_tr_b16 v[16:17], v200 offset:24576
  ds_read_b64_tr_b16 v[18:19], v200 offset:25344
  v_mfma_f32_32x32x16_bf16 v[80:95], v[44:47], v[12:15], v[80:95]
  ds_read_b64_tr_b16 v[20:21], v200 offset:36864
  ds_read_b64_tr_b16 v[22:23], v200 offset:37632
  s_add_u32 m0, s65, 0
  s_add_u32 s50, s64, 512
  buffer_load_dwordx4 v220, s[8:11], s50 offen lds
  v_mfma_f32_32x32x16_bf16 v[96:111], v[48:51], v[12:15], v[96:111]
  ds_read_b64_tr_b16 v[24:25], v201 offset:24576
  ds_read_b64_tr_b16 v[26:27], v201 offset:25344
  v_mfma_f32_32x32x16_bf16 v[112:127], v[52:55], v[12:15], v[112:127]
  ds_read_b64_tr_b16 v[28:29], v201 offset:36864
  ds_read_b64_tr_b16 v[30:31], v201 offset:37632
  s_add_u32 m0, s65, 1024
  s_add_u32 s50, s64, 10752
  buffer_load_dwordx4 v221, s[8:11], s50 offen lds
  v_mfma_f32_32x32x16_bf16 v[128:143], v[56:59], v[12:15], v[128:143]
  ds_read_b64_tr_b16 v[32:33], v202 offset:24576
  ds_read_b64_tr_b16 v[34:35], v202 offset:25344
  v_mfma_f32_16x16x32_bf16 v[160:163], v[168:171], v[40:43], v[160:163]
  v_mfma_f32_32x32x16_bf16 v[144:159], v[60:63], v[12:15], v[144:159]
  ds_read_b64_tr_b16 v[36:37], v202 offset:36864
  ds_read_b64_tr_b16 v[38:39], v202 offset:37632
  s_add_u32 m0, s65, 2048
  s_add_u32 s50, s64, 20992
  buffer_load_dwordx4 v220, s[8:11], s50 offen lds
  v_mfma_f32_16x16x32_bf16 v[164:167], v[168:171], v[44:47], v[164:167]
  s_waitcnt lgkmcnt(10)
  v_mfma_f32_32x32x16_bf16 v[64:79], v[16:19], v[8:11], v[64:79]
  ds_read_b128 v[12:15], v185 offset:49152
  ds_read_b64_tr_b16 v[40:41], v200 offset:27648
  ds_read_b64_tr_b16 v[42:43], v200 offset:28416
  s_waitcnt lgkmcnt(11)
  v_mfma_f32_32x32x16_bf16 v[80:95], v[20:23], v[8:11], v[80:95]
  ds_read_b64_tr_b16 v[44:45], v200 offset:39936
  ds_read_b64_tr_b16 v[46:47], v200 offset:40704
  s_add_u32 m0, s65, 3072
  s_add_u32 s50, s64, 31232
  buffer_load_dwordx4 v221, s[8:11], s50 offen lds
  s_waitcnt lgkmcnt(11)
  v_mfma_f32_32x32x16_bf16 v[96:111], v[24:27], v[8:11], v[96:111]
  ds_read_b64_tr_b16 v[48:49], v201 offset:27648
  ds_read_b64_tr_b16 v[50:51], v201 offset:28416
  s_waitcnt lgkmcnt(11)
  v_mfma_f32_32x32x16_bf16 v[112:127], v[28:31], v[8:11], v[112:127]
  ds_read_b64_tr_b16 v[52:53], v201 offset:39936
  ds_read_b64_tr_b16 v[54:55], v201 offset:40704
  s_add_u32 m0, s66, 114688
  s_add_u32 s50, s63, 786432
  buffer_load_dwordx4 v222, s[20:23], s50 offen lds
  s_waitcnt lgkmcnt(11)
  v_mfma_f32_32x32x16_bf16 v[128:143], v[32:35], v[8:11], v[128:143]
  ds_read_b64_tr_b16 v[56:57], v202 offset:27648
  ds_read_b64_tr_b16 v[58:59], v202 offset:28416
  v_mfma_f32_16x16x32_bf16 v[160:163], v[168:171], v[16:19], v[160:163]
  s_waitcnt lgkmcnt(11)
  v_mfma_f32_32x32x16_bf16 v[144:159], v[36:39], v[8:11], v[144:159]
  ds_read_b64_tr_b16 v[60:61], v202 offset:39936
  ds_read_b64_tr_b16 v[62:63], v202 offset:40704
  s_add_u32 m0, s66, 115712
  s_add_u32 s50, s63, 786432
  buffer_load_dwordx4 v223, s[20:23], s50 offen lds
  v_mfma_f32_16x16x32_bf16 v[164:167], v[168:171], v[20:23], v[164:167]
  s_waitcnt lgkmcnt(10)
  v_mfma_f32_32x32x16_bf16 v[64:79], v[40:43], v[12:15], v[64:79]
  ds_read_b128 v[8:11], v186 offset:49152
  ds_read_b64_tr_b16 v[16:17], v200 offset:30720
  ds_read_b64_tr_b16 v[18:19], v200 offset:31488
  s_waitcnt lgkmcnt(11)
  v_mfma_f32_32x32x16_bf16 v[80:95], v[44:47], v[12:15], v[80:95]
  ds_read_b64_tr_b16 v[20:21], v200 offset:43008
  ds_read_b64_tr_b16 v[22:23], v200 offset:43776
  s_add_u32 m0, s66, 116736
  s_add_u32 s50, s63, 786432
  buffer_load_dwordx4 v224, s[20:23], s50 offen lds
  s_waitcnt lgkmcnt(11)
  v_mfma_f32_32x32x16_bf16 v[96:111], v[48:51], v[12:15], v[96:111]
  ds_read_b64_tr_b16 v[24:25], v201 offset:30720
  ds_read_b64_tr_b16 v[26:27], v201 offset:31488
  s_waitcnt lgkmcnt(11)
  v_mfma_f32_32x32x16_bf16 v[112:127], v[52:55], v[12:15], v[112:127]
  ds_read_b64_tr_b16 v[28:29], v201 offset:43008
  ds_read_b64_tr_b16 v[30:31], v201 offset:43776
  s_add_u32 m0, s66, 126976
  s_add_u32 s50, s63, 786432
  buffer_load_dwordx4 v222, s[24:27], s50 offen lds
  s_waitcnt lgkmcnt(11)
  v_mfma_f32_32x32x16_bf16 v[128:143], v[56:59], v[12:15], v[128:143]
  ds_read_b64_tr_b16 v[32:33], v202 offset:30720
  ds_read_b64_tr_b16 v[34:35], v202 offset:31488
  v_mfma_f32_16x16x32_bf16 v[160:163], v[168:171], v[40:43], v[160:163]
  s_waitcnt lgkmcnt(11)
  v_mfma_f32_32x32x16_bf16 v[144:159], v[60:63], v[12:15], v[144:159]
  ds_read_b64_tr_b16 v[36:37], v202 offset:43008
  ds_read_b64_tr_b16 v[38:39], v202 offset:43776
  s_add_u32 m0, s66, 128000
  s_add_u32 s50, s63, 786432
  buffer_load_dwordx4 v223, s[24:27], s50 offen lds
  v_mfma_f32_16x16x32_bf16 v[164:167], v[168:171], v[44:47], v[164:167]
  s_waitcnt lgkmcnt(10)
  v_mfma_f32_32x32x16_bf16 v[64:79], v[16:19], v[8:11], v[64:79]
  ds_read_b128 v[12:15], v187 offset:49152
  ds_read_b64_tr_b16 v[40:41], v200 offset:33792
  ds_read_b64_tr_b16 v[42:43], v200 offset:34560
  s_waitcnt lgkmcnt(11)
  v_mfma_f32_32x32x16_bf16 v[80:95], v[20:23], v[8:11], v[80:95]
  ds_read_b64_tr_b16 v[44:45], v200 offset:46080
  ds_read_b64_tr_b16 v[46:47], v200 offset:46848
  s_add_u32 m0, s66, 129024
  s_add_u32 s50, s63, 786432
  buffer_load_dwordx4 v224, s[24:27], s50 offen lds
  s_waitcnt lgkmcnt(11)
  v_mfma_f32_32x32x16_bf16 v[96:111], v[24:27], v[8:11], v[96:111]
  ds_read_b64_tr_b16 v[48:49], v201 offset:33792
  ds_read_b64_tr_b16 v[50:51], v201 offset:34560
  s_waitcnt lgkmcnt(11)
  v_mfma_f32_32x32x16_bf16 v[112:127], v[28:31], v[8:11], v[112:127]
  ds_read_b64_tr_b16 v[52:53], v201 offset:46080
  ds_read_b64_tr_b16 v[54:55], v201 offset:46848
  s_waitcnt lgkmcnt(11)
  v_mfma_f32_32x32x16_bf16 v[128:143], v[32:35], v[8:11], v[128:143]
  ds_read_b64_tr_b16 v[56:57], v202 offset:33792
  ds_read_b64_tr_b16 v[58:59], v202 offset:34560
  v_mfma_f32_16x16x32_bf16 v[160:163], v[168:171], v[16:19], v[160:163]
  s_waitcnt lgkmcnt(11)
  v_mfma_f32_32x32x16_bf16 v[144:159], v[36:39], v[8:11], v[144:159]
  ds_read_b64_tr_b16 v[60:61], v202 offset:46080
  ds_read_b64_tr_b16 v[62:63], v202 offset:46848
  v_mfma_f32_16x16x32_bf16 v[164:167], v[168:171], v[20:23], v[164:167]
  s_waitcnt vmcnt(20)
  s_waitcnt lgkmcnt(0)
  s_barrier
  v_mfma_f32_32x32x16_bf16 v[64:79], v[40:43], v[12:15], v[64:79]
  ds_read_b128 v[8:11], v184 offset:32768
  ds_read_b64_tr_b16 v[16:17], v200 offset:0
  ds_read_b64_tr_b16 v[18:19], v200 offset:768
  v_mfma_f32_32x32x16_bf16 v[80:95], v[44:47], v[12:15], v[80:95]
  ds_read_b64_tr_b16 v[20:21], v200 offset:12288
  ds_read_b64_tr_b16 v[22:23], v200 offset:13056
  v_mfma_f32_32x32x16_bf16 v[96:111], v[48:51], v[12:15], v[96:111]
  ds_read_b64_tr_b16 v[24:25], v201 offset:0
  ds_read_b64_tr_b16 v[26:27], v201 offset:768
  v_mfma_f32_32x32x16_bf16 v[112:127], v[52:55], v[12:15], v[112:127]
  ds_read_b64_tr_b16 v[28:29], v201 offset:12288
  ds_read_b64_tr_b16 v[30:31], v201 offset:13056
  v_mfma_f32_32x32x16_bf16 v[128:143], v[56:59], v[12:15], v[128:143]
  ds_read_b64_tr_b16 v[32:33], v202 offset:0
  ds_read_b64_tr_b16 v[34:35], v202 offset:768
  v_mfma_f32_16x16x32_bf16 v[160:163], v[168:171], v[40:43], v[160:163]
  v_mfma_f32_32x32x16_bf16 v[144:159], v[60:63], v[12:15], v[144:159]
  ds_read_b64_tr_b16 v[36:37], v202 offset:12288
  ds_read_b64_tr_b16 v[38:39], v202 offset:13056
  v_mfma_f32_16x16x32_bf16 v[164:167], v[168:171], v[44:47], v[164:167]
  s_waitcnt lgkmcnt(10)
  v_mfma_f32_32x32x16_bf16 v[64:79], v[16:19], v[8:11], v[64:79]
  ds_read_b128 v[12:15], v185 offset:32768
  ds_read_b64_tr_b16 v[40:41], v200 offset:3072
  ds_read_b64_tr_b16 v[42:43], v200 offset:3840
  s_waitcnt lgkmcnt(11)
  v_mfma_f32_32x32x16_bf16 v[80:95], v[20:23], v[8:11], v[80:95]
  ds_read_b64_tr_b16 v[44:45], v200 offset:15360
  ds_read_b64_tr_b16 v[46:47], v200 offset:16128
  s_waitcnt lgkmcnt(11)
  v_mfma_f32_32x32x16_bf16 v[96:111], v[24:27], v[8:11], v[96:111]
  ds_read_b64_tr_b16 v[48:49], v201 offset:3072
  ds_read_b64_tr_b16 v[50:51], v201 offset:3840
  s_waitcnt lgkmcnt(11)
  v_mfma_f32_32x32x16_bf16 v[112:127], v[28:31], v[8:11], v[112:127]
  ds_read_b64_tr_b16 v[52:53], v201 offset:15360
  ds_read_b64_tr_b16 v[54:55], v201 offset:16128
  s_waitcnt lgkmcnt(11)
  v_mfma_f32_32x32x16_bf16 v[128:143], v[32:35], v[8:11], v[128:143]
  ds_read_b64_tr_b16 v[56:57], v202 offset:3072
  ds_read_b64_tr_b16 v[58:59], v202 offset:3840
  v_mfma_f32_16x16x32_bf16 v[160:163], v[168:171], v[16:19], v[160:163]
  s_waitcnt lgkmcnt(11)
  v_mfma_f32_32x32x16_bf16 v[144:159], v[36:39], v[8:11], v[144:159]
  ds_read_b64_tr_b16 v[60:61], v202 offset:15360
  ds_read_b64_tr_b16 v[62:63], v202 offset:16128
  v_mfma_f32_16x16x32_bf16 v[164:167], v[168:171], v[20:23], v[164:167]
  s_waitcnt lgkmcnt(10)
  v_mfma_f32_32x32x16_bf16 v[64:79], v[40:43], v[12:15], v[64:79]
  ds_read_b128 v[8:11], v186 offset:32768
  ds_read_b64_tr_b16 v[16:17], v200 offset:6144
  ds_read_b64_tr_b16 v[18:19], v200 offset:6912
  s_waitcnt lgkmcnt(11)
  v_mfma_f32_32x32x16_bf16 v[80:95], v[44:47], v[12:15], v[80:95]
  ds_read_b64_tr_b16 v[20:21], v200 offset:18432
  ds_read_b64_tr_b16 v[22:23], v200 offset:19200
  s_waitcnt lgkmcnt(11)
  v_mfma_f32_32x32x16_bf16 v[96:111], v[48:51], v[12:15], v[96:111]
  ds_read_b64_tr_b16 v[24:25], v201 offset:6144
  ds_read_b64_tr_b16 v[26:27], v201 offset:6912
  s_waitcnt lgkmcnt(11)
  v_mfma_f32_32x32x16_bf16 v[112:127], v[52:55], v[12:15], v[112:127]
  ds_read_b64_tr_b16 v[28:29], v201 offset:18432
  ds_read_b64_tr_b16 v[30:31], v201 offset:19200
  s_waitcnt lgkmcnt(11)
  v_mfma_f32_32x32x16_bf16 v[128:143], v[56:59], v[12:15], v[128:143]
  ds_read_b64_tr_b16 v[32:33], v202 offset:6144
  ds_read_b64_tr_b16 v[34:35], v202 offset:6912
  v_mfma_f32_16x16x32_bf16 v[160:163], v[168:171], v[40:43], v[160:163]
  s_waitcnt lgkmcnt(11)
  v_mfma_f32_32x32x16_bf16 v[144:159], v[60:63], v[12:15], v[144:159]
  ds_read_b64_tr_b16 v[36:37], v202 offset:18432
  ds_read_b64_tr_b16 v[38:39], v202 offset:19200
  v_mfma_f32_16x16x32_bf16 v[164:167], v[168:171], v[44:47], v[164:167]
  s_waitcnt lgkmcnt(10)
  v_mfma_f32_32x32x16_bf16 v[64:79], v[16:19], v[8:11], v[64:79]
  ds_read_b128 v[12:15], v187 offset:32768
  ds_read_b64_tr_b16 v[40:41], v200 offset:9216
  ds_read_b64_tr_b16 v[42:43], v200 offset:9984
  s_waitcnt lgkmcnt(11)
  v_mfma_f32_32x32x16_bf16 v[80:95], v[20:23], v[8:11], v[80:95]
  ds_read_b64_tr_b16 v[44:45], v200 offset:21504
  ds_read_b64_tr_b16 v[46:47], v200 offset:22272
  s_waitcnt lgkmcnt(11)
  v_mfma_f32_32x32x16_bf16 v[96:111], v[24:27], v[8:11], v[96:111]
  ds_read_b64_tr_b16 v[48:49], v201 offset:9216
  ds_read_b64_tr_b16 v[50:51], v201 offset:9984
  s_waitcnt lgkmcnt(11)
  v_mfma_f32_32x32x16_bf16 v[112:127], v[28:31], v[8:11], v[112:127]
  ds_read_b64_tr_b16 v[52:53], v201 offset:21504
  ds_read_b64_tr_b16 v[54:55], v201 offset:22272
  s_waitcnt lgkmcnt(11)
  v_mfma_f32_32x32x16_bf16 v[128:143], v[32:35], v[8:11], v[128:143]
  ds_read_b64_tr_b16 v[56:57], v202 offset:9216
  ds_read_b64_tr_b16 v[58:59], v202 offset:9984
  v_mfma_f32_16x16x32_bf16 v[160:163], v[168:171], v[16:19], v[160:163]
  s_waitcnt lgkmcnt(11)
  v_mfma_f32_32x32x16_bf16 v[144:159], v[36:39], v[8:11], v[144:159]
  ds_read_b64_tr_b16 v[60:61], v202 offset:21504
  ds_read_b64_tr_b16 v[62:63], v202 offset:22272
  v_mfma_f32_16x16x32_bf16 v[164:167], v[168:171], v[20:23], v[164:167]
  s_waitcnt vmcnt(10)
  s_waitcnt lgkmcnt(0)
  s_barrier
  v_mfma_f32_32x32x16_bf16 v[64:79], v[40:43], v[12:15], v[64:79]
  ds_read_b128 v[8:11], v184 offset:16384
  ds_read_b64_tr_b16 v[16:17], v203 offset:24576
  ds_read_b64_tr_b16 v[18:19], v203 offset:25344
  v_mfma_f32_32x32x16_bf16 v[80:95], v[44:47], v[12:15], v[80:95]
  ds_read_b64_tr_b16 v[20:21], v203 offset:36864
  ds_read_b64_tr_b16 v[22:23], v203 offset:37632
  v_mfma_f32_32x32x16_bf16 v[96:111], v[48:51], v[12:15], v[96:111]
  ds_read_b64_tr_b16 v[24:25], v204 offset:24576
  ds_read_b64_tr_b16 v[26:27], v204 offset:25344
  v_mfma_f32_32x32x16_bf16 v[112:127], v[52:55], v[12:15], v[112:127]
  ds_read_b64_tr_b16 v[28:29], v204 offset:36864
  ds_read_b64_tr_b16 v[30:31], v204 offset:37632
  v_mfma_f32_32x32x16_bf16 v[128:143], v[56:59], v[12:15], v[128:143]
  ds_read_b64_tr_b16 v[32:33], v205 offset:24576
  ds_read_b64_tr_b16 v[34:35], v205 offset:25344
  v_mfma_f32_16x16x32_bf16 v[160:163], v[168:171], v[40:43], v[160:163]
  v_mfma_f32_32x32x16_bf16 v[144:159], v[60:63], v[12:15], v[144:159]
  ds_read_b64_tr_b16 v[36:37], v205 offset:36864
  ds_read_b64_tr_b16 v[38:39], v205 offset:37632
  v_mfma_f32_16x16x32_bf16 v[164:167], v[168:171], v[44:47], v[164:167]
  s_waitcnt lgkmcnt(10)
  v_mfma_f32_32x32x16_bf16 v[64:79], v[16:19], v[8:11], v[64:79]
  ds_read_b128 v[12:15], v185 offset:16384
  ds_read_b64_tr_b16 v[40:41], v203 offset:27648
  ds_read_b64_tr_b16 v[42:43], v203 offset:28416
  s_waitcnt lgkmcnt(11)
  v_mfma_f32_32x32x16_bf16 v[80:95], v[20:23], v[8:11], v[80:95]
  ds_read_b64_tr_b16 v[44:45], v203 offset:39936
  ds_read_b64_tr_b16 v[46:47], v203 offset:40704
  s_waitcnt lgkmcnt(11)
  v_mfma_f32_32x32x16_bf16 v[96:111], v[24:27], v[8:11], v[96:111]
  ds_read_b64_tr_b16 v[48:49], v204 offset:27648
  ds_read_b64_tr_b16 v[50:51], v204 offset:28416
  s_waitcnt lgkmcnt(11)
  v_mfma_f32_32x32x16_bf16 v[112:127], v[28:31], v[8:11], v[112:127]
  ds_read_b64_tr_b16 v[52:53], v204 offset:39936
  ds_read_b64_tr_b16 v[54:55], v204 offset:40704
  s_waitcnt lgkmcnt(11)
  v_mfma_f32_32x32x16_bf16 v[128:143], v[32:35], v[8:11], v[128:143]
  ds_read_b64_tr_b16 v[56:57], v205 offset:27648
  ds_read_b64_tr_b16 v[58:59], v205 offset:28416
  v_mfma_f32_16x16x32_bf16 v[160:163], v[168:171], v[16:19], v[160:163]
  s_waitcnt lgkmcnt(11)
  v_mfma_f32_32x32x16_bf16 v[144:159], v[36:39], v[8:11], v[144:159]
  ds_read_b64_tr_b16 v[60:61], v205 offset:39936
  ds_read_b64_tr_b16 v[62:63], v205 offset:40704
  v_mfma_f32_16x16x32_bf16 v[164:167], v[168:171], v[20:23], v[164:167]
  s_waitcnt lgkmcnt(10)
  v_mfma_f32_32x32x16_bf16 v[64:79], v[40:43], v[12:15], v[64:79]
  ds_read_b128 v[8:11], v186 offset:16384
  ds_read_b64_tr_b16 v[16:17], v203 offset:30720
  ds_read_b64_tr_b16 v[18:19], v203 offset:31488
  s_waitcnt lgkmcnt(11)
  v_mfma_f32_32x32x16_bf16 v[80:95], v[44:47], v[12:15], v[80:95]
  ds_read_b64_tr_b16 v[20:21], v203 offset:43008
  ds_read_b64_tr_b16 v[22:23], v203 offset:43776
  s_waitcnt lgkmcnt(11)
  v_mfma_f32_32x32x16_bf16 v[96:111], v[48:51], v[12:15], v[96:111]
  ds_read_b64_tr_b16 v[24:25], v204 offset:30720
  ds_read_b64_tr_b16 v[26:27], v204 offset:31488
  s_waitcnt lgkmcnt(11)
  v_mfma_f32_32x32x16_bf16 v[112:127], v[52:55], v[12:15], v[112:127]
  ds_read_b64_tr_b16 v[28:29], v204 offset:43008
  ds_read_b64_tr_b16 v[30:31], v204 offset:43776
  s_waitcnt lgkmcnt(11)
  v_mfma_f32_32x32x16_bf16 v[128:143], v[56:59], v[12:15], v[128:143]
  ds_read_b64_tr_b16 v[32:33], v205 offset:30720
  ds_read_b64_tr_b16 v[34:35], v205 offset:31488
  v_mfma_f32_16x16x32_bf16 v[160:163], v[168:171], v[40:43], v[160:163]
  s_waitcnt lgkmcnt(11)
  v_mfma_f32_32x32x16_bf16 v[144:159], v[60:63], v[12:15], v[144:159]
  ds_read_b64_tr_b16 v[36:37], v205 offset:43008
  ds_read_b64_tr_b16 v[38:39], v205 offset:43776
  v_mfma_f32_16x16x32_bf16 v[164:167], v[168:171], v[44:47], v[164:167]
  s_waitcnt lgkmcnt(10)
  v_mfma_f32_32x32x16_bf16 v[64:79], v[16:19], v[8:11], v[64:79]
  ds_read_b128 v[12:15], v187 offset:16384
  ds_read_b64_tr_b16 v[40:41], v203 offset:33792
  ds_read_b64_tr_b16 v[42:43], v203 offset:34560
  s_waitcnt lgkmcnt(11)
  v_mfma_f32_32x32x16_bf16 v[80:95], v[20:23], v[8:11], v[80:95]
  ds_read_b64_tr_b16 v[44:45], v203 offset:46080
  ds_read_b64_tr_b16 v[46:47], v203 offset:46848
  s_waitcnt lgkmcnt(11)
  v_mfma_f32_32x32x16_bf16 v[96:111], v[24:27], v[8:11], v[96:111]
  ds_read_b64_tr_b16 v[48:49], v204 offset:33792
  ds_read_b64_tr_b16 v[50:51], v204 offset:34560
  s_waitcnt lgkmcnt(11)
  v_mfma_f32_32x32x16_bf16 v[112:127], v[28:31], v[8:11], v[112:127]
  ds_read_b64_tr_b16 v[52:53], v204 offset:46080
  ds_read_b64_tr_b16 v[54:55], v204 offset:46848
  s_waitcnt lgkmcnt(11)
  v_mfma_f32_32x32x16_bf16 v[128:143], v[32:35], v[8:11], v[128:143]
  ds_read_b64_tr_b16 v[56:57], v205 offset:33792
  ds_read_b64_tr_b16 v[58:59], v205 offset:34560
  v_mfma_f32_16x16x32_bf16 v[160:163], v[168:171], v[16:19], v[160:163]
  s_waitcnt lgkmcnt(11)
  v_mfma_f32_32x32x16_bf16 v[144:159], v[36:39], v[8:11], v[144:159]
  ds_read_b64_tr_b16 v[60:61], v205 offset:46080
  ds_read_b64_tr_b16 v[62:63], v205 offset:46848
  v_mfma_f32_16x16x32_bf16 v[164:167], v[168:171], v[20:23], v[164:167]
  s_waitcnt vmcnt(0)
  s_waitcnt lgkmcnt(0)
  s_barrier
  v_mfma_f32_32x32x16_bf16 v[64:79], v[40:43], v[12:15], v[64:79]
  ds_read_b128 v[8:11], v184 offset:0
  ds_read_b64_tr_b16 v[16:17], v203 offset:0
  ds_read_b64_tr_b16 v[18:19], v203 offset:768
  v_mfma_f32_32x32x16_bf16 v[80:95], v[44:47], v[12:15], v[80:95]
  ds_read_b64_tr_b16 v[20:21], v203 offset:12288
  ds_read_b64_tr_b16 v[22:23], v203 offset:13056
  v_mfma_f32_32x32x16_bf16 v[96:111], v[48:51], v[12:15], v[96:111]
  ds_read_b64_tr_b16 v[24:25], v204 offset:0
  ds_read_b64_tr_b16 v[26:27], v204 offset:768
  v_mfma_f32_32x32x16_bf16 v[112:127], v[52:55], v[12:15], v[112:127]
  ds_read_b64_tr_b16 v[28:29], v204 offset:12288
  ds_read_b64_tr_b16 v[30:31], v204 offset:13056
  v_mfma_f32_32x32x16_bf16 v[128:143], v[56:59], v[12:15], v[128:143]
  ds_read_b64_tr_b16 v[32:33], v205 offset:0
  ds_read_b64_tr_b16 v[34:35], v205 offset:768
  v_mfma_f32_16x16x32_bf16 v[160:163], v[168:171], v[40:43], v[160:163]
  v_mfma_f32_32x32x16_bf16 v[144:159], v[60:63], v[12:15], v[144:159]
  ds_read_b64_tr_b16 v[36:37], v205 offset:12288
  ds_read_b64_tr_b16 v[38:39], v205 offset:13056
  v_mfma_f32_16x16x32_bf16 v[164:167], v[168:171], v[44:47], v[164:167]
  s_waitcnt lgkmcnt(10)
  v_mfma_f32_32x32x16_bf16 v[64:79], v[16:19], v[8:11], v[64:79]
  ds_read_b128 v[12:15], v185 offset:0
  ds_read_b64_tr_b16 v[40:41], v203 offset:3072
  ds_read_b64_tr_b16 v[42:43], v203 offset:3840
  s_waitcnt lgkmcnt(11)
  v_mfma_f32_32x32x16_bf16 v[80:95], v[20:23], v[8:11], v[80:95]
  ds_read_b64_tr_b16 v[44:45], v203 offset:15360
  ds_read_b64_tr_b16 v[46:47], v203 offset:16128
  s_waitcnt lgkmcnt(11)
  v_mfma_f32_32x32x16_bf16 v[96:111], v[24:27], v[8:11], v[96:111]
  ds_read_b64_tr_b16 v[48:49], v204 offset:3072
  ds_read_b64_tr_b16 v[50:51], v204 offset:3840
  s_waitcnt lgkmcnt(11)
  v_mfma_f32_32x32x16_bf16 v[112:127], v[28:31], v[8:11], v[112:127]
  ds_read_b64_tr_b16 v[52:53], v204 offset:15360
  ds_read_b64_tr_b16 v[54:55], v204 offset:16128
  s_waitcnt lgkmcnt(11)
  v_mfma_f32_32x32x16_bf16 v[128:143], v[32:35], v[8:11], v[128:143]
  ds_read_b64_tr_b16 v[56:57], v205 offset:3072
  ds_read_b64_tr_b16 v[58:59], v205 offset:3840
  v_mfma_f32_16x16x32_bf16 v[160:163], v[168:171], v[16:19], v[160:163]
  s_waitcnt lgkmcnt(11)
  v_mfma_f32_32x32x16_bf16 v[144:159], v[36:39], v[8:11], v[144:159]
  ds_read_b64_tr_b16 v[60:61], v205 offset:15360
  ds_read_b64_tr_b16 v[62:63], v205 offset:16128
  v_mfma_f32_16x16x32_bf16 v[164:167], v[168:171], v[20:23], v[164:167]
  s_waitcnt lgkmcnt(10)
  v_mfma_f32_32x32x16_bf16 v[64:79], v[40:43], v[12:15], v[64:79]
  ds_read_b128 v[8:11], v186 offset:0
  ds_read_b64_tr_b16 v[16:17], v203 offset:6144
  ds_read_b64_tr_b16 v[18:19], v203 offset:6912
  s_waitcnt lgkmcnt(11)
  v_mfma_f32_32x32x16_bf16 v[80:95], v[44:47], v[12:15], v[80:95]
  ds_read_b64_tr_b16 v[20:21], v203 offset:18432
  ds_read_b64_tr_b16 v[22:23], v203 offset:19200
  s_waitcnt lgkmcnt(11)
  v_mfma_f32_32x32x16_bf16 v[96:111], v[48:51], v[12:15], v[96:111]
  ds_read_b64_tr_b16 v[24:25], v204 offset:6144
  ds_read_b64_tr_b16 v[26:27], v204 offset:6912
  s_waitcnt lgkmcnt(11)
  v_mfma_f32_32x32x16_bf16 v[112:127], v[52:55], v[12:15], v[112:127]
  ds_read_b64_tr_b16 v[28:29], v204 offset:18432
  ds_read_b64_tr_b16 v[30:31], v204 offset:19200
  s_waitcnt lgkmcnt(11)
  v_mfma_f32_32x32x16_bf16 v[128:143], v[56:59], v[12:15], v[128:143]
  ds_read_b64_tr_b16 v[32:33], v205 offset:6144
  ds_read_b64_tr_b16 v[34:35], v205 offset:6912
  v_mfma_f32_16x16x32_bf16 v[160:163], v[168:171], v[40:43], v[160:163]
  s_waitcnt lgkmcnt(11)
  v_mfma_f32_32x32x16_bf16 v[144:159], v[60:63], v[12:15], v[144:159]
  ds_read_b64_tr_b16 v[36:37], v205 offset:18432
  ds_read_b64_tr_b16 v[38:39], v205 offset:19200
  v_mfma_f32_16x16x32_bf16 v[164:167], v[168:171], v[44:47], v[164:167]
  s_waitcnt lgkmcnt(10)
  v_mfma_f32_32x32x16_bf16 v[64:79], v[16:19], v[8:11], v[64:79]
  ds_read_b128 v[12:15], v187 offset:0
  ds_read_b64_tr_b16 v[40:41], v203 offset:9216
  ds_read_b64_tr_b16 v[42:43], v203 offset:9984
  s_waitcnt lgkmcnt(11)
  v_mfma_f32_32x32x16_bf16 v[80:95], v[20:23], v[8:11], v[80:95]
  ds_read_b64_tr_b16 v[44:45], v203 offset:21504
  ds_read_b64_tr_b16 v[46:47], v203 offset:22272
  s_waitcnt lgkmcnt(11)
  v_mfma_f32_32x32x16_bf16 v[96:111], v[24:27], v[8:11], v[96:111]
  ds_read_b64_tr_b16 v[48:49], v204 offset:9216
  ds_read_b64_tr_b16 v[50:51], v204 offset:9984
  s_waitcnt lgkmcnt(11)
  v_mfma_f32_32x32x16_bf16 v[112:127], v[28:31], v[8:11], v[112:127]
  ds_read_b64_tr_b16 v[52:53], v204 offset:21504
  ds_read_b64_tr_b16 v[54:55], v204 offset:22272
  s_waitcnt lgkmcnt(11)
  v_mfma_f32_32x32x16_bf16 v[128:143], v[32:35], v[8:11], v[128:143]
  ds_read_b64_tr_b16 v[56:57], v205 offset:9216
  ds_read_b64_tr_b16 v[58:59], v205 offset:9984
  v_mfma_f32_16x16x32_bf16 v[160:163], v[168:171], v[16:19], v[160:163]
  s_waitcnt lgkmcnt(11)
  v_mfma_f32_32x32x16_bf16 v[144:159], v[36:39], v[8:11], v[144:159]
  ds_read_b64_tr_b16 v[60:61], v205 offset:21504
  ds_read_b64_tr_b16 v[62:63], v205 offset:22272
  v_mfma_f32_16x16x32_bf16 v[164:167], v[168:171], v[20:23], v[164:167]
  s_waitcnt lgkmcnt(0)
  s_barrier
  v_mfma_f32_32x32x16_bf16 v[64:79], v[40:43], v[12:15], v[64:79]
  ds_read_b128 v[8:11], v184 offset:49152
  ds_read_b64_tr_b16 v[16:17], v200 offset:24576
  ds_read_b64_tr_b16 v[18:19], v200 offset:25344
  v_mfma_f32_32x32x16_bf16 v[80:95], v[44:47], v[12:15], v[80:95]
  ds_read_b64_tr_b16 v[20:21], v200 offset:36864
  ds_read_b64_tr_b16 v[22:23], v200 offset:37632
  v_mfma_f32_32x32x16_bf16 v[96:111], v[48:51], v[12:15], v[96:111]
  ds_read_b64_tr_b16 v[24:25], v201 offset:24576
  ds_read_b64_tr_b16 v[26:27], v201 offset:25344
  v_mfma_f32_32x32x16_bf16 v[112:127], v[52:55], v[12:15], v[112:127]
  ds_read_b64_tr_b16 v[28:29], v201 offset:36864
  ds_read_b64_tr_b16 v[30:31], v201 offset:37632
  v_mfma_f32_32x32x16_bf16 v[128:143], v[56:59], v[12:15], v[128:143]
  ds_read_b64_tr_b16 v[32:33], v202 offset:24576
  ds_read_b64_tr_b16 v[34:35], v202 offset:25344
  v_mfma_f32_16x16x32_bf16 v[160:163], v[168:171], v[40:43], v[160:163]
  v_mfma_f32_32x32x16_bf16 v[144:159], v[60:63], v[12:15], v[144:159]
  ds_read_b64_tr_b16 v[36:37], v202 offset:36864
  ds_read_b64_tr_b16 v[38:39], v202 offset:37632
  v_mfma_f32_16x16x32_bf16 v[164:167], v[168:171], v[44:47], v[164:167]
  s_waitcnt lgkmcnt(10)
  v_mfma_f32_32x32x16_bf16 v[64:79], v[16:19], v[8:11], v[64:79]
  ds_read_b128 v[12:15], v185 offset:49152
  ds_read_b64_tr_b16 v[40:41], v200 offset:27648
  ds_read_b64_tr_b16 v[42:43], v200 offset:28416
  s_waitcnt lgkmcnt(11)
  v_mfma_f32_32x32x16_bf16 v[80:95], v[20:23], v[8:11], v[80:95]
  ds_read_b64_tr_b16 v[44:45], v200 offset:39936
  ds_read_b64_tr_b16 v[46:47], v200 offset:40704
  s_waitcnt lgkmcnt(11)
  v_mfma_f32_32x32x16_bf16 v[96:111], v[24:27], v[8:11], v[96:111]
  ds_read_b64_tr_b16 v[48:49], v201 offset:27648
  ds_read_b64_tr_b16 v[50:51], v201 offset:28416
  s_waitcnt lgkmcnt(11)
  v_mfma_f32_32x32x16_bf16 v[112:127], v[28:31], v[8:11], v[112:127]
  ds_read_b64_tr_b16 v[52:53], v201 offset:39936
  ds_read_b64_tr_b16 v[54:55], v201 offset:40704
  s_waitcnt lgkmcnt(11)
  v_mfma_f32_32x32x16_bf16 v[128:143], v[32:35], v[8:11], v[128:143]
  ds_read_b64_tr_b16 v[56:57], v202 offset:27648
  ds_read_b64_tr_b16 v[58:59], v202 offset:28416
  v_mfma_f32_16x16x32_bf16 v[160:163], v[168:171], v[16:19], v[160:163]
  s_waitcnt lgkmcnt(11)
  v_mfma_f32_32x32x16_bf16 v[144:159], v[36:39], v[8:11], v[144:159]
  ds_read_b64_tr_b16 v[60:61], v202 offset:39936
  ds_read_b64_tr_b16 v[62:63], v202 offset:40704
  v_mfma_f32_16x16x32_bf16 v[164:167], v[168:171], v[20:23], v[164:167]
  s_waitcnt lgkmcnt(10)
  v_mfma_f32_32x32x16_bf16 v[64:79], v[40:43], v[12:15], v[64:79]
  ds_read_b128 v[8:11], v186 offset:49152
  ds_read_b64_tr_b16 v[16:17], v200 offset:30720
  ds_read_b64_tr_b16 v[18:19], v200 offset:31488
  s_waitcnt lgkmcnt(11)
  v_mfma_f32_32x32x16_bf16 v[80:95], v[44:47], v[12:15], v[80:95]
  ds_read_b64_tr_b16 v[20:21], v200 offset:43008
  ds_read_b64_tr_b16 v[22:23], v200 offset:43776
  s_waitcnt lgkmcnt(11)
  v_mfma_f32_32x32x16_bf16 v[96:111], v[48:51], v[12:15], v[96:111]
  ds_read_b64_tr_b16 v[24:25], v201 offset:30720
  ds_read_b64_tr_b16 v[26:27], v201 offset:31488
  s_waitcnt lgkmcnt(11)
  v_mfma_f32_32x32x16_bf16 v[112:127], v[52:55], v[12:15], v[112:127]
  ds_read_b64_tr_b16 v[28:29], v201 offset:43008
  ds_read_b64_tr_b16 v[30:31], v201 offset:43776
  s_waitcnt lgkmcnt(11)
  v_mfma_f32_32x32x16_bf16 v[128:143], v[56:59], v[12:15], v[128:143]
  ds_read_b64_tr_b16 v[32:33], v202 offset:30720
  ds_read_b64_tr_b16 v[34:35], v202 offset:31488
  v_mfma_f32_16x16x32_bf16 v[160:163], v[168:171], v[40:43], v[160:163]
  s_waitcnt lgkmcnt(11)
  v_mfma_f32_32x32x16_bf16 v[144:159], v[60:63], v[12:15], v[144:159]
  ds_read_b64_tr_b16 v[36:37], v202 offset:43008
  ds_read_b64_tr_b16 v[38:39], v202 offset:43776
  v_mfma_f32_16x16x32_bf16 v[164:167], v[168:171], v[44:47], v[164:167]
  s_waitcnt lgkmcnt(10)
  v_mfma_f32_32x32x16_bf16 v[64:79], v[16:19], v[8:11], v[64:79]
  ds_read_b128 v[12:15], v187 offset:49152
  ds_read_b64_tr_b16 v[40:41], v200 offset:33792
  ds_read_b64_tr_b16 v[42:43], v200 offset:34560
  s_waitcnt lgkmcnt(11)
  v_mfma_f32_32x32x16_bf16 v[80:95], v[20:23], v[8:11], v[80:95]
  ds_read_b64_tr_b16 v[44:45], v200 offset:46080
  ds_read_b64_tr_b16 v[46:47], v200 offset:46848
  s_waitcnt lgkmcnt(11)
  v_mfma_f32_32x32x16_bf16 v[96:111], v[24:27], v[8:11], v[96:111]
  ds_read_b64_tr_b16 v[48:49], v201 offset:33792
  ds_read_b64_tr_b16 v[50:51], v201 offset:34560
  s_waitcnt lgkmcnt(11)
  v_mfma_f32_32x32x16_bf16 v[112:127], v[28:31], v[8:11], v[112:127]
  ds_read_b64_tr_b16 v[52:53], v201 offset:46080
  ds_read_b64_tr_b16 v[54:55], v201 offset:46848
  s_waitcnt lgkmcnt(11)
  v_mfma_f32_32x32x16_bf16 v[128:143], v[32:35], v[8:11], v[128:143]
  ds_read_b64_tr_b16 v[56:57], v202 offset:33792
  ds_read_b64_tr_b16 v[58:59], v202 offset:34560
  v_mfma_f32_16x16x32_bf16 v[160:163], v[168:171], v[16:19], v[160:163]
  s_waitcnt lgkmcnt(11)
  v_mfma_f32_32x32x16_bf16 v[144:159], v[36:39], v[8:11], v[144:159]
  ds_read_b64_tr_b16 v[60:61], v202 offset:46080
  ds_read_b64_tr_b16 v[62:63], v202 offset:46848
  v_mfma_f32_16x16x32_bf16 v[164:167], v[168:171], v[20:23], v[164:167]
  s_waitcnt lgkmcnt(0)
  s_barrier
  s_cmp_lg_u32 s38, 4
  s_cbranch_scc1 L_f1p_14
  s_mov_b32 s50, 28377088
  buffer_load_dword v225, v229, s[16:19], s50 offen sc1
  s_mov_b32 s50, 28385280
  buffer_load_dword v226, v229, s[16:19], s50 offen sc1
  s_mov_b32 s50, 28393472
  buffer_load_dword v227, v229, s[16:19], s50 offen sc1
  s_mov_b32 s50, 28401664
  buffer_load_dword v228, v229, s[16:19], s50 offen sc1
L_f1p_14:
  v_mfma_f32_32x32x16_bf16 v[64:79], v[40:43], v[12:15], v[64:79]
  ds_read_b128 v[8:11], v184 offset:32768
  ds_read_b64_tr_b16 v[16:17], v200 offset:0
  ds_read_b64_tr_b16 v[18:19], v200 offset:768
  v_mfma_f32_32x32x16_bf16 v[80:95], v[44:47], v[12:15], v[80:95]
  ds_read_b64_tr_b16 v[20:21], v200 offset:12288
  ds_read_b64_tr_b16 v[22:23], v200 offset:13056
  v_mfma_f32_32x32x16_bf16 v[96:111], v[48:51], v[12:15], v[96:111]
  ds_read_b64_tr_b16 v[24:25], v201 offset:0
  ds_read_b64_tr_b16 v[26:27], v201 offset:768
  v_mfma_f32_32x32x16_bf16 v[112:127], v[52:55], v[12:15], v[112:127]
  ds_read_b64_tr_b16 v[28:29], v201 offset:12288
  ds_read_b64_tr_b16 v[30:31], v201 offset:13056
  v_mfma_f32_32x32x16_bf16 v[128:143], v[56:59], v[12:15], v[128:143]
  ds_read_b64_tr_b16 v[32:33], v202 offset:0
  ds_read_b64_tr_b16 v[34:35], v202 offset:768
  v_mfma_f32_16x16x32_bf16 v[160:163], v[168:171], v[40:43], v[160:163]
  v_mfma_f32_32x32x16_bf16 v[144:159], v[60:63], v[12:15], v[144:159]
  ds_read_b64_tr_b16 v[36:37], v202 offset:12288
  ds_read_b64_tr_b16 v[38:39], v202 offset:13056
  v_mfma_f32_16x16x32_bf16 v[164:167], v[168:171], v[44:47], v[164:167]
  s_waitcnt lgkmcnt(10)
  v_mfma_f32_32x32x16_bf16 v[64:79], v[16:19], v[8:11], v[64:79]
  ds_read_b128 v[12:15], v185 offset:32768
  ds_read_b64_tr_b16 v[40:41], v200 offset:3072
  ds_read_b64_tr_b16 v[42:43], v200 offset:3840
  s_waitcnt lgkmcnt(11)
  v_mfma_f32_32x32x16_bf16 v[80:95], v[20:23], v[8:11], v[80:95]
  ds_read_b64_tr_b16 v[44:45], v200 offset:15360
  ds_read_b64_tr_b16 v[46:47], v200 offset:16128
  s_waitcnt lgkmcnt(11)
  v_mfma_f32_32x32x16_bf16 v[96:111], v[24:27], v[8:11], v[96:111]
  ds_read_b64_tr_b16 v[48:49], v201 offset:3072
  ds_read_b64_tr_b16 v[50:51], v201 offset:3840
  s_waitcnt lgkmcnt(11)
  v_mfma_f32_32x32x16_bf16 v[112:127], v[28:31], v[8:11], v[112:127]
  ds_read_b64_tr_b16 v[52:53], v201 offset:15360
  ds_read_b64_tr_b16 v[54:55], v201 offset:16128
  s_waitcnt lgkmcnt(11)
  v_mfma_f32_32x32x16_bf16 v[128:143], v[32:35], v[8:11], v[128:143]
  ds_read_b64_tr_b16 v[56:57], v202 offset:3072
  ds_read_b64_tr_b16 v[58:59], v202 offset:3840
  v_mfma_f32_16x16x32_bf16 v[160:163], v[168:171], v[16:19], v[160:163]
  s_waitcnt lgkmcnt(11)
  v_mfma_f32_32x32x16_bf16 v[144:159], v[36:39], v[8:11], v[144:159]
  ds_read_b64_tr_b16 v[60:61], v202 offset:15360
  ds_read_b64_tr_b16 v[62:63], v202 offset:16128
  v_mfma_f32_16x16x32_bf16 v[164:167], v[168:171], v[20:23], v[164:167]
  s_waitcnt lgkmcnt(10)
  v_mfma_f32_32x32x16_bf16 v[64:79], v[40:43], v[12:15], v[64:79]
  ds_read_b128 v[8:11], v186 offset:32768
  ds_read_b64_tr_b16 v[16:17], v200 offset:6144
  ds_read_b64_tr_b16 v[18:19], v200 offset:6912
  s_waitcnt lgkmcnt(11)
  v_mfma_f32_32x32x16_bf16 v[80:95], v[44:47], v[12:15], v[80:95]
  ds_read_b64_tr_b16 v[20:21], v200 offset:18432
  ds_read_b64_tr_b16 v[22:23], v200 offset:19200
  s_waitcnt lgkmcnt(11)
  v_mfma_f32_32x32x16_bf16 v[96:111], v[48:51], v[12:15], v[96:111]
  ds_read_b64_tr_b16 v[24:25], v201 offset:6144
  ds_read_b64_tr_b16 v[26:27], v201 offset:6912
  s_waitcnt lgkmcnt(11)
  v_mfma_f32_32x32x16_bf16 v[112:127], v[52:55], v[12:15], v[112:127]
  ds_read_b64_tr_b16 v[28:29], v201 offset:18432
  ds_read_b64_tr_b16 v[30:31], v201 offset:19200
  s_waitcnt lgkmcnt(11)
  v_mfma_f32_32x32x16_bf16 v[128:143], v[56:59], v[12:15], v[128:143]
  ds_read_b64_tr_b16 v[32:33], v202 offset:6144
  ds_read_b64_tr_b16 v[34:35], v202 offset:6912
  v_mfma_f32_16x16x32_bf16 v[160:163], v[168:171], v[40:43], v[160:163]
  s_waitcnt lgkmcnt(11)
  v_mfma_f32_32x32x16_bf16 v[144:159], v[60:63], v[12:15], v[144:159]
  ds_read_b64_tr_b16 v[36:37], v202 offset:18432
  ds_read_b64_tr_b16 v[38:39], v202 offset:19200
  v_mfma_f32_16x16x32_bf16 v[164:167], v[168:171], v[44:47], v[164:167]
  s_cmp_lg_u32 s38, 4
  s_cbranch_scc1 L_f1_15_ok
  s_mov_b32 s51, 0
L_f1_15:
  s_waitcnt vmcnt(0)
  v_xor_b32 v225, s58, v225
  v_xor_b32 v226, s58, v226
  v_xor_b32 v227, s58, v227
  v_xor_b32 v228, s58, v228
  v_or3_b32 v225, v225, v226, v227
  v_or_b32 v225, v225, v228
  v_cmp_ne_u32 vcc, 0, v225
  s_add_u32 s51, s51, 1
  s_nop 1
  s_cmp_eq_u64 vcc, 0
  s_cbranch_scc1 L_f1_15_ok
  s_cmp_ge_u32 s51, 0x20000
  s_cbranch_scc1 L_f1_15_ok
  s_sleep 8
  s_mov_b32 s50, 28377088
  buffer_load_dword v225, v229, s[16:19], s50 offen sc1
  s_mov_b32 s50, 28385280
  buffer_load_dword v226, v229, s[16:19], s50 offen sc1
  s_mov_b32 s50, 28393472
  buffer_load_dword v227, v229, s[16:19], s50 offen sc1
  s_mov_b32 s50, 28401664
  buffer_load_dword v228, v229, s[16:19], s50 offen sc1
  s_branch L_f1_15
L_f1_15_ok:
  s_waitcnt lgkmcnt(10)
  v_mfma_f32_32x32x16_bf16 v[64:79], v[16:19], v[8:11], v[64:79]
  ds_read_b128 v[12:15], v187 offset:32768
  ds_read_b64_tr_b16 v[40:41], v200 offset:9216
  ds_read_b64_tr_b16 v[42:43], v200 offset:9984
  s_waitcnt lgkmcnt(11)
  v_mfma_f32_32x32x16_bf16 v[80:95], v[20:23], v[8:11], v[80:95]
  ds_read_b64_tr_b16 v[44:45], v200 offset:21504
  ds_read_b64_tr_b16 v[46:47], v200 offset:22272
  s_waitcnt lgkmcnt(11)
  v_mfma_f32_32x32x16_bf16 v[96:111], v[24:27], v[8:11], v[96:111]
  ds_read_b64_tr_b16 v[48:49], v201 offset:9216
  ds_read_b64_tr_b16 v[50:51], v201 offset:9984
  s_waitcnt lgkmcnt(11)
  v_mfma_f32_32x32x16_bf16 v[112:127], v[28:31], v[8:11], v[112:127]
  ds_read_b64_tr_b16 v[52:53], v201 offset:21504
  ds_read_b64_tr_b16 v[54:55], v201 offset:22272
  s_waitcnt lgkmcnt(11)
  v_mfma_f32_32x32x16_bf16 v[128:143], v[32:35], v[8:11], v[128:143]
  ds_read_b64_tr_b16 v[56:57], v202 offset:9216
  ds_read_b64_tr_b16 v[58:59], v202 offset:9984
  v_mfma_f32_16x16x32_bf16 v[160:163], v[168:171], v[16:19], v[160:163]
  s_waitcnt lgkmcnt(11)
  v_mfma_f32_32x32x16_bf16 v[144:159], v[36:39], v[8:11], v[144:159]
  ds_read_b64_tr_b16 v[60:61], v202 offset:21504
  ds_read_b64_tr_b16 v[62:63], v202 offset:22272
  v_mfma_f32_16x16x32_bf16 v[164:167], v[168:171], v[20:23], v[164:167]
  s_waitcnt lgkmcnt(0)
  s_barrier
  v_mfma_f32_32x32x16_bf16 v[64:79], v[40:43], v[12:15], v[64:79]
  ds_read_b128 v[8:11], v184 offset:16384
  ds_read_b64_tr_b16 v[16:17], v203 offset:24576
  ds_read_b64_tr_b16 v[18:19], v203 offset:25344
  v_mfma_f32_32x32x16_bf16 v[80:95], v[44:47], v[12:15], v[80:95]
  ds_read_b64_tr_b16 v[20:21], v203 offset:36864
  ds_read_b64_tr_b16 v[22:23], v203 offset:37632
  v_mfma_f32_32x32x16_bf16 v[96:111], v[48:51], v[12:15], v[96:111]
  ds_read_b64_tr_b16 v[24:25], v204 offset:24576
  ds_read_b64_tr_b16 v[26:27], v204 offset:25344
  v_mfma_f32_32x32x16_bf16 v[112:127], v[52:55], v[12:15], v[112:127]
  ds_read_b64_tr_b16 v[28:29], v204 offset:36864
  ds_read_b64_tr_b16 v[30:31], v204 offset:37632
  v_mfma_f32_32x32x16_bf16 v[128:143], v[56:59], v[12:15], v[128:143]
  ds_read_b64_tr_b16 v[32:33], v205 offset:24576
  ds_read_b64_tr_b16 v[34:35], v205 offset:25344
  v_mfma_f32_16x16x32_bf16 v[160:163], v[168:171], v[40:43], v[160:163]
  v_mfma_f32_32x32x16_bf16 v[144:159], v[60:63], v[12:15], v[144:159]
  ds_read_b64_tr_b16 v[36:37], v205 offset:36864
  ds_read_b64_tr_b16 v[38:39], v205 offset:37632
  v_mfma_f32_16x16x32_bf16 v[164:167], v[168:171], v[44:47], v[164:167]
  s_waitcnt lgkmcnt(10)
  v_mfma_f32_32x32x16_bf16 v[64:79], v[16:19], v[8:11], v[64:79]
  ds_read_b128 v[12:15], v185 offset:16384
  ds_read_b64_tr_b16 v[40:41], v203 offset:27648
  ds_read_b64_tr_b16 v[42:43], v203 offset:28416
  s_waitcnt lgkmcnt(11)
  v_mfma_f32_32x32x16_bf16 v[80:95], v[20:23], v[8:11], v[80:95]
  ds_read_b64_tr_b16 v[44:45], v203 offset:39936
  ds_read_b64_tr_b16 v[46:47], v203 offset:40704
  s_waitcnt lgkmcnt(11)
  v_mfma_f32_32x32x16_bf16 v[96:111], v[24:27], v[8:11], v[96:111]
  ds_read_b64_tr_b16 v[48:49], v204 offset:27648
  ds_read_b64_tr_b16 v[50:51], v204 offset:28416
  s_waitcnt lgkmcnt(11)
  v_mfma_f32_32x32x16_bf16 v[112:127], v[28:31], v[8:11], v[112:127]
  ds_read_b64_tr_b16 v[52:53], v204 offset:39936
  ds_read_b64_tr_b16 v[54:55], v204 offset:40704
  s_waitcnt lgkmcnt(11)
  v_mfma_f32_32x32x16_bf16 v[128:143], v[32:35], v[8:11], v[128:143]
  ds_read_b64_tr_b16 v[56:57], v205 offset:27648
  ds_read_b64_tr_b16 v[58:59], v205 offset:28416
  v_mfma_f32_16x16x32_bf16 v[160:163], v[168:171], v[16:19], v[160:163]
  s_waitcnt lgkmcnt(11)
  v_mfma_f32_32x32x16_bf16 v[144:159], v[36:39], v[8:11], v[144:159]
  ds_read_b64_tr_b16 v[60:61], v205 offset:39936
  ds_read_b64_tr_b16 v[62:63], v205 offset:40704
  v_mfma_f32_16x16x32_bf16 v[164:167], v[168:171], v[20:23], v[164:167]
  s_waitcnt lgkmcnt(10)
  v_mfma_f32_32x32x16_bf16 v[64:79], v[40:43], v[12:15], v[64:79]
  ds_read_b128 v[8:11], v186 offset:16384
  ds_read_b64_tr_b16 v[16:17], v203 offset:30720
  ds_read_b64_tr_b16 v[18:19], v203 offset:31488
  s_waitcnt lgkmcnt(11)
  v_mfma_f32_32x32x16_bf16 v[80:95], v[44:47], v[12:15], v[80:95]
  ds_read_b64_tr_b16 v[20:21], v203 offset:43008
  ds_read_b64_tr_b16 v[22:23], v203 offset:43776
  s_waitcnt lgkmcnt(11)
  v_mfma_f32_32x32x16_bf16 v[96:111], v[48:51], v[12:15], v[96:111]
  ds_read_b64_tr_b16 v[24:25], v204 offset:30720
  ds_read_b64_tr_b16 v[26:27], v204 offset:31488
  s_waitcnt lgkmcnt(11)
  v_mfma_f32_32x32x16_bf16 v[112:127], v[52:55], v[12:15], v[112:127]
  ds_read_b64_tr_b16 v[28:29], v204 offset:43008
  ds_read_b64_tr_b16 v[30:31], v204 offset:43776
  s_waitcnt lgkmcnt(11)
  v_mfma_f32_32x32x16_bf16 v[128:143], v[56:59], v[12:15], v[128:143]
  ds_read_b64_tr_b16 v[32:33], v205 offset:30720
  ds_read_b64_tr_b16 v[34:35], v205 offset:31488
  v_mfma_f32_16x16x32_bf16 v[160:163], v[168:171], v[40:43], v[160:163]
  s_waitcnt lgkmcnt(11)
  v_mfma_f32_32x32x16_bf16 v[144:159], v[60:63], v[12:15], v[144:159]
  ds_read_b64_tr_b16 v[36:37], v205 offset:43008
  ds_read_b64_tr_b16 v[38:39], v205 offset:43776
  v_mfma_f32_16x16x32_bf16 v[164:167], v[168:171], v[44:47], v[164:167]
  s_waitcnt lgkmcnt(10)
  v_mfma_f32_32x32x16_bf16 v[64:79], v[16:19], v[8:11], v[64:79]
  ds_read_b128 v[12:15], v187 offset:16384
  ds_read_b64_tr_b16 v[40:41], v203 offset:33792
  ds_read_b64_tr_b16 v[42:43], v203 offset:34560
  s_waitcnt lgkmcnt(11)
  v_mfma_f32_32x32x16_bf16 v[80:95], v[20:23], v[8:11], v[80:95]
  ds_read_b64_tr_b16 v[44:45], v203 offset:46080
  ds_read_b64_tr_b16 v[46:47], v203 offset:46848
  s_waitcnt lgkmcnt(11)
  v_mfma_f32_32x32x16_bf16 v[96:111], v[24:27], v[8:11], v[96:111]
  ds_read_b64_tr_b16 v[48:49], v204 offset:33792
  ds_read_b64_tr_b16 v[50:51], v204 offset:34560
  s_waitcnt lgkmcnt(11)
  v_mfma_f32_32x32x16_bf16 v[112:127], v[28:31], v[8:11], v[112:127]
  ds_read_b64_tr_b16 v[52:53], v204 offset:46080
  ds_read_b64_tr_b16 v[54:55], v204 offset:46848
  s_waitcnt lgkmcnt(11)
  v_mfma_f32_32x32x16_bf16 v[128:143], v[32:35], v[8:11], v[128:143]
  ds_read_b64_tr_b16 v[56:57], v205 offset:33792
  ds_read_b64_tr_b16 v[58:59], v205 offset:34560
  v_mfma_f32_16x16x32_bf16 v[160:163], v[168:171], v[16:19], v[160:163]
  s_waitcnt lgkmcnt(11)
  v_mfma_f32_32x32x16_bf16 v[144:159], v[36:39], v[8:11], v[144:159]
  ds_read_b64_tr_b16 v[60:61], v205 offset:46080
  ds_read_b64_tr_b16 v[62:63], v205 offset:46848
  v_mfma_f32_16x16x32_bf16 v[164:167], v[168:171], v[20:23], v[164:167]
  s_waitcnt lgkmcnt(0)
  s_barrier
  v_mfma_f32_32x32x16_bf16 v[64:79], v[40:43], v[12:15], v[64:79]
  ds_read_b128 v[8:11], v184 offset:0
  ds_read_b64_tr_b16 v[16:17], v203 offset:0
  ds_read_b64_tr_b16 v[18:19], v203 offset:768
  v_mfma_f32_32x32x16_bf16 v[80:95], v[44:47], v[12:15], v[80:95]
  ds_read_b64_tr_b16 v[20:21], v203 offset:12288
  ds_read_b64_tr_b16 v[22:23], v203 offset:13056
  v_mfma_f32_32x32x16_bf16 v[96:111], v[48:51], v[12:15], v[96:111]
  ds_read_b64_tr_b16 v[24:25], v204 offset:0
  ds_read_b64_tr_b16 v[26:27], v204 offset:768
  v_mfma_f32_32x32x16_bf16 v[112:127], v[52:55], v[12:15], v[112:127]
  ds_read_b64_tr_b16 v[28:29], v204 offset:12288
  ds_read_b64_tr_b16 v[30:31], v204 offset:13056
  v_mfma_f32_32x32x16_bf16 v[128:143], v[56:59], v[12:15], v[128:143]
  ds_read_b64_tr_b16 v[32:33], v205 offset:0
  ds_read_b64_tr_b16 v[34:35], v205 offset:768
  v_mfma_f32_16x16x32_bf16 v[160:163], v[168:171], v[40:43], v[160:163]
  v_mfma_f32_32x32x16_bf16 v[144:159], v[60:63], v[12:15], v[144:159]
  ds_read_b64_tr_b16 v[36:37], v205 offset:12288
  ds_read_b64_tr_b16 v[38:39], v205 offset:13056
  v_mfma_f32_16x16x32_bf16 v[164:167], v[168:171], v[44:47], v[164:167]
  s_waitcnt lgkmcnt(10)
  v_mfma_f32_32x32x16_bf16 v[64:79], v[16:19], v[8:11], v[64:79]
  ds_read_b128 v[12:15], v185 offset:0
  ds_read_b64_tr_b16 v[40:41], v203 offset:3072
  ds_read_b64_tr_b16 v[42:43], v203 offset:3840
  s_waitcnt lgkmcnt(11)
  v_mfma_f32_32x32x16_bf16 v[80:95], v[20:23], v[8:11], v[80:95]
  ds_read_b64_tr_b16 v[44:45], v203 offset:15360
  ds_read_b64_tr_b16 v[46:47], v203 offset:16128
  s_waitcnt lgkmcnt(11)
  v_mfma_f32_32x32x16_bf16 v[96:111], v[24:27], v[8:11], v[96:111]
  ds_read_b64_tr_b16 v[48:49], v204 offset:3072
  ds_read_b64_tr_b16 v[50:51], v204 offset:3840
  s_waitcnt lgkmcnt(11)
  v_mfma_f32_32x32x16_bf16 v[112:127], v[28:31], v[8:11], v[112:127]
  ds_read_b64_tr_b16 v[52:53], v204 offset:15360
  ds_read_b64_tr_b16 v[54:55], v204 offset:16128
  s_waitcnt lgkmcnt(11)
  v_mfma_f32_32x32x16_bf16 v[128:143], v[32:35], v[8:11], v[128:143]
  ds_read_b64_tr_b16 v[56:57], v205 offset:3072
  ds_read_b64_tr_b16 v[58:59], v205 offset:3840
  v_mfma_f32_16x16x32_bf16 v[160:163], v[168:171], v[16:19], v[160:163]
  s_waitcnt lgkmcnt(11)
  v_mfma_f32_32x32x16_bf16 v[144:159], v[36:39], v[8:11], v[144:159]
  ds_read_b64_tr_b16 v[60:61], v205 offset:15360
  ds_read_b64_tr_b16 v[62:63], v205 offset:16128
  v_mfma_f32_16x16x32_bf16 v[164:167], v[168:171], v[20:23], v[164:167]
  s_waitcnt lgkmcnt(10)
  v_mfma_f32_32x32x16_bf16 v[64:79], v[40:43], v[12:15], v[64:79]
  ds_read_b128 v[8:11], v186 offset:0
  ds_read_b64_tr_b16 v[16:17], v203 offset:6144
  ds_read_b64_tr_b16 v[18:19], v203 offset:6912
  s_waitcnt lgkmcnt(11)
  v_mfma_f32_32x32x16_bf16 v[80:95], v[44:47], v[12:15], v[80:95]
  ds_read_b64_tr_b16 v[20:21], v203 offset:18432
  ds_read_b64_tr_b16 v[22:23], v203 offset:19200
  s_waitcnt lgkmcnt(11)
  v_mfma_f32_32x32x16_bf16 v[96:111], v[48:51], v[12:15], v[96:111]
  ds_read_b64_tr_b16 v[24:25], v204 offset:6144
  ds_read_b64_tr_b16 v[26:27], v204 offset:6912
  s_waitcnt lgkmcnt(11)
  v_mfma_f32_32x32x16_bf16 v[112:127], v[52:55], v[12:15], v[112:127]
  ds_read_b64_tr_b16 v[28:29], v204 offset:18432
  ds_read_b64_tr_b16 v[30:31], v204 offset:19200
  s_waitcnt lgkmcnt(11)
  v_mfma_f32_32x32x16_bf16 v[128:143], v[56:59], v[12:15], v[128:143]
  ds_read_b64_tr_b16 v[32:33], v205 offset:6144
  ds_read_b64_tr_b16 v[34:35], v205 offset:6912
  v_mfma_f32_16x16x32_bf16 v[160:163], v[168:171], v[40:43], v[160:163]
  s_waitcnt lgkmcnt(11)
  v_mfma_f32_32x32x16_bf16 v[144:159], v[60:63], v[12:15], v[144:159]
  ds_read_b64_tr_b16 v[36:37], v205 offset:18432
  ds_read_b64_tr_b16 v[38:39], v205 offset:19200
  v_mfma_f32_16x16x32_bf16 v[164:167], v[168:171], v[44:47], v[164:167]
  s_waitcnt lgkmcnt(10)
  v_mfma_f32_32x32x16_bf16 v[64:79], v[16:19], v[8:11], v[64:79]
  ds_read_b128 v[12:15], v187 offset:0
  ds_read_b64_tr_b16 v[40:41], v203 offset:9216
  ds_read_b64_tr_b16 v[42:43], v203 offset:9984
  s_waitcnt lgkmcnt(11)
  v_mfma_f32_32x32x16_bf16 v[80:95], v[20:23], v[8:11], v[80:95]
  ds_read_b64_tr_b16 v[44:45], v203 offset:21504
  ds_read_b64_tr_b16 v[46:47], v203 offset:22272
  s_waitcnt lgkmcnt(11)
  v_mfma_f32_32x32x16_bf16 v[96:111], v[24:27], v[8:11], v[96:111]
  ds_read_b64_tr_b16 v[48:49], v204 offset:9216
  ds_read_b64_tr_b16 v[50:51], v204 offset:9984
  s_waitcnt lgkmcnt(11)
  v_mfma_f32_32x32x16_bf16 v[112:127], v[28:31], v[8:11], v[112:127]
  ds_read_b64_tr_b16 v[52:53], v204 offset:21504
  ds_read_b64_tr_b16 v[54:55], v204 offset:22272
  s_waitcnt lgkmcnt(11)
  v_mfma_f32_32x32x16_bf16 v[128:143], v[32:35], v[8:11], v[128:143]
  ds_read_b64_tr_b16 v[56:57], v205 offset:9216
  ds_read_b64_tr_b16 v[58:59], v205 offset:9984
  v_mfma_f32_16x16x32_bf16 v[160:163], v[168:171], v[16:19], v[160:163]
  s_waitcnt lgkmcnt(11)
  v_mfma_f32_32x32x16_bf16 v[144:159], v[36:39], v[8:11], v[144:159]
  ds_read_b64_tr_b16 v[60:61], v205 offset:21504
  ds_read_b64_tr_b16 v[62:63], v205 offset:22272
  v_mfma_f32_16x16x32_bf16 v[164:167], v[168:171], v[20:23], v[164:167]
  s_waitcnt lgkmcnt(10)
  v_mfma_f32_32x32x16_bf16 v[64:79], v[40:43], v[12:15], v[64:79]
  s_waitcnt lgkmcnt(8)
  v_mfma_f32_32x32x16_bf16 v[80:95], v[44:47], v[12:15], v[80:95]
  s_waitcnt lgkmcnt(6)
  v_mfma_f32_32x32x16_bf16 v[96:111], v[48:51], v[12:15], v[96:111]
  s_waitcnt lgkmcnt(4)
  v_mfma_f32_32x32x16_bf16 v[112:127], v[52:55], v[12:15], v[112:127]
  s_waitcnt lgkmcnt(2)
  v_mfma_f32_32x32x16_bf16 v[128:143], v[56:59], v[12:15], v[128:143]
  v_mfma_f32_16x16x32_bf16 v[160:163], v[168:171], v[40:43], v[160:163]
  s_waitcnt lgkmcnt(0)
  v_mfma_f32_32x32x16_bf16 v[144:159], v[60:63], v[12:15], v[144:159]
  v_mfma_f32_16x16x32_bf16 v[164:167], v[168:171], v[44:47], v[164:167]
  s_lshl_b32 s50, s60, 7
  s_add_u32 s50, s50, 143360
  v_lshl_add_u32 v5, v3, 2, s50
  s_lshl_b32 s68, s39, 2
  s_add_u32 s68, s68, s59
  s_mul_i32 s68, s68, 98304
  s_mul_i32 s50, s43, 3072
  s_add_u32 s68, s68, s50
  s_add_u32 s68, s68, 14680064
  s_mov_b64 exec, 0xffff
  ds_write_b32 v5, v160 offset:0
  ds_write_b32 v5, v161 offset:64
  ds_write_b32 v5, v164 offset:384
  ds_write_b32 v5, v165 offset:448
  s_mov_b64 exec, -1
  v_lshrrev_b32 v6, 4, v3
  v_mul_u32_u24 v6, 49152, v6
  v_lshl_add_u32 v6, v4, 8, v6
  v_and_b32 v7, 15, v3
  v_lshl_add_u32 v6, v7, 4, v6
  s_waitcnt lgkmcnt(0)
  s_barrier
  s_setprio 3
  s_lshl_b32 s50, s60, 7
  s_add_u32 s50, s50, 143360
  v_lshl_add_u32 v5, v4, 4, s50
  ds_read_b128 v[16:19], v5 offset:0
  ds_read_b128 v[20:23], v5 offset:32
  ds_read_b128 v[24:27], v5 offset:64
  ds_read_b128 v[28:31], v5 offset:96
  ds_read_b128 v[32:35], v5 offset:384
  ds_read_b128 v[36:39], v5 offset:416
  ds_read_b128 v[40:43], v5 offset:448
  ds_read_b128 v[44:47], v5 offset:480
  s_lshl_b32 s50, s61, 7
  s_add_u32 s50, s50, 143360
  v_lshl_add_u32 v5, v4, 4, s50
  ds_read_b128 v[184:187], v5 offset:0
  ds_read_b128 v[188:191], v5 offset:32
  ds_read_b128 v[192:195], v5 offset:64
  ds_read_b128 v[196:199], v5 offset:96
  ds_read_b128 v[200:203], v5 offset:384
  ds_read_b128 v[204:207], v5 offset:416
  ds_read_b128 v[208:211], v5 offset:448
  ds_read_b128 v[212:215], v5 offset:480
  s_waitcnt lgkmcnt(8)
  v_fmac_f32 v64, v16, v180
  v_fmac_f32 v80, v32, v180
  v_fmac_f32 v65, v17, v180
  v_fmac_f32 v81, v33, v180
  v_fmac_f32 v66, v18, v180
  v_fmac_f32 v82, v34, v180
  v_fmac_f32 v67, v19, v180
  v_fmac_f32 v83, v35, v180
  v_fmac_f32 v68, v20, v180
  v_fmac_f32 v84, v36, v180
  v_fmac_f32 v69, v21, v180
  v_fmac_f32 v85, v37, v180
  v_fmac_f32 v70, v22, v180
  v_fmac_f32 v86, v38, v180
  v_fmac_f32 v71, v23, v180
  v_fmac_f32 v87, v39, v180
  v_fmac_f32 v72, v24, v180
  v_fmac_f32 v88, v40, v180
  v_fmac_f32 v73, v25, v180
  v_fmac_f32 v89, v41, v180
  v_fmac_f32 v74, v26, v180
  v_fmac_f32 v90, v42, v180
  v_fmac_f32 v75, v27, v180
  v_fmac_f32 v91, v43, v180
  v_fmac_f32 v76, v28, v180
  v_fmac_f32 v92, v44, v180
  v_fmac_f32 v77, v29, v180
  v_fmac_f32 v93, v45, v180
  v_fmac_f32 v78, v30, v180
  v_fmac_f32 v94, v46, v180
  v_fmac_f32 v79, v31, v180
  v_fmac_f32 v95, v47, v180
  s_lshl_b32 s50, s62, 7
  s_add_u32 s50, s50, 143360
  v_lshl_add_u32 v5, v4, 4, s50
  ds_read_b128 v[16:19], v5 offset:0
  ds_read_b128 v[20:23], v5 offset:32
  ds_read_b128 v[24:27], v5 offset:64
  ds_read_b128 v[28:31], v5 offset:96
  ds_read_b128 v[32:35], v5 offset:384
  ds_read_b128 v[36:39], v5 offset:416
  ds_read_b128 v[40:43], v5 offset:448
  ds_read_b128 v[44:47], v5 offset:480
  s_lshl_b32 s50, s60, 10
  s_add_u32 s50, s50, s68
  v_max_f32 v64, 0, v64
  v_mul_f32 v80, v80, v181
  v_max_f32 v65, 0, v65
  v_mul_f32 v81, v81, v181
  v_max_f32 v66, 0, v66
  v_mul_f32 v82, v82, v181
  v_max_f32 v67, 0, v67
  v_mul_f32 v83, v83, v181
  v_max_f32 v68, 0, v68
  v_mul_f32 v84, v84, v181
  v_max_f32 v69, 0, v69
  v_mul_f32 v85, v85, v181
  v_max_f32 v70, 0, v70
  v_mul_f32 v86, v86, v181
  v_max_f32 v71, 0, v71
  v_mul_f32 v87, v87, v181
  v_mul_f32 v64, v64, v80
  v_mul_f32 v65, v65, v81
  v_mul_f32 v66, v66, v82
  v_mul_f32 v67, v67, v83
  v_mul_f32 v68, v68, v84
  v_mul_f32 v69, v69, v85
  v_mul_f32 v70, v70, v86
  v_mul_f32 v71, v71, v87
  v_cvt_pk_bf16_f32 v80, v64, v65
  v_cvt_pk_bf16_f32 v81, v66, v67
  v_cvt_pk_bf16_f32 v82, v68, v69
  v_cvt_pk_bf16_f32 v83, v70, v71
  s_nop 1
  v_permlane32_swap_b32 v80, v82
  v_permlane32_swap_b32 v81, v83
  buffer_store_dwordx4 v[80:83], v6, s[16:19], s50 offen offset:0 sc1
  v_max_f32 v72, 0, v72
  v_mul_f32 v88, v88, v181
  v_max_f32 v73, 0, v73
  v_mul_f32 v89, v89, v181
  v_max_f32 v74, 0, v74
  v_mul_f32 v90, v90, v181
  v_max_f32 v75, 0, v75
  v_mul_f32 v91, v91, v181
  v_max_f32 v76, 0, v76
  v_mul_f32 v92, v92, v181
  v_max_f32 v77, 0, v77
  v_mul_f32 v93, v93, v181
  v_max_f32 v78, 0, v78
  v_mul_f32 v94, v94, v181
  v_max_f32 v79, 0, v79
  v_mul_f32 v95, v95, v181
  v_mul_f32 v72, v72, v88
  v_mul_f32 v73, v73, v89
  v_mul_f32 v74, v74, v90
  v_mul_f32 v75, v75, v91
  v_mul_f32 v76, v76, v92
  v_mul_f32 v77, v77, v93
  v_mul_f32 v78, v78, v94
  v_mul_f32 v79, v79, v95
  v_cvt_pk_bf16_f32 v88, v72, v73
  v_cvt_pk_bf16_f32 v89, v74, v75
  v_cvt_pk_bf16_f32 v90, v76, v77
  v_cvt_pk_bf16_f32 v91, v78, v79
  s_nop 1
  v_permlane32_swap_b32 v88, v90
  v_permlane32_swap_b32 v89, v91
  buffer_store_dwordx4 v[88:91], v6, s[16:19], s50 offen offset:512 sc1
  s_waitcnt lgkmcnt(8)
  v_fmac_f32 v96, v184, v180
  v_fmac_f32 v112, v200, v180
  v_fmac_f32 v97, v185, v180
  v_fmac_f32 v113, v201, v180
  v_fmac_f32 v98, v186, v180
  v_fmac_f32 v114, v202, v180
  v_fmac_f32 v99, v187, v180
  v_fmac_f32 v115, v203, v180
  v_fmac_f32 v100, v188, v180
  v_fmac_f32 v116, v204, v180
  v_fmac_f32 v101, v189, v180
  v_fmac_f32 v117, v205, v180
  v_fmac_f32 v102, v190, v180
  v_fmac_f32 v118, v206, v180
  v_fmac_f32 v103, v191, v180
  v_fmac_f32 v119, v207, v180
  v_fmac_f32 v104, v192, v180
  v_fmac_f32 v120, v208, v180
  v_fmac_f32 v105, v193, v180
  v_fmac_f32 v121, v209, v180
  v_fmac_f32 v106, v194, v180
  v_fmac_f32 v122, v210, v180
  v_fmac_f32 v107, v195, v180
  v_fmac_f32 v123, v211, v180
  v_fmac_f32 v108, v196, v180
  v_fmac_f32 v124, v212, v180
  v_fmac_f32 v109, v197, v180
  v_fmac_f32 v125, v213, v180
  v_fmac_f32 v110, v198, v180
  v_fmac_f32 v126, v214, v180
  v_fmac_f32 v111, v199, v180
  v_fmac_f32 v127, v215, v180
  s_lshl_b32 s50, s61, 10
  s_add_u32 s50, s50, s68
  v_max_f32 v96, 0, v96
  v_mul_f32 v112, v112, v181
  v_max_f32 v97, 0, v97
  v_mul_f32 v113, v113, v181
  v_max_f32 v98, 0, v98
  v_mul_f32 v114, v114, v181
  v_max_f32 v99, 0, v99
  v_mul_f32 v115, v115, v181
  v_max_f32 v100, 0, v100
  v_mul_f32 v116, v116, v181
  v_max_f32 v101, 0, v101
  v_mul_f32 v117, v117, v181
  v_max_f32 v102, 0, v102
  v_mul_f32 v118, v118, v181
  v_max_f32 v103, 0, v103
  v_mul_f32 v119, v119, v181
  v_mul_f32 v96, v96, v112
  v_mul_f32 v97, v97, v113
  v_mul_f32 v98, v98, v114
  v_mul_f32 v99, v99, v115
  v_mul_f32 v100, v100, v116
  v_mul_f32 v101, v101, v117
  v_mul_f32 v102, v102, v118
  v_mul_f32 v103, v103, v119
  v_cvt_pk_bf16_f32 v112, v96, v97
  v_cvt_pk_bf16_f32 v113, v98, v99
  v_cvt_pk_bf16_f32 v114, v100, v101
  v_cvt_pk_bf16_f32 v115, v102, v103
  s_nop 1
  v_permlane32_swap_b32 v112, v114
  v_permlane32_swap_b32 v113, v115
  buffer_store_dwordx4 v[112:115], v6, s[16:19], s50 offen offset:0 sc1
  v_max_f32 v104, 0, v104
  v_mul_f32 v120, v120, v181
  v_max_f32 v105, 0, v105
  v_mul_f32 v121, v121, v181
  v_max_f32 v106, 0, v106
  v_mul_f32 v122, v122, v181
  v_max_f32 v107, 0, v107
  v_mul_f32 v123, v123, v181
  v_max_f32 v108, 0, v108
  v_mul_f32 v124, v124, v181
  v_max_f32 v109, 0, v109
  v_mul_f32 v125, v125, v181
  v_max_f32 v110, 0, v110
  v_mul_f32 v126, v126, v181
  v_max_f32 v111, 0, v111
  v_mul_f32 v127, v127, v181
  v_mul_f32 v104, v104, v120
  v_mul_f32 v105, v105, v121
  v_mul_f32 v106, v106, v122
  v_mul_f32 v107, v107, v123
  v_mul_f32 v108, v108, v124
  v_mul_f32 v109, v109, v125
  v_mul_f32 v110, v110, v126
  v_mul_f32 v111, v111, v127
  v_cvt_pk_bf16_f32 v120, v104, v105
  v_cvt_pk_bf16_f32 v121, v106, v107
  v_cvt_pk_bf16_f32 v122, v108, v109
  v_cvt_pk_bf16_f32 v123, v110, v111
  s_nop 1
  v_permlane32_swap_b32 v120, v122
  v_permlane32_swap_b32 v121, v123
  buffer_store_dwordx4 v[120:123], v6, s[16:19], s50 offen offset:512 sc1
  s_waitcnt lgkmcnt(0)
  v_fmac_f32 v128, v16, v180
  v_fmac_f32 v144, v32, v180
  v_fmac_f32 v129, v17, v180
  v_fmac_f32 v145, v33, v180
  v_fmac_f32 v130, v18, v180
  v_fmac_f32 v146, v34, v180
  v_fmac_f32 v131, v19, v180
  v_fmac_f32 v147, v35, v180
  v_fmac_f32 v132, v20, v180
  v_fmac_f32 v148, v36, v180
  v_fmac_f32 v133, v21, v180
  v_fmac_f32 v149, v37, v180
  v_fmac_f32 v134, v22, v180
  v_fmac_f32 v150, v38, v180
  v_fmac_f32 v135, v23, v180
  v_fmac_f32 v151, v39, v180
  v_fmac_f32 v136, v24, v180
  v_fmac_f32 v152, v40, v180
  v_fmac_f32 v137, v25, v180
  v_fmac_f32 v153, v41, v180
  v_fmac_f32 v138, v26, v180
  v_fmac_f32 v154, v42, v180
  v_fmac_f32 v139, v27, v180
  v_fmac_f32 v155, v43, v180
  v_fmac_f32 v140, v28, v180
  v_fmac_f32 v156, v44, v180
  v_fmac_f32 v141, v29, v180
  v_fmac_f32 v157, v45, v180
  v_fmac_f32 v142, v30, v180
  v_fmac_f32 v158, v46, v180
  v_fmac_f32 v143, v31, v180
  v_fmac_f32 v159, v47, v180
  s_lshl_b32 s50, s62, 10
  s_add_u32 s50, s50, s68
  v_max_f32 v128, 0, v128
  v_mul_f32 v144, v144, v181
  v_max_f32 v129, 0, v129
  v_mul_f32 v145, v145, v181
  v_max_f32 v130, 0, v130
  v_mul_f32 v146, v146, v181
  v_max_f32 v131, 0, v131
  v_mul_f32 v147, v147, v181
  v_max_f32 v132, 0, v132
  v_mul_f32 v148, v148, v181
  v_max_f32 v133, 0, v133
  v_mul_f32 v149, v149, v181
  v_max_f32 v134, 0, v134
  v_mul_f32 v150, v150, v181
  v_max_f32 v135, 0, v135
  v_mul_f32 v151, v151, v181
  v_mul_f32 v128, v128, v144
  v_mul_f32 v129, v129, v145
  v_mul_f32 v130, v130, v146
  v_mul_f32 v131, v131, v147
  v_mul_f32 v132, v132, v148
  v_mul_f32 v133, v133, v149
  v_mul_f32 v134, v134, v150
  v_mul_f32 v135, v135, v151
  v_cvt_pk_bf16_f32 v144, v128, v129
  v_cvt_pk_bf16_f32 v145, v130, v131
  v_cvt_pk_bf16_f32 v146, v132, v133
  v_cvt_pk_bf16_f32 v147, v134, v135
  s_nop 1
  v_permlane32_swap_b32 v144, v146
  v_permlane32_swap_b32 v145, v147
  buffer_store_dwordx4 v[144:147], v6, s[16:19], s50 offen offset:0 sc1
  v_max_f32 v136, 0, v136
  v_mul_f32 v152, v152, v181
  v_max_f32 v137, 0, v137
  v_mul_f32 v153, v153, v181
  v_max_f32 v138, 0, v138
  v_mul_f32 v154, v154, v181
  v_max_f32 v139, 0, v139
  v_mul_f32 v155, v155, v181
  v_max_f32 v140, 0, v140
  v_mul_f32 v156, v156, v181
  v_max_f32 v141, 0, v141
  v_mul_f32 v157, v157, v181
  v_max_f32 v142, 0, v142
  v_mul_f32 v158, v158, v181
  v_max_f32 v143, 0, v143
  v_mul_f32 v159, v159, v181
  v_mul_f32 v136, v136, v152
  v_mul_f32 v137, v137, v153
  v_mul_f32 v138, v138, v154
  v_mul_f32 v139, v139, v155
  v_mul_f32 v140, v140, v156
  v_mul_f32 v141, v141, v157
  v_mul_f32 v142, v142, v158
  v_mul_f32 v143, v143, v159
  v_cvt_pk_bf16_f32 v152, v136, v137
  v_cvt_pk_bf16_f32 v153, v138, v139
  v_cvt_pk_bf16_f32 v154, v140, v141
  v_cvt_pk_bf16_f32 v155, v142, v143
  s_nop 1
  v_permlane32_swap_b32 v152, v154
  v_permlane32_swap_b32 v153, v155
  buffer_store_dwordx4 v[152:155], v6, s[16:19], s50 offen offset:512 sc1
  s_lshl_b32 s60, s42, 2
  s_and_b32 s50, s41, 3
  s_add_u32 s60, s60, s50
  s_lshr_b32 s61, s41, 2
  s_mul_i32 s62, s60, 163840
  v_lshlrev_b32 v120, 4, v2
  s_lshl_b32 s50, s61, 8
  s_lshl_b32 s51, s38, 5
  s_add_u32 s50, s50, s51
  v_add_u32 v5, s50, v3
  v_lshrrev_b32 v6, 4, v5
  v_mul_u32_u24 v118, 20480, v6
  v_and_b32 v6, 15, v5
  v_lshl_add_u32 v118, v6, 4, v118
  v_lshl_add_u32 v119, v4, 8, v118
  s_lshr_b32 s50, s38, 2
  s_mul_i32 s50, s50, 5120
  s_add_u32 s50, s50, 153600
  v_and_b32 v5, 127, v5
  v_lshl_add_u32 v6, v5, 4, s50
  v_lshl_add_u32 v6, v4, 11, v6
  v_lshl_add_u32 v7, v5, 3, s50
  v_and_b32 v5, 0x13, v3
  v_and_b32 v113, 4, v3
  v_lshl_or_b32 v5, v113, 1, v5
  v_and_b32 v113, 8, v3
  v_lshrrev_b32 v113, 1, v113
  v_or_b32 v5, v5, v113
  v_lshlrev_b32 v104, 4, v5
  v_lshl_add_u32 v104, v4, 11, v104
  v_lshlrev_b32 v105, 3, v5
  v_add_u32 v105, 4096, v105
  v_mul_u32_u24 v106, 320, v4
  v_lshl_add_u32 v106, v3, 4, v106
  v_add_u32 v106, 5120, v106
  v_add_u32 v107, 61440, v104
  v_add_u32 v108, 61440, v105
  v_add_u32 v109, 61440, v106
  v_add_u32 v110, 122880, v104
  v_add_u32 v111, 122880, v105
  v_add_u32 v112, 122880, v106
  v_mov_b32 v12, 0
  v_mov_b32 v13, 0
  v_mov_b32 v14, 0
  v_mov_b32 v15, 0
  v_mov_b32 v56, 0
  v_mov_b32 v57, 0
  v_mov_b32 v58, 0
  v_mov_b32 v59, 0
  v_mov_b32 v60, 0
  v_mov_b32 v61, 0
  v_mov_b32 v62, 0
  v_mov_b32 v63, 0
  v_mov_b32 v64, 0
  v_mov_b32 v65, 0
  v_mov_b32 v66, 0
  v_mov_b32 v67, 0
  v_mov_b32 v68, 0
  v_mov_b32 v69, 0
  v_mov_b32 v70, 0
  v_mov_b32 v71, 0
  v_cmp_eq_u32 vcc, 20, v3
  v_mov_b32 v113, 0x3f803f80
  s_nop 0
  v_cndmask_b32 v114, 0, v113, vcc
  v_mov_b32 v82, 0x3f80
  v_mov_b32 v83, 0
  v_mov_b32 v88, v114
  v_mov_b32 v89, v114
  v_mov_b32 v90, v114
  v_mov_b32 v91, v114
  v_mov_b32 v92, v114
  v_mov_b32 v93, v114
  v_mov_b32 v94, v114
  v_mov_b32 v95, v114
  v_mov_b32 v86, 0x3f80
  v_mov_b32 v87, 0
  v_mov_b32 v96, v114
  v_mov_b32 v97, v114
  v_mov_b32 v98, v114
  v_mov_b32 v99, v114
  v_mov_b32 v100, v114
  v_mov_b32 v101, v114
  v_mov_b32 v102, v114
  v_mov_b32 v103, v114
  v_mov_b32 v48, 0
  v_mov_b32 v49, 0
  v_mov_b32 v50, 0
  v_mov_b32 v51, 0
  v_mov_b32 v52, 0
  v_mov_b32 v53, 0
  v_mov_b32 v54, 0
  v_mov_b32 v55, 0
  v_mov_b32 v124, 0
  v_mov_b32 v125, 0
  v_mov_b32 v126, 0
  v_mov_b32 v127, 0
  v_mov_b32 v128, 0
  v_mov_b32 v129, 0
  v_mov_b32 v130, 0
  v_mov_b32 v131, 0
  v_mov_b32 v132, 0
  v_mov_b32 v133, 0
  v_mov_b32 v134, 0
  v_mov_b32 v135, 0
  v_mov_b32 v136, 0
  v_mov_b32 v137, 0
  v_mov_b32 v138, 0
  v_mov_b32 v139, 0
  v_mov_b32 v140, 0
  v_mov_b32 v141, 0
  v_mov_b32 v142, 0
  v_mov_b32 v143, 0
  v_mov_b32 v144, 0
  v_mov_b32 v145, 0
  v_mov_b32 v146, 0
  v_mov_b32 v147, 0
  v_mov_b32 v148, 0
  v_mov_b32 v149, 0
  v_mov_b32 v150, 0
  v_mov_b32 v151, 0
  v_mov_b32 v152, 0
  v_mov_b32 v153, 0
  v_mov_b32 v154, 0
  v_mov_b32 v155, 0
  v_mov_b32 v156, 0
  v_mov_b32 v157, 0
  v_mov_b32 v158, 0
  v_mov_b32 v159, 0
  v_mov_b32 v160, 0
  v_mov_b32 v161, 0
  v_mov_b32 v162, 0
  v_mov_b32 v163, 0
  s_and_b32 s50, s42, 3
  s_lshl_b32 s51, s61, 2
  s_add_u32 s50, s50, s51
  s_lshl_b32 s54, s50, 1
  s_lshl_b32 s50, s50, 2
  s_lshr_b32 s52, s42, 2
  s_lshl_b32 s52, s52, 2
  s_and_b32 s53, s41, 3
  s_add_u32 s52, s52, s53
  s_mul_i32 s68, s50, 20480
  s_mul_i32 s53, s52, 160
  s_add_u32 s68, s68, s53
  s_and_b32 s53, s38, 1
  s_add_u32 s54, s54, s53
  s_lshl_b32 s53, s53, 1
  s_add_u32 s50, s50, s53
  s_lshr_b32 s53, s38, 1
  s_lshl_b32 s55, s53, 10
  s_mul_i32 s64, s50, 49152
  s_add_u32 s64, s64, s55
  s_add_u32 s64, s64, 14680064
  s_mul_i32 s65, s50, 20480
  s_add_u32 s65, s65, s55
  s_add_u32 s65, s65, 10485760
  s_mul_i32 s66, s53, 40960
  s_mul_i32 s55, s52, 5120
  s_add_u32 s66, s66, s55
  s_add_u32 s66, s66, 25165824
  s_lshr_b32 s55, s54, 2
  s_lshl_b32 s55, s55, 3
  s_and_b32 s54, s54, 3
  s_add_u32 s55, s55, s54
  s_lshl_b32 s55, s55, 11
  s_add_u32 s70, s55, 28450816
  v_and_b32 v5, 15, v2
  v_lshlrev_b32 v121, 7, v5
  s_mul_i32 s55, s52, 5
  s_lshr_b32 s55, s55, 2
  v_lshrrev_b32 v5, 1, v2
  v_mul_u32_u24 v5, 10, v5
  v_and_b32 v122, 1, v2
  v_add3_u32 v122, v122, v5, s55
  v_lshlrev_b32 v122, 7, v122
L_p3_go:
  ds_read_b128 v[8:11], v6
  s_mov_b64 exec, s[44:45]
  ds_read_b64 v[12:13], v7 offset:4096
  s_mov_b64 exec, -1
  ds_read_b128 v[72:75], v104 offset:40960
  ds_read_b64 v[80:81], v105 offset:40960
  ds_read_b128 v[76:79], v104 offset:41472
  ds_read_b64 v[84:85], v105 offset:41216
  s_mov_b64 exec, s[46:47]
  ds_read_b128 v[88:91], v106 offset:40960
  ds_read_b128 v[92:95], v106 offset:41600
  s_mov_b64 exec, -1
  s_waitcnt lgkmcnt(4)
  v_mfma_f32_32x32x16_bf16 v[16:31], v[72:75], v[8:11], 0
  v_mfma_f32_32x32x16_bf16 v[16:31], v[80:83], v[12:15], v[16:31]
  s_nop 11
  v_max3_f32 v113, v16, v17, v18
  v_max3_f32 v114, v19, v20, v21
  v_max3_f32 v115, v22, v23, v24
  v_max3_f32 v116, v25, v26, v27
  v_max3_f32 v113, v113, v28, v29
  v_max3_f32 v114, v114, v30, v31
  v_max3_f32 v113, v113, v114, v115
  v_max3_f32 v113, v113, v116, v116
  v_mov_b32 v114, v113
  s_nop 1
  v_permlane32_swap_b32 v113, v114
  v_max_f32 v113, v113, v114
  v_xor_b32 v113, 0x80000000, v113
  v_lshrrev_b32 v113, 16, v113
  v_cndmask_b32 v14, 0, v113, s[44:45]
  s_nop 1
  v_mfma_f32_32x32x16_bf16 v[16:31], v[72:75], v[8:11], 0
  v_mfma_f32_32x32x16_bf16 v[16:31], v[80:83], v[12:15], v[16:31]
  s_nop 11
  s_setprio 3
  s_waitcnt lgkmcnt(2)
  v_mfma_f32_32x32x16_bf16 v[32:47], v[76:79], v[8:11], 0
  v_exp_f32 v16, v16
  v_exp_f32 v17, v17
  v_exp_f32 v18, v18
  v_exp_f32 v19, v19
  v_mfma_f32_32x32x16_bf16 v[32:47], v[84:87], v[12:15], v[32:47]
  ds_read_b128 v[72:75], v104 offset:41984
  ds_read_b64 v[80:81], v105 offset:41472
  v_exp_f32 v20, v20
  v_exp_f32 v21, v21
  v_exp_f32 v22, v22
  v_exp_f32 v23, v23
  v_cvt_pk_bf16_f32 v48, v16, v17
  v_cvt_pk_bf16_f32 v49, v18, v19
  s_mov_b64 exec, s[46:47]
  ds_read_b128 v[96:99], v106 offset:42240
  ds_read_b128 v[100:103], v106 offset:42880
  s_mov_b64 exec, -1
  v_cvt_pk_bf16_f32 v50, v20, v21
  v_cvt_pk_bf16_f32 v51, v22, v23
  v_exp_f32 v24, v24
  v_exp_f32 v25, v25
  v_exp_f32 v26, v26
  v_exp_f32 v27, v27
  s_waitcnt lgkmcnt(5)
  v_mfma_f32_32x32x16_bf16 v[56:71], v[88:91], v[48:51], v[56:71]
  v_exp_f32 v28, v28
  v_exp_f32 v29, v29
  v_exp_f32 v30, v30
  v_exp_f32 v31, v31
  v_cvt_pk_bf16_f32 v52, v24, v25
  v_cvt_pk_bf16_f32 v53, v26, v27
  v_cvt_pk_bf16_f32 v54, v28, v29
  v_cvt_pk_bf16_f32 v55, v30, v31
  s_lshl_b32 s52, s38, 10
  s_add_u32 s50, s52, 5283840
  s_add_u32 s51, s52, 81920
  s_mov_b32 m0, s51
  s_add_u32 s50, s50, s62
  buffer_load_dwordx4 v120, s[16:19], s50 offen lds
  s_setprio 2
  s_waitcnt lgkmcnt(2)
  v_mfma_f32_32x32x16_bf16 v[16:31], v[72:75], v[8:11], 0
  v_exp_f32 v32, v32
  v_exp_f32 v33, v33
  v_exp_f32 v34, v34
  v_exp_f32 v35, v35
  v_mfma_f32_32x32x16_bf16 v[16:31], v[80:83], v[12:15], v[16:31]
  ds_read_b128 v[76:79], v104 offset:42496
  ds_read_b64 v[84:85], v105 offset:41728
  v_exp_f32 v36, v36
  v_exp_f32 v37, v37
  v_exp_f32 v38, v38
  v_exp_f32 v39, v39
  v_cvt_pk_bf16_f32 v48, v32, v33
  v_cvt_pk_bf16_f32 v49, v34, v35
  v_mfma_f32_32x32x16_bf16 v[56:71], v[92:95], v[52:55], v[56:71]
  s_mov_b64 exec, s[46:47]
  ds_read_b128 v[88:91], v106 offset:43520
  ds_read_b128 v[92:95], v106 offset:44160
  s_mov_b64 exec, -1
  v_cvt_pk_bf16_f32 v50, v36, v37
  v_cvt_pk_bf16_f32 v51, v38, v39
  v_exp_f32 v40, v40
  v_exp_f32 v41, v41
  v_exp_f32 v42, v42
  v_exp_f32 v43, v43
  s_waitcnt lgkmcnt(5)
  v_mfma_f32_32x32x16_bf16 v[56:71], v[96:99], v[48:51], v[56:71]
  v_exp_f32 v44, v44
  v_exp_f32 v45, v45
  v_exp_f32 v46, v46
  v_exp_f32 v47, v47
  v_cvt_pk_bf16_f32 v52, v40, v41
  v_cvt_pk_bf16_f32 v53, v42, v43
  v_cvt_pk_bf16_f32 v54, v44, v45
  v_cvt_pk_bf16_f32 v55, v46, v47
  s_lshl_b32 s52, s38, 10
  s_add_u32 s50, s52, 5292032
  s_add_u32 s51, s52, 90112
  s_mov_b32 m0, s51
  s_add_u32 s50, s50, s62
  buffer_load_dwordx4 v120, s[16:19], s50 offen lds
  s_waitcnt vmcnt(2)
  v_mov_b32 v113, 0
  v_mov_b32 v114, s58
  s_mov_b64 exec, 1
  buffer_store_dword v114, v113, s[16:19], s67 offen sc1
  s_mov_b64 exec, -1
  s_setprio 1
  s_waitcnt lgkmcnt(2)
  v_mfma_f32_32x32x16_bf16 v[32:47], v[76:79], v[8:11], 0
  v_exp_f32 v16, v16
  v_exp_f32 v17, v17
  v_exp_f32 v18, v18
  v_exp_f32 v19, v19
  v_mfma_f32_32x32x16_bf16 v[32:47], v[84:87], v[12:15], v[32:47]
  ds_read_b128 v[72:75], v104 offset:51200
  ds_read_b64 v[80:81], v105 offset:51200
  v_exp_f32 v20, v20
  v_exp_f32 v21, v21
  v_exp_f32 v22, v22
  v_exp_f32 v23, v23
  v_cvt_pk_bf16_f32 v48, v16, v17
  v_cvt_pk_bf16_f32 v49, v18, v19
  v_mfma_f32_32x32x16_bf16 v[56:71], v[100:103], v[52:55], v[56:71]
  s_mov_b64 exec, s[46:47]
  ds_read_b128 v[96:99], v106 offset:44800
  ds_read_b128 v[100:103], v106 offset:45440
  s_mov_b64 exec, -1
  v_cvt_pk_bf16_f32 v50, v20, v21
  v_cvt_pk_bf16_f32 v51, v22, v23
  v_exp_f32 v24, v24
  v_exp_f32 v25, v25
  v_exp_f32 v26, v26
  v_exp_f32 v27, v27
  s_waitcnt lgkmcnt(5)
  v_mfma_f32_32x32x16_bf16 v[56:71], v[88:91], v[48:51], v[56:71]
  v_exp_f32 v28, v28
  v_exp_f32 v29, v29
  v_exp_f32 v30, v30
  v_exp_f32 v31, v31
  v_cvt_pk_bf16_f32 v52, v24, v25
  v_cvt_pk_bf16_f32 v53, v26, v27
  v_cvt_pk_bf16_f32 v54, v28, v29
  v_cvt_pk_bf16_f32 v55, v30, v31
  s_lshl_b32 s52, s38, 10
  s_add_u32 s50, s52, 5300224
  s_add_u32 s51, s52, 98304
  s_mov_b32 m0, s51
  s_add_u32 s50, s50, s62
  buffer_load_dwordx4 v120, s[16:19], s50 offen lds
  s_setprio 0
  s_waitcnt lgkmcnt(2)
  v_mfma_f32_32x32x16_bf16 v[16:31], v[72:75], v[8:11], 0
  v_exp_f32 v32, v32
  v_exp_f32 v33, v33
  v_exp_f32 v34, v34
  v_exp_f32 v35, v35
  v_mfma_f32_32x32x16_bf16 v[16:31], v[80:83], v[12:15], v[16:31]
  ds_read_b128 v[76:79], v104 offset:51712
  ds_read_b64 v[84:85], v105 offset:51456
  v_exp_f32 v36, v36
  v_exp_f32 v37, v37
  v_exp_f32 v38, v38
  v_exp_f32 v39, v39
  v_cvt_pk_bf16_f32 v48, v32, v33
  v_cvt_pk_bf16_f32 v49, v34, v35
  v_mfma_f32_32x32x16_bf16 v[56:71], v[92:95], v[52:55], v[56:71]
  s_mov_b64 exec, s[46:47]
  ds_read_b128 v[88:91], v106 offset:51200
  ds_read_b128 v[92:95], v106 offset:51840
  s_mov_b64 exec, -1
  v_cvt_pk_bf16_f32 v50, v36, v37
  v_cvt_pk_bf16_f32 v51, v38, v39
  v_exp_f32 v40, v40
  v_exp_f32 v41, v41
  v_exp_f32 v42, v42
  v_exp_f32 v43, v43
  s_waitcnt lgkmcnt(5)
  v_mfma_f32_32x32x16_bf16 v[56:71], v[96:99], v[48:51], v[56:71]
  v_exp_f32 v44, v44
  v_exp_f32 v45, v45
  v_exp_f32 v46, v46
  v_exp_f32 v47, v47
  v_cvt_pk_bf16_f32 v52, v40, v41
  v_cvt_pk_bf16_f32 v53, v42, v43
  v_cvt_pk_bf16_f32 v54, v44, v45
  v_cvt_pk_bf16_f32 v55, v46, v47
  s_lshl_b32 s52, s38, 10
  s_add_u32 s50, s52, 5308416
  s_add_u32 s51, s52, 106496
  s_mov_b32 m0, s51
  s_add_u32 s50, s50, s62
  buffer_load_dwordx4 v120, s[16:19], s50 offen lds
  s_setprio 3
  s_waitcnt lgkmcnt(2)
  v_mfma_f32_32x32x16_bf16 v[32:47], v[76:79], v[8:11], 0
  v_exp_f32 v16, v16
  v_exp_f32 v17, v17
  v_exp_f32 v18, v18
  v_exp_f32 v19, v19
  v_mfma_f32_32x32x16_bf16 v[32:47], v[84:87], v[12:15], v[32:47]
  ds_read_b128 v[72:75], v104 offset:52224
  ds_read_b64 v[80:81], v105 offset:51712
  v_exp_f32 v20, v20
  v_exp_f32 v21, v21
  v_exp_f32 v22, v22
  v_exp_f32 v23, v23
  v_cvt_pk_bf16_f32 v48, v16, v17
  v_cvt_pk_bf16_f32 v49, v18, v19
  v_mfma_f32_32x32x16_bf16 v[56:71], v[100:103], v[52:55], v[56:71]
  s_mov_b64 exec, s[46:47]
  ds_read_b128 v[96:99], v106 offset:52480
  ds_read_b128 v[100:103], v106 offset:53120
  s_mov_b64 exec, -1
  v_cvt_pk_bf16_f32 v50, v20, v21
  v_cvt_pk_bf16_f32 v51, v22, v23
  v_exp_f32 v24, v24
  v_exp_f32 v25, v25
  v_exp_f32 v26, v26
  v_exp_f32 v27, v27
  s_waitcnt lgkmcnt(5)
  v_mfma_f32_32x32x16_bf16 v[56:71], v[88:91], v[48:51], v[56:71]
  v_exp_f32 v28, v28
  v_exp_f32 v29, v29
  v_exp_f32 v30, v30
  v_exp_f32 v31, v31
  v_cvt_pk_bf16_f32 v52, v24, v25
  v_cvt_pk_bf16_f32 v53, v26, v27
  v_cvt_pk_bf16_f32 v54, v28, v29
  v_cvt_pk_bf16_f32 v55, v30, v31
  s_lshl_b32 s52, s38, 10
  s_add_u32 s50, s52, 5316608
  s_add_u32 s51, s52, 114688
  s_mov_b32 m0, s51
  s_add_u32 s50, s50, s62
  buffer_load_dwordx4 v120, s[16:19], s50 offen lds
  s_setprio 2
  s_waitcnt lgkmcnt(2)
  v_mfma_f32_32x32x16_bf16 v[16:31], v[72:75], v[8:11], 0
  v_exp_f32 v32, v32
  v_exp_f32 v33, v33
  v_exp_f32 v34, v34
  v_exp_f32 v35, v35
  v_mfma_f32_32x32x16_bf16 v[16:31], v[80:83], v[12:15], v[16:31]
  ds_read_b128 v[76:79], v104 offset:52736
  ds_read_b64 v[84:85], v105 offset:51968
  v_exp_f32 v36, v36
  v_exp_f32 v37, v37
  v_exp_f32 v38, v38
  v_exp_f32 v39, v39
  v_cvt_pk_bf16_f32 v48, v32, v33
  v_cvt_pk_bf16_f32 v49, v34, v35
  v_mfma_f32_32x32x16_bf16 v[56:71], v[92:95], v[52:55], v[56:71]
  s_mov_b64 exec, s[46:47]
  ds_read_b128 v[88:91], v106 offset:53760
  ds_read_b128 v[92:95], v106 offset:54400
  s_mov_b64 exec, -1
  v_cvt_pk_bf16_f32 v50, v36, v37
  v_cvt_pk_bf16_f32 v51, v38, v39
  v_exp_f32 v40, v40
  v_exp_f32 v41, v41
  v_exp_f32 v42, v42
  v_exp_f32 v43, v43
  s_waitcnt lgkmcnt(5)
  v_mfma_f32_32x32x16_bf16 v[56:71], v[96:99], v[48:51], v[56:71]
  v_exp_f32 v44, v44
  v_exp_f32 v45, v45
  v_exp_f32 v46, v46
  v_exp_f32 v47, v47
  v_cvt_pk_bf16_f32 v52, v40, v41
  v_cvt_pk_bf16_f32 v53, v42, v43
  v_cvt_pk_bf16_f32 v54, v44, v45
  v_cvt_pk_bf16_f32 v55, v46, v47
  s_lshl_b32 s52, s38, 10
  s_add_u32 s50, s52, 5324800
  s_add_u32 s51, s52, 122880
  s_mov_b32 m0, s51
  s_add_u32 s50, s50, s62
  buffer_load_dwordx4 v120, s[16:19], s50 offen lds
  s_setprio 1
  s_waitcnt lgkmcnt(2)
  v_mfma_f32_32x32x16_bf16 v[32:47], v[76:79], v[8:11], 0
  v_exp_f32 v16, v16
  v_exp_f32 v17, v17
  v_exp_f32 v18, v18
  v_exp_f32 v19, v19
  v_mfma_f32_32x32x16_bf16 v[32:47], v[84:87], v[12:15], v[32:47]
  ds_read_b128 v[72:75], v107 offset:0
  ds_read_b64 v[80:81], v108 offset:0
  v_exp_f32 v20, v20
  v_exp_f32 v21, v21
  v_exp_f32 v22, v22
  v_exp_f32 v23, v23
  v_cvt_pk_bf16_f32 v48, v16, v17
  v_cvt_pk_bf16_f32 v49, v18, v19
  v_mfma_f32_32x32x16_bf16 v[56:71], v[100:103], v[52:55], v[56:71]
  s_mov_b64 exec, s[46:47]
  ds_read_b128 v[96:99], v106 offset:55040
  ds_read_b128 v[100:103], v106 offset:55680
  s_mov_b64 exec, -1
  v_cvt_pk_bf16_f32 v50, v20, v21
  v_cvt_pk_bf16_f32 v51, v22, v23
  v_exp_f32 v24, v24
  v_exp_f32 v25, v25
  v_exp_f32 v26, v26
  v_exp_f32 v27, v27
  s_waitcnt lgkmcnt(5)
  v_mfma_f32_32x32x16_bf16 v[56:71], v[88:91], v[48:51], v[56:71]
  v_exp_f32 v28, v28
  v_exp_f32 v29, v29
  v_exp_f32 v30, v30
  v_exp_f32 v31, v31
  v_cvt_pk_bf16_f32 v52, v24, v25
  v_cvt_pk_bf16_f32 v53, v26, v27
  v_cvt_pk_bf16_f32 v54, v28, v29
  v_cvt_pk_bf16_f32 v55, v30, v31
  s_lshl_b32 s52, s38, 10
  s_add_u32 s50, s52, 5332992
  s_add_u32 s51, s52, 131072
  s_mov_b32 m0, s51
  s_add_u32 s50, s50, s62
  buffer_load_dwordx4 v120, s[16:19], s50 offen lds
  s_setprio 0
  s_waitcnt lgkmcnt(2)
  v_mfma_f32_32x32x16_bf16 v[16:31], v[72:75], v[8:11], 0
  v_exp_f32 v32, v32
  v_exp_f32 v33, v33
  v_exp_f32 v34, v34
  v_exp_f32 v35, v35
  v_mfma_f32_32x32x16_bf16 v[16:31], v[80:83], v[12:15], v[16:31]
  ds_read_b128 v[76:79], v107 offset:512
  ds_read_b64 v[84:85], v108 offset:256
  v_exp_f32 v36, v36
  v_exp_f32 v37, v37
  v_exp_f32 v38, v38
  v_exp_f32 v39, v39
  v_cvt_pk_bf16_f32 v48, v32, v33
  v_cvt_pk_bf16_f32 v49, v34, v35
  v_mfma_f32_32x32x16_bf16 v[56:71], v[92:95], v[52:55], v[56:71]
  s_mov_b64 exec, s[46:47]
  ds_read_b128 v[88:91], v109 offset:0
  ds_read_b128 v[92:95], v109 offset:640
  s_mov_b64 exec, -1
  v_cvt_pk_bf16_f32 v50, v36, v37
  v_cvt_pk_bf16_f32 v51, v38, v39
  v_exp_f32 v40, v40
  v_exp_f32 v41, v41
  v_exp_f32 v42, v42
  v_exp_f32 v43, v43
  s_waitcnt lgkmcnt(5)
  v_mfma_f32_32x32x16_bf16 v[56:71], v[96:99], v[48:51], v[56:71]
  v_exp_f32 v44, v44
  v_exp_f32 v45, v45
  v_exp_f32 v46, v46
  v_exp_f32 v47, v47
  v_cvt_pk_bf16_f32 v52, v40, v41
  v_cvt_pk_bf16_f32 v53, v42, v43
  v_cvt_pk_bf16_f32 v54, v44, v45
  v_cvt_pk_bf16_f32 v55, v46, v47
  s_lshl_b32 s52, s38, 10
  s_add_u32 s50, s52, 5341184
  s_add_u32 s51, s52, 139264
  s_add_u32 s53, s52, 5361664
  s_add_u32 s52, s52, 4294963200
  s_cmp_ge_u32 s38, 4
  s_cselect_b32 s50, s53, s50
  s_cselect_b32 s51, s52, s51
  s_mov_b32 m0, s51
  s_add_u32 s50, s50, s62
  buffer_load_dwordx4 v120, s[16:19], s50 offen lds
  s_setprio 3
  s_waitcnt lgkmcnt(2)
  v_mfma_f32_32x32x16_bf16 v[32:47], v[76:79], v[8:11], 0
  v_exp_f32 v16, v16
  v_exp_f32 v17, v17
  v_exp_f32 v18, v18
  v_exp_f32 v19, v19
  v_mfma_f32_32x32x16_bf16 v[32:47], v[84:87], v[12:15], v[32:47]
  ds_read_b128 v[72:75], v107 offset:1024
  ds_read_b64 v[80:81], v108 offset:512
  v_exp_f32 v20, v20
  v_exp_f32 v21, v21
  v_exp_f32 v22, v22
  v_exp_f32 v23, v23
  v_cvt_pk_bf16_f32 v48, v16, v17
  v_cvt_pk_bf16_f32 v49, v18, v19
  v_mfma_f32_32x32x16_bf16 v[56:71], v[100:103], v[52:55], v[56:71]
  s_mov_b64 exec, s[46:47]
  ds_read_b128 v[96:99], v109 offset:1280
  ds_read_b128 v[100:103], v109 offset:1920
  s_mov_b64 exec, -1
  v_cvt_pk_bf16_f32 v50, v20, v21
  v_cvt_pk_bf16_f32 v51, v22, v23
  v_exp_f32 v24, v24
  v_exp_f32 v25, v25
  v_exp_f32 v26, v26
  v_exp_f32 v27, v27
  s_waitcnt lgkmcnt(5)
  v_mfma_f32_32x32x16_bf16 v[56:71], v[88:91], v[48:51], v[56:71]
  v_exp_f32 v28, v28
  v_exp_f32 v29, v29
  v_exp_f32 v30, v30
  v_exp_f32 v31, v31
  v_cvt_pk_bf16_f32 v52, v24, v25
  v_cvt_pk_bf16_f32 v53, v26, v27
  v_cvt_pk_bf16_f32 v54, v28, v29
  v_cvt_pk_bf16_f32 v55, v30, v31
  s_lshl_b32 s52, s38, 10
  s_add_u32 s50, s52, 5369856
  s_add_u32 s51, s52, 4096
  s_mov_b32 m0, s51
  s_add_u32 s50, s50, s62
  buffer_load_dwordx4 v120, s[16:19], s50 offen lds
  s_cmp_lg_u32 s38, 0
  s_cbranch_scc1 L_pp_16
  v_mov_b32 v251, s58
  s_mov_b32 s50, 28704768
  buffer_load_dword v249, v122, s[16:19], s50 offen sc1
  s_mov_b32 s50, 28745728
  buffer_load_dword v250, v122, s[16:19], s50 offen sc1
  s_mov_b64 exec, 0xff
  s_mov_b32 s50, 28786688
  buffer_load_dword v251, v122, s[16:19], s50 offen sc1
  s_mov_b64 exec, -1
L_pp_16:
  s_setprio 2
  s_waitcnt lgkmcnt(2)
  v_mfma_f32_32x32x16_bf16 v[16:31], v[72:75], v[8:11], 0
  v_exp_f32 v32, v32
  v_exp_f32 v33, v33
  v_exp_f32 v34, v34
  v_exp_f32 v35, v35
  v_mfma_f32_32x32x16_bf16 v[16:31], v[80:83], v[12:15], v[16:31]
  ds_read_b128 v[76:79], v107 offset:1536
  ds_read_b64 v[84:85], v108 offset:768
  v_exp_f32 v36, v36
  v_exp_f32 v37, v37
  v_exp_f32 v38, v38
  v_exp_f32 v39, v39
  v_cvt_pk_bf16_f32 v48, v32, v33
  v_cvt_pk_bf16_f32 v49, v34, v35
  v_mfma_f32_32x32x16_bf16 v[56:71], v[92:95], v[52:55], v[56:71]
  s_mov_b64 exec, s[46:47]
  ds_read_b128 v[88:91], v109 offset:2560
  ds_read_b128 v[92:95], v109 offset:3200
  s_mov_b64 exec, -1
  v_cvt_pk_bf16_f32 v50, v36, v37
  v_cvt_pk_bf16_f32 v51, v38, v39
  v_exp_f32 v40, v40
  v_exp_f32 v41, v41
  v_exp_f32 v42, v42
  v_exp_f32 v43, v43
  s_waitcnt lgkmcnt(5)
  v_mfma_f32_32x32x16_bf16 v[56:71], v[96:99], v[48:51], v[56:71]
  v_exp_f32 v44, v44
  v_exp_f32 v45, v45
  v_exp_f32 v46, v46
  v_exp_f32 v47, v47
  v_cvt_pk_bf16_f32 v52, v40, v41
  v_cvt_pk_bf16_f32 v53, v42, v43
  v_cvt_pk_bf16_f32 v54, v44, v45
  v_cvt_pk_bf16_f32 v55, v46, v47
  s_lshl_b32 s52, s38, 10
  s_add_u32 s50, s52, 5378048
  s_add_u32 s51, s52, 12288
  s_mov_b32 m0, s51
  s_add_u32 s50, s50, s62
  buffer_load_dwordx4 v120, s[16:19], s50 offen lds
  s_setprio 1
  s_waitcnt lgkmcnt(2)
  v_mfma_f32_32x32x16_bf16 v[32:47], v[76:79], v[8:11], 0
  v_exp_f32 v16, v16
  v_exp_f32 v17, v17
  v_exp_f32 v18, v18
  v_exp_f32 v19, v19
  v_mfma_f32_32x32x16_bf16 v[32:47], v[84:87], v[12:15], v[32:47]
  ds_read_b128 v[72:75], v107 offset:10240
  ds_read_b64 v[80:81], v108 offset:10240
  v_exp_f32 v20, v20
  v_exp_f32 v21, v21
  v_exp_f32 v22, v22
  v_exp_f32 v23, v23
  v_cvt_pk_bf16_f32 v48, v16, v17
  v_cvt_pk_bf16_f32 v49, v18, v19
  v_mfma_f32_32x32x16_bf16 v[56:71], v[100:103], v[52:55], v[56:71]
  s_mov_b64 exec, s[46:47]
  ds_read_b128 v[96:99], v109 offset:3840
  ds_read_b128 v[100:103], v109 offset:4480
  s_mov_b64 exec, -1
  v_cvt_pk_bf16_f32 v50, v20, v21
  v_cvt_pk_bf16_f32 v51, v22, v23
  v_exp_f32 v24, v24
  v_exp_f32 v25, v25
  v_exp_f32 v26, v26
  v_exp_f32 v27, v27
  s_waitcnt lgkmcnt(5)
  v_mfma_f32_32x32x16_bf16 v[56:71], v[88:91], v[48:51], v[56:71]
  v_exp_f32 v28, v28
  v_exp_f32 v29, v29
  v_exp_f32 v30, v30
  v_exp_f32 v31, v31
  v_cvt_pk_bf16_f32 v52, v24, v25
  v_cvt_pk_bf16_f32 v53, v26, v27
  v_cvt_pk_bf16_f32 v54, v28, v29
  v_cvt_pk_bf16_f32 v55, v30, v31
  s_setprio 0
  s_waitcnt lgkmcnt(2)
  v_mfma_f32_32x32x16_bf16 v[16:31], v[72:75], v[8:11], 0
  v_exp_f32 v32, v32
  v_exp_f32 v33, v33
  v_exp_f32 v34, v34
  v_exp_f32 v35, v35
  v_mfma_f32_32x32x16_bf16 v[16:31], v[80:83], v[12:15], v[16:31]
  ds_read_b128 v[76:79], v107 offset:10752
  ds_read_b64 v[84:85], v108 offset:10496
  v_exp_f32 v36, v36
  v_exp_f32 v37, v37
  v_exp_f32 v38, v38
  v_exp_f32 v39, v39
  v_cvt_pk_bf16_f32 v48, v32, v33
  v_cvt_pk_bf16_f32 v49, v34, v35
  v_mfma_f32_32x32x16_bf16 v[56:71], v[92:95], v[52:55], v[56:71]
  s_mov_b64 exec, s[46:47]
  ds_read_b128 v[88:91], v109 offset:10240
  ds_read_b128 v[92:95], v109 offset:10880
  s_mov_b64 exec, -1
  v_cvt_pk_bf16_f32 v50, v36, v37
  v_cvt_pk_bf16_f32 v51, v38, v39
  v_exp_f32 v40, v40
  v_exp_f32 v41, v41
  v_exp_f32 v42, v42
  v_exp_f32 v43, v43
  s_waitcnt lgkmcnt(5)
  v_mfma_f32_32x32x16_bf16 v[56:71], v[96:99], v[48:51], v[56:71]
  v_exp_f32 v44, v44
  v_exp_f32 v45, v45
  v_exp_f32 v46, v46
  v_exp_f32 v47, v47
  v_cvt_pk_bf16_f32 v52, v40, v41
  v_cvt_pk_bf16_f32 v53, v42, v43
  v_cvt_pk_bf16_f32 v54, v44, v45
  v_cvt_pk_bf16_f32 v55, v46, v47
  s_cmp_lg_u32 s38, 0
  s_cbranch_scc1 L_ppc_17_ok
  s_mov_b32 s51, 0
  s_waitcnt vmcnt(1)
L_ppc_17:
  v_xor_b32 v113, s58, v249
  v_xor_b32 v114, s58, v250
  v_xor_b32 v115, s58, v251
  v_or3_b32 v113, v113, v114, v115
  v_cmp_ne_u32 vcc, 0, v113
  s_add_u32 s51, s51, 1
  s_nop 1
  s_cmp_eq_u64 vcc, 0
  s_cbranch_scc1 L_ppc_17_ok
  s_cmp_ge_u32 s51, 0x20000
  s_cbranch_scc1 L_ppc_17_ok
  s_sleep 8
  s_mov_b32 s50, 28704768
  buffer_load_dword v249, v122, s[16:19], s50 offen sc1
  s_mov_b32 s50, 28745728
  buffer_load_dword v250, v122, s[16:19], s50 offen sc1
  s_mov_b64 exec, 0xff
  s_mov_b32 s50, 28786688
  buffer_load_dword v251, v122, s[16:19], s50 offen sc1
  s_mov_b64 exec, -1
  s_waitcnt vmcnt(0)
  s_branch L_ppc_17
L_ppc_17_ok:
  s_waitcnt vmcnt(5)
  s_barrier
  s_setprio 3
  s_waitcnt lgkmcnt(2)
  v_mfma_f32_32x32x16_bf16 v[32:47], v[76:79], v[8:11], 0
  v_exp_f32 v16, v16
  v_exp_f32 v17, v17
  v_exp_f32 v18, v18
  v_exp_f32 v19, v19
  v_mfma_f32_32x32x16_bf16 v[32:47], v[84:87], v[12:15], v[32:47]
  ds_read_b128 v[72:75], v107 offset:11264
  ds_read_b64 v[80:81], v108 offset:10752
  v_exp_f32 v20, v20
  v_exp_f32 v21, v21
  v_exp_f32 v22, v22
  v_exp_f32 v23, v23
  v_cvt_pk_bf16_f32 v48, v16, v17
  v_cvt_pk_bf16_f32 v49, v18, v19
  v_mfma_f32_32x32x16_bf16 v[56:71], v[100:103], v[52:55], v[56:71]
  s_mov_b64 exec, s[46:47]
  ds_read_b128 v[96:99], v109 offset:11520
  ds_read_b128 v[100:103], v109 offset:12160
  s_mov_b64 exec, -1
  v_cvt_pk_bf16_f32 v50, v20, v21
  v_cvt_pk_bf16_f32 v51, v22, v23
  v_exp_f32 v24, v24
  v_exp_f32 v25, v25
  v_exp_f32 v26, v26
  v_exp_f32 v27, v27
  s_waitcnt lgkmcnt(5)
  v_mfma_f32_32x32x16_bf16 v[56:71], v[88:91], v[48:51], v[56:71]
  s_add_u32 s50, s66, 819200
  buffer_load_dwordx4 v[172:175], v120, s[16:19], s50 offen offset:0
  buffer_load_dwordx4 v[176:179], v120, s[16:19], s50 offen offset:1024
  v_exp_f32 v28, v28
  v_exp_f32 v29, v29
  v_exp_f32 v30, v30
  v_exp_f32 v31, v31
  v_cvt_pk_bf16_f32 v52, v24, v25
  v_cvt_pk_bf16_f32 v53, v26, v27
  v_cvt_pk_bf16_f32 v54, v28, v29
  v_cvt_pk_bf16_f32 v55, v30, v31
  s_lshl_b32 s52, s38, 10
  s_add_u32 s50, s52, 5345280
  s_add_u32 s51, s52, 143360
  s_mov_b32 m0, s51
  s_add_u32 s50, s50, s62
  buffer_load_dwordx4 v120, s[16:19], s50 offen lds
  buffer_load_dword v248, v121, s[16:19], s70 offen sc1
  s_setprio 2
  s_waitcnt lgkmcnt(2)
  v_mfma_f32_32x32x16_bf16 v[16:31], v[72:75], v[8:11], 0
  v_exp_f32 v32, v32
  v_exp_f32 v33, v33
  v_exp_f32 v34, v34
  v_exp_f32 v35, v35
  v_mfma_f32_32x32x16_bf16 v[16:31], v[80:83], v[12:15], v[16:31]
  ds_read_b128 v[76:79], v107 offset:11776
  ds_read_b64 v[84:85], v108 offset:11008
  v_exp_f32 v36, v36
  v_exp_f32 v37, v37
  v_exp_f32 v38, v38
  v_exp_f32 v39, v39
  v_cvt_pk_bf16_f32 v48, v32, v33
  v_cvt_pk_bf16_f32 v49, v34, v35
  v_mfma_f32_32x32x16_bf16 v[56:71], v[92:95], v[52:55], v[56:71]
  s_mov_b64 exec, s[46:47]
  ds_read_b128 v[88:91], v109 offset:12800
  ds_read_b128 v[92:95], v109 offset:13440
  s_mov_b64 exec, -1
  v_cvt_pk_bf16_f32 v50, v36, v37
  v_cvt_pk_bf16_f32 v51, v38, v39
  v_exp_f32 v40, v40
  v_exp_f32 v41, v41
  v_exp_f32 v42, v42
  v_exp_f32 v43, v43
  s_waitcnt lgkmcnt(5)
  v_mfma_f32_32x32x16_bf16 v[56:71], v[96:99], v[48:51], v[56:71]
  s_add_u32 s50, s66, 819200
  buffer_load_dwordx4 v[180:183], v120, s[16:19], s50 offen offset:2048
  buffer_load_dwordx4 v[184:187], v120, s[16:19], s50 offen offset:3072
  v_exp_f32 v44, v44
  v_exp_f32 v45, v45
  v_exp_f32 v46, v46
  v_exp_f32 v47, v47
  v_cvt_pk_bf16_f32 v52, v40, v41
  v_cvt_pk_bf16_f32 v53, v42, v43
  v_cvt_pk_bf16_f32 v54, v44, v45
  v_cvt_pk_bf16_f32 v55, v46, v47
  s_lshl_b32 s52, s38, 10
  s_add_u32 s50, s52, 5353472
  s_add_u32 s51, s52, 151552
  s_mov_b32 m0, s51
  s_add_u32 s50, s50, s62
  buffer_load_dwordx4 v120, s[16:19], s50 offen lds
  s_setprio 1
  s_waitcnt lgkmcnt(2)
  v_mfma_f32_32x32x16_bf16 v[32:47], v[76:79], v[8:11], 0
  v_exp_f32 v16, v16
  v_exp_f32 v17, v17
  v_exp_f32 v18, v18
  v_exp_f32 v19, v19
  v_mfma_f32_32x32x16_bf16 v[32:47], v[84:87], v[12:15], v[32:47]
  ds_read_b128 v[72:75], v107 offset:20480
  ds_read_b64 v[80:81], v108 offset:20480
  v_exp_f32 v20, v20
  v_exp_f32 v21, v21
  v_exp_f32 v22, v22
  v_exp_f32 v23, v23
  v_cvt_pk_bf16_f32 v48, v16, v17
  v_cvt_pk_bf16_f32 v49, v18, v19
  v_mfma_f32_32x32x16_bf16 v[56:71], v[100:103], v[52:55], v[56:71]
  s_mov_b64 exec, s[46:47]
  ds_read_b128 v[96:99], v109 offset:14080
  ds_read_b128 v[100:103], v109 offset:14720
  s_mov_b64 exec, -1
  v_cvt_pk_bf16_f32 v50, v20, v21
  v_cvt_pk_bf16_f32 v51, v22, v23
  v_exp_f32 v24, v24
  v_exp_f32 v25, v25
  v_exp_f32 v26, v26
  v_exp_f32 v27, v27
  s_waitcnt lgkmcnt(5)
  v_mfma_f32_32x32x16_bf16 v[56:71], v[88:91], v[48:51], v[56:71]
  v_exp_f32 v28, v28
  v_exp_f32 v29, v29
  v_exp_f32 v30, v30
  v_exp_f32 v31, v31
  v_cvt_pk_bf16_f32 v52, v24, v25
  v_cvt_pk_bf16_f32 v53, v26, v27
  v_cvt_pk_bf16_f32 v54, v28, v29
  v_cvt_pk_bf16_f32 v55, v30, v31
  s_lshl_b32 s52, s38, 10
  s_add_u32 s50, s52, 5361664
  s_add_u32 s51, s52, 159744
  s_add_u32 s53, s52, 5382144
  s_add_u32 s52, s52, 16384
  s_cmp_ge_u32 s38, 4
  s_cselect_b32 s50, s53, s50
  s_cselect_b32 s51, s52, s51
  s_mov_b32 m0, s51
  s_add_u32 s50, s50, s62
  buffer_load_dwordx4 v120, s[16:19], s50 offen lds
  s_waitcnt vmcnt(4)
  s_mov_b32 s51, 0
L_f2_18:
  v_cmp_ne_u32 vcc, s58, v248
  s_add_u32 s51, s51, 1
  s_nop 1
  s_cmp_eq_u64 vcc, 0
  s_cbranch_scc1 L_f2_18_ok
  s_cmp_ge_u32 s51, 0x20000
  s_cbranch_scc1 L_f2_18_ok
  s_sleep 4
  buffer_load_dword v248, v121, s[16:19], s70 offen sc1
  s_waitcnt vmcnt(0)
  s_branch L_f2_18
L_f2_18_ok:
  s_setprio 0
  s_waitcnt lgkmcnt(2)
  v_mfma_f32_32x32x16_bf16 v[16:31], v[72:75], v[8:11], 0
  v_exp_f32 v32, v32
  v_exp_f32 v33, v33
  v_exp_f32 v34, v34
  v_exp_f32 v35, v35
  v_mfma_f32_32x32x16_bf16 v[16:31], v[80:83], v[12:15], v[16:31]
  ds_read_b128 v[76:79], v107 offset:20992
  ds_read_b64 v[84:85], v108 offset:20736
  v_exp_f32 v36, v36
  v_exp_f32 v37, v37
  v_exp_f32 v38, v38
  v_exp_f32 v39, v39
  v_cvt_pk_bf16_f32 v48, v32, v33
  v_cvt_pk_bf16_f32 v49, v34, v35
  v_mfma_f32_32x32x16_bf16 v[56:71], v[92:95], v[52:55], v[56:71]
  s_mov_b64 exec, s[46:47]
  ds_read_b128 v[88:91], v109 offset:20480
  ds_read_b128 v[92:95], v109 offset:21120
  s_mov_b64 exec, -1
  v_cvt_pk_bf16_f32 v50, v36, v37
  v_cvt_pk_bf16_f32 v51, v38, v39
  v_exp_f32 v40, v40
  v_exp_f32 v41, v41
  v_exp_f32 v42, v42
  v_exp_f32 v43, v43
  s_waitcnt lgkmcnt(5)
  v_mfma_f32_32x32x16_bf16 v[56:71], v[96:99], v[48:51], v[56:71]
  s_add_u32 s50, s66, 823296
  buffer_load_dwordx4 v[188:191], v120, s[16:19], s50 offen
  s_add_u32 s50, s64, 0
  buffer_load_dwordx4 v[164:167], v120, s[16:19], s50 offen
  v_exp_f32 v44, v44
  v_exp_f32 v45, v45
  v_exp_f32 v46, v46
  v_exp_f32 v47, v47
  v_cvt_pk_bf16_f32 v52, v40, v41
  v_cvt_pk_bf16_f32 v53, v42, v43
  v_cvt_pk_bf16_f32 v54, v44, v45
  v_cvt_pk_bf16_f32 v55, v46, v47
  s_lshl_b32 s52, s38, 10
  s_add_u32 s50, s52, 5390336
  s_add_u32 s51, s52, 24576
  s_mov_b32 m0, s51
  s_add_u32 s50, s50, s62
  buffer_load_dwordx4 v120, s[16:19], s50 offen lds
  s_setprio 3
  s_waitcnt lgkmcnt(2)
  v_mfma_f32_32x32x16_bf16 v[32:47], v[76:79], v[8:11], 0
  v_exp_f32 v16, v16
  v_exp_f32 v17, v17
  v_exp_f32 v18, v18
  v_exp_f32 v19, v19
  v_mfma_f32_32x32x16_bf16 v[32:47], v[84:87], v[12:15], v[32:47]
  ds_read_b128 v[72:75], v107 offset:21504
  ds_read_b64 v[80:81], v108 offset:20992
  v_exp_f32 v20, v20
  v_exp_f32 v21, v21
  v_exp_f32 v22, v22
  v_exp_f32 v23, v23
  v_cvt_pk_bf16_f32 v48, v16, v17
  v_cvt_pk_bf16_f32 v49, v18, v19
  v_mfma_f32_32x32x16_bf16 v[56:71], v[100:103], v[52:55], v[56:71]
  s_mov_b64 exec, s[46:47]
  ds_read_b128 v[96:99], v109 offset:21760
  ds_read_b128 v[100:103], v109 offset:22400
  s_mov_b64 exec, -1
  v_cvt_pk_bf16_f32 v50, v20, v21
  v_cvt_pk_bf16_f32 v51, v22, v23
  v_exp_f32 v24, v24
  v_exp_f32 v25, v25
  v_exp_f32 v26, v26
  v_exp_f32 v27, v27
  s_waitcnt lgkmcnt(5)
  v_mfma_f32_32x32x16_bf16 v[56:71], v[88:91], v[48:51], v[56:71]
  s_add_u32 s50, s64, 49152
  buffer_load_dwordx4 v[168:171], v120, s[16:19], s50 offen
  s_add_u32 s50, s66, 983040
  buffer_load_dwordx4 v[200:203], v120, s[16:19], s50 offen offset:0
  buffer_load_dwordx4 v[204:207], v120, s[16:19], s50 offen offset:1024
  v_exp_f32 v28, v28
  v_exp_f32 v29, v29
  v_exp_f32 v30, v30
  v_exp_f32 v31, v31
  v_cvt_pk_bf16_f32 v52, v24, v25
  v_cvt_pk_bf16_f32 v53, v26, v27
  v_cvt_pk_bf16_f32 v54, v28, v29
  v_cvt_pk_bf16_f32 v55, v30, v31
  s_lshl_b32 s52, s38, 10
  s_add_u32 s50, s52, 5398528
  s_add_u32 s51, s52, 32768
  s_mov_b32 m0, s51
  s_add_u32 s50, s50, s62
  buffer_load_dwordx4 v120, s[16:19], s50 offen lds
  s_setprio 2
  s_waitcnt lgkmcnt(2)
  v_mfma_f32_32x32x16_bf16 v[16:31], v[72:75], v[8:11], 0
  v_exp_f32 v32, v32
  v_exp_f32 v33, v33
  v_exp_f32 v34, v34
  v_exp_f32 v35, v35
  v_mfma_f32_32x32x16_bf16 v[16:31], v[80:83], v[12:15], v[16:31]
  ds_read_b128 v[76:79], v107 offset:22016
  ds_read_b64 v[84:85], v108 offset:21248
  v_exp_f32 v36, v36
  v_exp_f32 v37, v37
  v_exp_f32 v38, v38
  v_exp_f32 v39, v39
  v_cvt_pk_bf16_f32 v48, v32, v33
  v_cvt_pk_bf16_f32 v49, v34, v35
  v_mfma_f32_32x32x16_bf16 v[56:71], v[92:95], v[52:55], v[56:71]
  s_mov_b64 exec, s[46:47]
  ds_read_b128 v[88:91], v109 offset:23040
  ds_read_b128 v[92:95], v109 offset:23680
  s_mov_b64 exec, -1
  v_cvt_pk_bf16_f32 v50, v36, v37
  v_cvt_pk_bf16_f32 v51, v38, v39
  v_exp_f32 v40, v40
  v_exp_f32 v41, v41
  v_exp_f32 v42, v42
  v_exp_f32 v43, v43
  s_waitcnt lgkmcnt(5)
  v_mfma_f32_32x32x16_bf16 v[56:71], v[96:99], v[48:51], v[56:71]
  s_add_u32 s50, s66, 983040
  buffer_load_dwordx4 v[208:211], v120, s[16:19], s50 offen offset:2048
  buffer_load_dwordx4 v[212:215], v120, s[16:19], s50 offen offset:3072
  v_exp_f32 v44, v44
  v_exp_f32 v45, v45
  v_exp_f32 v46, v46
  v_exp_f32 v47, v47
  v_cvt_pk_bf16_f32 v52, v40, v41
  v_cvt_pk_bf16_f32 v53, v42, v43
  v_cvt_pk_bf16_f32 v54, v44, v45
  v_cvt_pk_bf16_f32 v55, v46, v47
  s_setprio 1
  s_waitcnt lgkmcnt(2)
  v_mfma_f32_32x32x16_bf16 v[32:47], v[76:79], v[8:11], 0
  v_exp_f32 v16, v16
  v_exp_f32 v17, v17
  v_exp_f32 v18, v18
  v_exp_f32 v19, v19
  v_mfma_f32_32x32x16_bf16 v[32:47], v[84:87], v[12:15], v[32:47]
  ds_read_b128 v[72:75], v107 offset:30720
  ds_read_b64 v[80:81], v108 offset:30720
  v_exp_f32 v20, v20
  v_exp_f32 v21, v21
  v_exp_f32 v22, v22
  v_exp_f32 v23, v23
  v_cvt_pk_bf16_f32 v48, v16, v17
  v_cvt_pk_bf16_f32 v49, v18, v19
  v_mfma_f32_32x32x16_bf16 v[56:71], v[100:103], v[52:55], v[56:71]
  s_mov_b64 exec, s[46:47]
  ds_read_b128 v[96:99], v109 offset:24320
  ds_read_b128 v[100:103], v109 offset:24960
  s_mov_b64 exec, -1
  v_cvt_pk_bf16_f32 v50, v20, v21
  v_cvt_pk_bf16_f32 v51, v22, v23
  v_exp_f32 v24, v24
  v_exp_f32 v25, v25
  v_exp_f32 v26, v26
  v_exp_f32 v27, v27
  s_waitcnt lgkmcnt(5)
  v_mfma_f32_32x32x16_bf16 v[56:71], v[88:91], v[48:51], v[56:71]
  s_add_u32 s50, s66, 987136
  buffer_load_dwordx4 v[216:219], v120, s[16:19], s50 offen
  s_add_u32 s50, s64, 4096
  buffer_load_dwordx4 v[192:195], v120, s[16:19], s50 offen
  v_exp_f32 v28, v28
  v_exp_f32 v29, v29
  v_exp_f32 v30, v30
  v_exp_f32 v31, v31
  v_cvt_pk_bf16_f32 v52, v24, v25
  v_cvt_pk_bf16_f32 v53, v26, v27
  v_cvt_pk_bf16_f32 v54, v28, v29
  v_cvt_pk_bf16_f32 v55, v30, v31
  s_setprio 0
  s_waitcnt lgkmcnt(2)
  v_mfma_f32_32x32x16_bf16 v[16:31], v[72:75], v[8:11], 0
  v_exp_f32 v32, v32
  v_exp_f32 v33, v33
  v_exp_f32 v34, v34
  v_exp_f32 v35, v35
  v_mfma_f32_32x32x16_bf16 v[16:31], v[80:83], v[12:15], v[16:31]
  ds_read_b128 v[76:79], v107 offset:31232
  ds_read_b64 v[84:85], v108 offset:30976
  v_exp_f32 v36, v36
  v_exp_f32 v37, v37
  v_exp_f32 v38, v38
  v_exp_f32 v39, v39
  v_cvt_pk_bf16_f32 v48, v32, v33
  v_cvt_pk_bf16_f32 v49, v34, v35
  v_mfma_f32_32x32x16_bf16 v[56:71], v[92:95], v[52:55], v[56:71]
  s_mov_b64 exec, s[46:47]
  ds_read_b128 v[88:91], v109 offset:30720
  ds_read_b128 v[92:95], v109 offset:31360
  s_mov_b64 exec, -1
  v_cvt_pk_bf16_f32 v50, v36, v37
  v_cvt_pk_bf16_f32 v51, v38, v39
  v_exp_f32 v40, v40
  v_exp_f32 v41, v41
  v_exp_f32 v42, v42
  v_exp_f32 v43, v43
  s_waitcnt lgkmcnt(5)
  v_mfma_f32_32x32x16_bf16 v[56:71], v[96:99], v[48:51], v[56:71]
  s_add_u32 s50, s64, 53248
  buffer_load_dwordx4 v[196:199], v120, s[16:19], s50 offen
  v_exp_f32 v44, v44
  v_exp_f32 v45, v45
  v_exp_f32 v46, v46
  v_exp_f32 v47, v47
  v_cvt_pk_bf16_f32 v52, v40, v41
  v_cvt_pk_bf16_f32 v53, v42, v43
  v_cvt_pk_bf16_f32 v54, v44, v45
  v_cvt_pk_bf16_f32 v55, v46, v47
  s_setprio 3
  s_waitcnt lgkmcnt(2)
  v_mfma_f32_32x32x16_bf16 v[32:47], v[76:79], v[8:11], 0
  v_exp_f32 v16, v16
  v_exp_f32 v17, v17
  s_waitcnt vmcnt(8)
  v_mfma_f32_16x16x32_bf16 v[124:127], v[172:175], v[164:167], v[124:127]
  v_exp_f32 v18, v18
  v_exp_f32 v19, v19
  v_mfma_f32_32x32x16_bf16 v[32:47], v[84:87], v[12:15], v[32:47]
  ds_read_b128 v[72:75], v107 offset:31744
  ds_read_b64 v[80:81], v108 offset:31232
  v_exp_f32 v20, v20
  v_exp_f32 v21, v21
  v_mfma_f32_16x16x32_bf16 v[144:147], v[172:175], v[168:171], v[144:147]
  v_exp_f32 v22, v22
  v_exp_f32 v23, v23
  v_cvt_pk_bf16_f32 v48, v16, v17
  v_cvt_pk_bf16_f32 v49, v18, v19
  v_mfma_f32_32x32x16_bf16 v[56:71], v[100:103], v[52:55], v[56:71]
  s_mov_b64 exec, s[46:47]
  ds_read_b128 v[96:99], v109 offset:32000
  ds_read_b128 v[100:103], v109 offset:32640
  s_mov_b64 exec, -1
  v_cvt_pk_bf16_f32 v50, v20, v21
  v_cvt_pk_bf16_f32 v51, v22, v23
  v_exp_f32 v24, v24
  v_exp_f32 v25, v25
  v_mfma_f32_16x16x32_bf16 v[128:131], v[176:179], v[164:167], v[128:131]
  v_exp_f32 v26, v26
  v_exp_f32 v27, v27
  s_waitcnt lgkmcnt(5)
  v_mfma_f32_32x32x16_bf16 v[56:71], v[88:91], v[48:51], v[56:71]
  s_add_u32 s50, s66, 1146880
  buffer_load_dwordx4 v[228:231], v120, s[16:19], s50 offen offset:0
  buffer_load_dwordx4 v[232:235], v120, s[16:19], s50 offen offset:1024
  v_exp_f32 v28, v28
  v_exp_f32 v29, v29
  v_exp_f32 v30, v30
  v_exp_f32 v31, v31
  v_cvt_pk_bf16_f32 v52, v24, v25
  v_cvt_pk_bf16_f32 v53, v26, v27
  v_cvt_pk_bf16_f32 v54, v28, v29
  v_cvt_pk_bf16_f32 v55, v30, v31
  s_setprio 2
  s_waitcnt lgkmcnt(2)
  v_mfma_f32_32x32x16_bf16 v[16:31], v[72:75], v[8:11], 0
  v_exp_f32 v32, v32
  v_exp_f32 v33, v33
  v_mfma_f32_16x16x32_bf16 v[148:151], v[176:179], v[168:171], v[148:151]
  v_exp_f32 v34, v34
  v_exp_f32 v35, v35
  v_mfma_f32_32x32x16_bf16 v[16:31], v[80:83], v[12:15], v[16:31]
  ds_read_b128 v[76:79], v107 offset:32256
  ds_read_b64 v[84:85], v108 offset:31488
  v_exp_f32 v36, v36
  v_exp_f32 v37, v37
  v_mfma_f32_16x16x32_bf16 v[132:135], v[180:183], v[164:167], v[132:135]
  v_exp_f32 v38, v38
  v_exp_f32 v39, v39
  v_cvt_pk_bf16_f32 v48, v32, v33
  v_cvt_pk_bf16_f32 v49, v34, v35
  v_mfma_f32_32x32x16_bf16 v[56:71], v[92:95], v[52:55], v[56:71]
  s_mov_b64 exec, s[46:47]
  ds_read_b128 v[88:91], v109 offset:33280
  ds_read_b128 v[92:95], v109 offset:33920
  s_mov_b64 exec, -1
  v_cvt_pk_bf16_f32 v50, v36, v37
  v_cvt_pk_bf16_f32 v51, v38, v39
  v_exp_f32 v40, v40
  v_exp_f32 v41, v41
  v_exp_f32 v42, v42
  v_exp_f32 v43, v43
  s_waitcnt lgkmcnt(5)
  v_mfma_f32_32x32x16_bf16 v[56:71], v[96:99], v[48:51], v[56:71]
  s_add_u32 s50, s66, 1146880
  buffer_load_dwordx4 v[236:239], v120, s[16:19], s50 offen offset:2048
  buffer_load_dwordx4 v[240:243], v120, s[16:19], s50 offen offset:3072
  v_exp_f32 v44, v44
  v_exp_f32 v45, v45
  v_exp_f32 v46, v46
  v_exp_f32 v47, v47
  v_cvt_pk_bf16_f32 v52, v40, v41
  v_cvt_pk_bf16_f32 v53, v42, v43
  v_cvt_pk_bf16_f32 v54, v44, v45
  v_cvt_pk_bf16_f32 v55, v46, v47
  s_setprio 1
  s_waitcnt lgkmcnt(2)
  v_mfma_f32_32x32x16_bf16 v[32:47], v[76:79], v[8:11], 0
  v_exp_f32 v16, v16
  v_exp_f32 v17, v17
  v_mfma_f32_16x16x32_bf16 v[152:155], v[180:183], v[168:171], v[152:155]
  v_exp_f32 v18, v18
  v_exp_f32 v19, v19
  v_mfma_f32_32x32x16_bf16 v[32:47], v[84:87], v[12:15], v[32:47]
  ds_read_b128 v[72:75], v107 offset:40960
  ds_read_b64 v[80:81], v108 offset:40960
  v_exp_f32 v20, v20
  v_exp_f32 v21, v21
  v_mfma_f32_16x16x32_bf16 v[136:139], v[184:187], v[164:167], v[136:139]
  v_exp_f32 v22, v22
  v_exp_f32 v23, v23
  v_cvt_pk_bf16_f32 v48, v16, v17
  v_cvt_pk_bf16_f32 v49, v18, v19
  v_mfma_f32_32x32x16_bf16 v[56:71], v[100:103], v[52:55], v[56:71]
  s_mov_b64 exec, s[46:47]
  ds_read_b128 v[96:99], v109 offset:34560
  ds_read_b128 v[100:103], v109 offset:35200
  s_mov_b64 exec, -1
  v_cvt_pk_bf16_f32 v50, v20, v21
  v_cvt_pk_bf16_f32 v51, v22, v23
  v_exp_f32 v24, v24
  v_exp_f32 v25, v25
  v_exp_f32 v26, v26
  v_exp_f32 v27, v27
  s_waitcnt lgkmcnt(5)
  v_mfma_f32_32x32x16_bf16 v[56:71], v[88:91], v[48:51], v[56:71]
  s_add_u32 s50, s66, 1150976
  buffer_load_dwordx4 v[244:247], v120, s[16:19], s50 offen
  s_add_u32 s50, s64, 8192
  buffer_load_dwordx4 v[220:223], v120, s[16:19], s50 offen
  v_exp_f32 v28, v28
  v_exp_f32 v29, v29
  v_exp_f32 v30, v30
  v_exp_f32 v31, v31
  v_cvt_pk_bf16_f32 v52, v24, v25
  v_cvt_pk_bf16_f32 v53, v26, v27
  v_cvt_pk_bf16_f32 v54, v28, v29
  v_cvt_pk_bf16_f32 v55, v30, v31
  s_setprio 0
  s_waitcnt lgkmcnt(2)
  v_mfma_f32_32x32x16_bf16 v[16:31], v[72:75], v[8:11], 0
  v_exp_f32 v32, v32
  v_exp_f32 v33, v33
  v_mfma_f32_16x16x32_bf16 v[156:159], v[184:187], v[168:171], v[156:159]
  v_exp_f32 v34, v34
  v_exp_f32 v35, v35
  v_mfma_f32_32x32x16_bf16 v[16:31], v[80:83], v[12:15], v[16:31]
  ds_read_b128 v[76:79], v107 offset:41472
  ds_read_b64 v[84:85], v108 offset:41216
  v_exp_f32 v36, v36
  v_exp_f32 v37, v37
  v_mfma_f32_16x16x32_bf16 v[140:143], v[188:191], v[164:167], v[140:143]
  v_exp_f32 v38, v38
  v_exp_f32 v39, v39
  v_cvt_pk_bf16_f32 v48, v32, v33
  v_cvt_pk_bf16_f32 v49, v34, v35
  v_mfma_f32_32x32x16_bf16 v[56:71], v[92:95], v[52:55], v[56:71]
  s_mov_b64 exec, s[46:47]
  ds_read_b128 v[88:91], v109 offset:40960
  ds_read_b128 v[92:95], v109 offset:41600
  s_mov_b64 exec, -1
  v_cvt_pk_bf16_f32 v50, v36, v37
  v_cvt_pk_bf16_f32 v51, v38, v39
  v_exp_f32 v40, v40
  v_exp_f32 v41, v41
  v_mfma_f32_16x16x32_bf16 v[160:163], v[188:191], v[168:171], v[160:163]
  v_exp_f32 v42, v42
  v_exp_f32 v43, v43
  s_waitcnt lgkmcnt(5)
  v_mfma_f32_32x32x16_bf16 v[56:71], v[96:99], v[48:51], v[56:71]
  s_add_u32 s50, s64, 57344
  buffer_load_dwordx4 v[224:227], v120, s[16:19], s50 offen
  v_exp_f32 v44, v44
  v_exp_f32 v45, v45
  v_exp_f32 v46, v46
  v_exp_f32 v47, v47
  v_cvt_pk_bf16_f32 v52, v40, v41
  v_cvt_pk_bf16_f32 v53, v42, v43
  v_cvt_pk_bf16_f32 v54, v44, v45
  v_cvt_pk_bf16_f32 v55, v46, v47
  s_setprio 3
  s_waitcnt lgkmcnt(2)
  v_mfma_f32_32x32x16_bf16 v[32:47], v[76:79], v[8:11], 0
  v_exp_f32 v16, v16
  v_exp_f32 v17, v17
  s_waitcnt vmcnt(7)
  v_mfma_f32_16x16x32_bf16 v[124:127], v[200:203], v[192:195], v[124:127]
  v_exp_f32 v18, v18
  v_exp_f32 v19, v19
  v_mfma_f32_32x32x16_bf16 v[32:47], v[84:87], v[12:15], v[32:47]
  ds_read_b128 v[72:75], v107 offset:41984
  ds_read_b64 v[80:81], v108 offset:41472
  v_exp_f32 v20, v20
  v_exp_f32 v21, v21
  v_mfma_f32_16x16x32_bf16 v[144:147], v[200:203], v[196:199], v[144:147]
  v_exp_f32 v22, v22
  v_exp_f32 v23, v23
  v_cvt_pk_bf16_f32 v48, v16, v17
  v_cvt_pk_bf16_f32 v49, v18, v19
  v_mfma_f32_32x32x16_bf16 v[56:71], v[100:103], v[52:55], v[56:71]
  s_mov_b64 exec, s[46:47]
  ds_read_b128 v[96:99], v109 offset:42240
  ds_read_b128 v[100:103], v109 offset:42880
  s_mov_b64 exec, -1
  v_cvt_pk_bf16_f32 v50, v20, v21
  v_cvt_pk_bf16_f32 v51, v22, v23
  v_exp_f32 v24, v24
  v_exp_f32 v25, v25
  v_exp_f32 v26, v26
  v_exp_f32 v27, v27
  s_waitcnt lgkmcnt(5)
  v_mfma_f32_32x32x16_bf16 v[56:71], v[88:91], v[48:51], v[56:71]
  v_exp_f32 v28, v28
  v_exp_f32 v29, v29
  v_exp_f32 v30, v30
  v_exp_f32 v31, v31
  v_cvt_pk_bf16_f32 v52, v24, v25
  v_cvt_pk_bf16_f32 v53, v26, v27
  v_cvt_pk_bf16_f32 v54, v28, v29
  v_cvt_pk_bf16_f32 v55, v30, v31
  s_setprio 2
  s_waitcnt lgkmcnt(2)
  v_mfma_f32_32x32x16_bf16 v[16:31], v[72:75], v[8:11], 0
  v_exp_f32 v32, v32
  v_exp_f32 v33, v33
  v_mfma_f32_16x16x32_bf16 v[128:131], v[204:207], v[192:195], v[128:131]
  v_exp_f32 v34, v34
  v_exp_f32 v35, v35
  v_mfma_f32_32x32x16_bf16 v[16:31], v[80:83], v[12:15], v[16:31]
  ds_read_b128 v[76:79], v107 offset:42496
  ds_read_b64 v[84:85], v108 offset:41728
  v_exp_f32 v36, v36
  v_exp_f32 v37, v37
  v_mfma_f32_16x16x32_bf16 v[148:151], v[204:207], v[196:199], v[148:151]
  v_exp_f32 v38, v38
  v_exp_f32 v39, v39
  v_cvt_pk_bf16_f32 v48, v32, v33
  v_cvt_pk_bf16_f32 v49, v34, v35
  v_mfma_f32_32x32x16_bf16 v[56:71], v[92:95], v[52:55], v[56:71]
  s_mov_b64 exec, s[46:47]
  ds_read_b128 v[88:91], v109 offset:43520
  ds_read_b128 v[92:95], v109 offset:44160
  s_mov_b64 exec, -1
  v_cvt_pk_bf16_f32 v50, v36, v37
  v_cvt_pk_bf16_f32 v51, v38, v39
  v_exp_f32 v40, v40
  v_exp_f32 v41, v41
  v_exp_f32 v42, v42
  v_exp_f32 v43, v43
  s_waitcnt lgkmcnt(5)
  v_mfma_f32_32x32x16_bf16 v[56:71], v[96:99], v[48:51], v[56:71]
  s_add_u32 s50, s66, 1310720
  buffer_load_dwordx4 v[172:175], v120, s[16:19], s50 offen offset:0
  buffer_load_dwordx4 v[176:179], v120, s[16:19], s50 offen offset:1024
  v_exp_f32 v44, v44
  v_exp_f32 v45, v45
  v_exp_f32 v46, v46
  v_exp_f32 v47, v47
  v_cvt_pk_bf16_f32 v52, v40, v41
  v_cvt_pk_bf16_f32 v53, v42, v43
  v_cvt_pk_bf16_f32 v54, v44, v45
  v_cvt_pk_bf16_f32 v55, v46, v47
  s_setprio 1
  s_waitcnt lgkmcnt(2)
  v_mfma_f32_32x32x16_bf16 v[32:47], v[76:79], v[8:11], 0
  v_exp_f32 v16, v16
  v_exp_f32 v17, v17
  v_mfma_f32_16x16x32_bf16 v[132:135], v[208:211], v[192:195], v[132:135]
  v_exp_f32 v18, v18
  v_exp_f32 v19, v19
  v_mfma_f32_32x32x16_bf16 v[32:47], v[84:87], v[12:15], v[32:47]
  ds_read_b128 v[72:75], v107 offset:51200
  ds_read_b64 v[80:81], v108 offset:51200
  v_exp_f32 v20, v20
  v_exp_f32 v21, v21
  v_mfma_f32_16x16x32_bf16 v[152:155], v[208:211], v[196:199], v[152:155]
  v_exp_f32 v22, v22
  v_exp_f32 v23, v23
  v_cvt_pk_bf16_f32 v48, v16, v17
  v_cvt_pk_bf16_f32 v49, v18, v19
  v_mfma_f32_32x32x16_bf16 v[56:71], v[100:103], v[52:55], v[56:71]
  s_mov_b64 exec, s[46:47]
  ds_read_b128 v[96:99], v109 offset:44800
  ds_read_b128 v[100:103], v109 offset:45440
  s_mov_b64 exec, -1
  v_cvt_pk_bf16_f32 v50, v20, v21
  v_cvt_pk_bf16_f32 v51, v22, v23
  v_exp_f32 v24, v24
  v_exp_f32 v25, v25
  v_exp_f32 v26, v26
  v_exp_f32 v27, v27
  s_waitcnt lgkmcnt(5)
  v_mfma_f32_32x32x16_bf16 v[56:71], v[88:91], v[48:51], v[56:71]
  s_add_u32 s50, s66, 1310720
  buffer_load_dwordx4 v[180:183], v120, s[16:19], s50 offen offset:2048
  buffer_load_dwordx4 v[184:187], v120, s[16:19], s50 offen offset:3072
  v_exp_f32 v28, v28
  v_exp_f32 v29, v29
  v_exp_f32 v30, v30
  v_exp_f32 v31, v31
  v_cvt_pk_bf16_f32 v52, v24, v25
  v_cvt_pk_bf16_f32 v53, v26, v27
  v_cvt_pk_bf16_f32 v54, v28, v29
  v_cvt_pk_bf16_f32 v55, v30, v31
  s_setprio 0
  s_waitcnt lgkmcnt(2)
  v_mfma_f32_32x32x16_bf16 v[16:31], v[72:75], v[8:11], 0
  v_exp_f32 v32, v32
  v_exp_f32 v33, v33
  v_mfma_f32_16x16x32_bf16 v[136:139], v[212:215], v[192:195], v[136:139]
  v_exp_f32 v34, v34
  v_exp_f32 v35, v35
  v_mfma_f32_32x32x16_bf16 v[16:31], v[80:83], v[12:15], v[16:31]
  ds_read_b128 v[76:79], v107 offset:51712
  ds_read_b64 v[84:85], v108 offset:51456
  v_exp_f32 v36, v36
  v_exp_f32 v37, v37
  v_mfma_f32_16x16x32_bf16 v[156:159], v[212:215], v[196:199], v[156:159]
  v_exp_f32 v38, v38
  v_exp_f32 v39, v39
  v_cvt_pk_bf16_f32 v48, v32, v33
  v_cvt_pk_bf16_f32 v49, v34, v35
  v_mfma_f32_32x32x16_bf16 v[56:71], v[92:95], v[52:55], v[56:71]
  s_mov_b64 exec, s[46:47]
  ds_read_b128 v[88:91], v109 offset:51200
  ds_read_b128 v[92:95], v109 offset:51840
  s_mov_b64 exec, -1
  v_cvt_pk_bf16_f32 v50, v36, v37
  v_cvt_pk_bf16_f32 v51, v38, v39
  v_exp_f32 v40, v40
  v_exp_f32 v41, v41
  v_mfma_f32_16x16x32_bf16 v[140:143], v[216:219], v[192:195], v[140:143]
  v_exp_f32 v42, v42
  v_exp_f32 v43, v43
  s_waitcnt lgkmcnt(5)
  v_mfma_f32_32x32x16_bf16 v[56:71], v[96:99], v[48:51], v[56:71]
  s_add_u32 s50, s66, 1314816
  buffer_load_dwordx4 v[188:191], v120, s[16:19], s50 offen
  s_add_u32 s50, s64, 12288
  buffer_load_dwordx4 v[164:167], v120, s[16:19], s50 offen
  v_exp_f32 v44, v44
  v_exp_f32 v45, v45
  v_exp_f32 v46, v46
  v_exp_f32 v47, v47
  v_cvt_pk_bf16_f32 v52, v40, v41
  v_cvt_pk_bf16_f32 v53, v42, v43
  v_cvt_pk_bf16_f32 v54, v44, v45
  v_cvt_pk_bf16_f32 v55, v46, v47
  s_barrier
  s_setprio 3
  s_waitcnt lgkmcnt(2)
  v_mfma_f32_32x32x16_bf16 v[32:47], v[76:79], v[8:11], 0
  v_exp_f32 v16, v16
  v_exp_f32 v17, v17
  v_mfma_f32_16x16x32_bf16 v[160:163], v[216:219], v[196:199], v[160:163]
  v_exp_f32 v18, v18
  v_exp_f32 v19, v19
  v_mfma_f32_32x32x16_bf16 v[32:47], v[84:87], v[12:15], v[32:47]
  ds_read_b128 v[72:75], v107 offset:52224
  ds_read_b64 v[80:81], v108 offset:51712
  v_exp_f32 v20, v20
  v_exp_f32 v21, v21
  s_waitcnt vmcnt(6)
  v_mfma_f32_16x16x32_bf16 v[124:127], v[228:231], v[220:223], v[124:127]
  v_exp_f32 v22, v22
  v_exp_f32 v23, v23
  v_cvt_pk_bf16_f32 v48, v16, v17
  v_cvt_pk_bf16_f32 v49, v18, v19
  v_mfma_f32_32x32x16_bf16 v[56:71], v[100:103], v[52:55], v[56:71]
  s_mov_b64 exec, s[46:47]
  ds_read_b128 v[96:99], v109 offset:52480
  ds_read_b128 v[100:103], v109 offset:53120
  s_mov_b64 exec, -1
  v_cvt_pk_bf16_f32 v50, v20, v21
  v_cvt_pk_bf16_f32 v51, v22, v23
  v_exp_f32 v24, v24
  v_exp_f32 v25, v25
  v_exp_f32 v26, v26
  v_exp_f32 v27, v27
  s_waitcnt lgkmcnt(5)
  v_mfma_f32_32x32x16_bf16 v[56:71], v[88:91], v[48:51], v[56:71]
  s_add_u32 s50, s64, 61440
  buffer_load_dwordx4 v[168:171], v120, s[16:19], s50 offen
  v_exp_f32 v28, v28
  v_exp_f32 v29, v29
  v_exp_f32 v30, v30
  v_exp_f32 v31, v31
  v_cvt_pk_bf16_f32 v52, v24, v25
  v_cvt_pk_bf16_f32 v53, v26, v27
  v_cvt_pk_bf16_f32 v54, v28, v29
  v_cvt_pk_bf16_f32 v55, v30, v31
  s_setprio 2
  s_waitcnt lgkmcnt(2)
  v_mfma_f32_32x32x16_bf16 v[16:31], v[72:75], v[8:11], 0
  v_exp_f32 v32, v32
  v_exp_f32 v33, v33
  v_mfma_f32_16x16x32_bf16 v[144:147], v[228:231], v[224:227], v[144:147]
  v_exp_f32 v34, v34
  v_exp_f32 v35, v35
  v_mfma_f32_32x32x16_bf16 v[16:31], v[80:83], v[12:15], v[16:31]
  ds_read_b128 v[76:79], v107 offset:52736
  ds_read_b64 v[84:85], v108 offset:51968
  v_exp_f32 v36, v36
  v_exp_f32 v37, v37
  v_mfma_f32_16x16x32_bf16 v[128:131], v[232:235], v[220:223], v[128:131]
  v_exp_f32 v38, v38
  v_exp_f32 v39, v39
  v_cvt_pk_bf16_f32 v48, v32, v33
  v_cvt_pk_bf16_f32 v49, v34, v35
  v_mfma_f32_32x32x16_bf16 v[56:71], v[92:95], v[52:55], v[56:71]
  s_mov_b64 exec, s[46:47]
  ds_read_b128 v[88:91], v109 offset:53760
  ds_read_b128 v[92:95], v109 offset:54400
  s_mov_b64 exec, -1
  v_cvt_pk_bf16_f32 v50, v36, v37
  v_cvt_pk_bf16_f32 v51, v38, v39
  v_exp_f32 v40, v40
  v_exp_f32 v41, v41
  v_exp_f32 v42, v42
  v_exp_f32 v43, v43
  s_waitcnt lgkmcnt(5)
  v_mfma_f32_32x32x16_bf16 v[56:71], v[96:99], v[48:51], v[56:71]
  s_add_u32 s50, s66, 1474560
  buffer_load_dwordx4 v[200:203], v120, s[16:19], s50 offen offset:0
  buffer_load_dwordx4 v[204:207], v120, s[16:19], s50 offen offset:1024
  v_exp_f32 v44, v44
  v_exp_f32 v45, v45
  v_exp_f32 v46, v46
  v_exp_f32 v47, v47
  v_cvt_pk_bf16_f32 v52, v40, v41
  v_cvt_pk_bf16_f32 v53, v42, v43
  v_cvt_pk_bf16_f32 v54, v44, v45
  v_cvt_pk_bf16_f32 v55, v46, v47
  s_setprio 1
  s_waitcnt lgkmcnt(2)
  v_mfma_f32_32x32x16_bf16 v[32:47], v[76:79], v[8:11], 0
  v_exp_f32 v16, v16
  v_exp_f32 v17, v17
  v_mfma_f32_16x16x32_bf16 v[148:151], v[232:235], v[224:227], v[148:151]
  v_exp_f32 v18, v18
  v_exp_f32 v19, v19
  v_mfma_f32_32x32x16_bf16 v[32:47], v[84:87], v[12:15], v[32:47]
  ds_read_b128 v[72:75], v110 offset:0
  ds_read_b64 v[80:81], v111 offset:0
  v_exp_f32 v20, v20
  v_exp_f32 v21, v21
  v_mfma_f32_16x16x32_bf16 v[132:135], v[236:239], v[220:223], v[132:135]
  v_exp_f32 v22, v22
  v_exp_f32 v23, v23
  v_cvt_pk_bf16_f32 v48, v16, v17
  v_cvt_pk_bf16_f32 v49, v18, v19
  v_mfma_f32_32x32x16_bf16 v[56:71], v[100:103], v[52:55], v[56:71]
  s_mov_b64 exec, s[46:47]
  ds_read_b128 v[96:99], v109 offset:55040
  ds_read_b128 v[100:103], v109 offset:55680
  s_mov_b64 exec, -1
  v_cvt_pk_bf16_f32 v50, v20, v21
  v_cvt_pk_bf16_f32 v51, v22, v23
  v_exp_f32 v24, v24
  v_exp_f32 v25, v25
  v_exp_f32 v26, v26
  v_exp_f32 v27, v27
  s_waitcnt lgkmcnt(5)
  v_mfma_f32_32x32x16_bf16 v[56:71], v[88:91], v[48:51], v[56:71]
  s_add_u32 s50, s66, 1474560
  buffer_load_dwordx4 v[208:211], v120, s[16:19], s50 offen offset:2048
  buffer_load_dwordx4 v[212:215], v120, s[16:19], s50 offen offset:3072
  v_exp_f32 v28, v28
  v_exp_f32 v29, v29
  v_exp_f32 v30, v30
  v_exp_f32 v31, v31
  v_cvt_pk_bf16_f32 v52, v24, v25
  v_cvt_pk_bf16_f32 v53, v26, v27
  v_cvt_pk_bf16_f32 v54, v28, v29
  v_cvt_pk_bf16_f32 v55, v30, v31
  s_setprio 0
  s_waitcnt lgkmcnt(2)
  v_mfma_f32_32x32x16_bf16 v[16:31], v[72:75], v[8:11], 0
  v_exp_f32 v32, v32
  v_exp_f32 v33, v33
  v_mfma_f32_16x16x32_bf16 v[152:155], v[236:239], v[224:227], v[152:155]
  v_exp_f32 v34, v34
  v_exp_f32 v35, v35
  v_mfma_f32_32x32x16_bf16 v[16:31], v[80:83], v[12:15], v[16:31]
  ds_read_b128 v[76:79], v110 offset:512
  ds_read_b64 v[84:85], v111 offset:256
  v_exp_f32 v36, v36
  v_exp_f32 v37, v37
  v_mfma_f32_16x16x32_bf16 v[136:139], v[240:243], v[220:223], v[136:139]
  v_exp_f32 v38, v38
  v_exp_f32 v39, v39
  v_cvt_pk_bf16_f32 v48, v32, v33
  v_cvt_pk_bf16_f32 v49, v34, v35
  v_mfma_f32_32x32x16_bf16 v[56:71], v[92:95], v[52:55], v[56:71]
  s_mov_b64 exec, s[46:47]
  ds_read_b128 v[88:91], v112 offset:0
  ds_read_b128 v[92:95], v112 offset:640
  s_mov_b64 exec, -1
  v_cvt_pk_bf16_f32 v50, v36, v37
  v_cvt_pk_bf16_f32 v51, v38, v39
  v_exp_f32 v40, v40
  v_exp_f32 v41, v41
  v_mfma_f32_16x16x32_bf16 v[156:159], v[240:243], v[224:227], v[156:159]
  v_exp_f32 v42, v42
  v_exp_f32 v43, v43
  s_waitcnt lgkmcnt(5)
  v_mfma_f32_32x32x16_bf16 v[56:71], v[96:99], v[48:51], v[56:71]
  s_add_u32 s50, s66, 1478656
  buffer_load_dwordx4 v[216:219], v120, s[16:19], s50 offen
  s_add_u32 s50, s64, 16384
  buffer_load_dwordx4 v[192:195], v120, s[16:19], s50 offen
  v_exp_f32 v44, v44
  v_exp_f32 v45, v45
  v_exp_f32 v46, v46
  v_exp_f32 v47, v47
  v_cvt_pk_bf16_f32 v52, v40, v41
  v_cvt_pk_bf16_f32 v53, v42, v43
  v_cvt_pk_bf16_f32 v54, v44, v45
  v_cvt_pk_bf16_f32 v55, v46, v47
  s_setprio 3
  s_waitcnt lgkmcnt(2)
  v_mfma_f32_32x32x16_bf16 v[32:47], v[76:79], v[8:11], 0
  v_exp_f32 v16, v16
  v_exp_f32 v17, v17
  v_mfma_f32_16x16x32_bf16 v[140:143], v[244:247], v[220:223], v[140:143]
  v_exp_f32 v18, v18
  v_exp_f32 v19, v19
  v_mfma_f32_32x32x16_bf16 v[32:47], v[84:87], v[12:15], v[32:47]
  ds_read_b128 v[72:75], v110 offset:1024
  ds_read_b64 v[80:81], v111 offset:512
  v_exp_f32 v20, v20
  v_exp_f32 v21, v21
  v_mfma_f32_16x16x32_bf16 v[160:163], v[244:247], v[224:227], v[160:163]
  v_exp_f32 v22, v22
  v_exp_f32 v23, v23
  v_cvt_pk_bf16_f32 v48, v16, v17
  v_cvt_pk_bf16_f32 v49, v18, v19
  v_mfma_f32_32x32x16_bf16 v[56:71], v[100:103], v[52:55], v[56:71]
  s_mov_b64 exec, s[46:47]
  ds_read_b128 v[96:99], v112 offset:1280
  ds_read_b128 v[100:103], v112 offset:1920
  s_mov_b64 exec, -1
  v_cvt_pk_bf16_f32 v50, v20, v21
  v_cvt_pk_bf16_f32 v51, v22, v23
  v_exp_f32 v24, v24
  v_exp_f32 v25, v25
  v_exp_f32 v26, v26
  v_exp_f32 v27, v27
  s_waitcnt lgkmcnt(5)
  v_mfma_f32_32x32x16_bf16 v[56:71], v[88:91], v[48:51], v[56:71]
  s_add_u32 s50, s64, 65536
  buffer_load_dwordx4 v[196:199], v120, s[16:19], s50 offen
  v_exp_f32 v28, v28
  v_exp_f32 v29, v29
  v_exp_f32 v30, v30
  v_exp_f32 v31, v31
  v_cvt_pk_bf16_f32 v52, v24, v25
  v_cvt_pk_bf16_f32 v53, v26, v27
  v_cvt_pk_bf16_f32 v54, v28, v29
  v_cvt_pk_bf16_f32 v55, v30, v31
  s_setprio 2
  s_waitcnt lgkmcnt(2)
  v_mfma_f32_32x32x16_bf16 v[16:31], v[72:75], v[8:11], 0
  v_exp_f32 v32, v32
  v_exp_f32 v33, v33
  s_waitcnt vmcnt(7)
  v_mfma_f32_16x16x32_bf16 v[124:127], v[172:175], v[164:167], v[124:127]
  v_exp_f32 v34, v34
  v_exp_f32 v35, v35
  v_mfma_f32_32x32x16_bf16 v[16:31], v[80:83], v[12:15], v[16:31]
  ds_read_b128 v[76:79], v110 offset:1536
  ds_read_b64 v[84:85], v111 offset:768
  v_exp_f32 v36, v36
  v_exp_f32 v37, v37
  v_mfma_f32_16x16x32_bf16 v[144:147], v[172:175], v[168:171], v[144:147]
  v_exp_f32 v38, v38
  v_exp_f32 v39, v39
  v_cvt_pk_bf16_f32 v48, v32, v33
  v_cvt_pk_bf16_f32 v49, v34, v35
  v_mfma_f32_32x32x16_bf16 v[56:71], v[92:95], v[52:55], v[56:71]
  s_mov_b64 exec, s[46:47]
  ds_read_b128 v[88:91], v112 offset:2560
  ds_read_b128 v[92:95], v112 offset:3200
  s_mov_b64 exec, -1
  v_cvt_pk_bf16_f32 v50, v36, v37
  v_cvt_pk_bf16_f32 v51, v38, v39
  v_exp_f32 v40, v40
  v_exp_f32 v41, v41
  v_exp_f32 v42, v42
  v_exp_f32 v43, v43
  s_waitcnt lgkmcnt(5)
  v_mfma_f32_32x32x16_bf16 v[56:71], v[96:99], v[48:51], v[56:71]
  v_exp_f32 v44, v44
  v_exp_f32 v45, v45
  v_exp_f32 v46, v46
  v_exp_f32 v47, v47
  v_cvt_pk_bf16_f32 v52, v40, v41
  v_cvt_pk_bf16_f32 v53, v42, v43
  v_cvt_pk_bf16_f32 v54, v44, v45
  v_cvt_pk_bf16_f32 v55, v46, v47
  s_setprio 1
  s_waitcnt lgkmcnt(2)
  v_mfma_f32_32x32x16_bf16 v[32:47], v[76:79], v[8:11], 0
  v_exp_f32 v16, v16
  v_exp_f32 v17, v17
  v_mfma_f32_16x16x32_bf16 v[128:131], v[176:179], v[164:167], v[128:131]
  v_exp_f32 v18, v18
  v_exp_f32 v19, v19
  v_mfma_f32_32x32x16_bf16 v[32:47], v[84:87], v[12:15], v[32:47]
  ds_read_b128 v[72:75], v110 offset:10240
  ds_read_b64 v[80:81], v111 offset:10240
  v_exp_f32 v20, v20
  v_exp_f32 v21, v21
  v_mfma_f32_16x16x32_bf16 v[148:151], v[176:179], v[168:171], v[148:151]
  v_exp_f32 v22, v22
  v_exp_f32 v23, v23
  v_cvt_pk_bf16_f32 v48, v16, v17
  v_cvt_pk_bf16_f32 v49, v18, v19
  v_mfma_f32_32x32x16_bf16 v[56:71], v[100:103], v[52:55], v[56:71]
  s_mov_b64 exec, s[46:47]
  ds_read_b128 v[96:99], v112 offset:3840
  ds_read_b128 v[100:103], v112 offset:4480
  s_mov_b64 exec, -1
  v_cvt_pk_bf16_f32 v50, v20, v21
  v_cvt_pk_bf16_f32 v51, v22, v23
  v_exp_f32 v24, v24
  v_exp_f32 v25, v25
  v_mfma_f32_16x16x32_bf16 v[132:135], v[180:183], v[164:167], v[132:135]
  v_exp_f32 v26, v26
  v_exp_f32 v27, v27
  s_waitcnt lgkmcnt(5)
  v_mfma_f32_32x32x16_bf16 v[56:71], v[88:91], v[48:51], v[56:71]
  s_add_u32 s50, s66, 1638400
  buffer_load_dwordx4 v[228:231], v120, s[16:19], s50 offen offset:0
  buffer_load_dwordx4 v[232:235], v120, s[16:19], s50 offen offset:1024
  v_exp_f32 v28, v28
  v_exp_f32 v29, v29
  v_exp_f32 v30, v30
  v_exp_f32 v31, v31
  v_cvt_pk_bf16_f32 v52, v24, v25
  v_cvt_pk_bf16_f32 v53, v26, v27
  v_cvt_pk_bf16_f32 v54, v28, v29
  v_cvt_pk_bf16_f32 v55, v30, v31
  s_setprio 0
  s_waitcnt lgkmcnt(2)
  v_mfma_f32_32x32x16_bf16 v[16:31], v[72:75], v[8:11], 0
  v_exp_f32 v32, v32
  v_exp_f32 v33, v33
  v_mfma_f32_16x16x32_bf16 v[152:155], v[180:183], v[168:171], v[152:155]
  v_exp_f32 v34, v34
  v_exp_f32 v35, v35
  v_mfma_f32_32x32x16_bf16 v[16:31], v[80:83], v[12:15], v[16:31]
  ds_read_b128 v[76:79], v110 offset:10752
  ds_read_b64 v[84:85], v111 offset:10496
  v_exp_f32 v36, v36
  v_exp_f32 v37, v37
  v_mfma_f32_16x16x32_bf16 v[136:139], v[184:187], v[164:167], v[136:139]
  v_exp_f32 v38, v38
  v_exp_f32 v39, v39
  v_cvt_pk_bf16_f32 v48, v32, v33
  v_cvt_pk_bf16_f32 v49, v34, v35
  v_mfma_f32_32x32x16_bf16 v[56:71], v[92:95], v[52:55], v[56:71]
  s_mov_b64 exec, s[46:47]
  ds_read_b128 v[88:91], v112 offset:10240
  ds_read_b128 v[92:95], v112 offset:10880
  s_mov_b64 exec, -1
  v_cvt_pk_bf16_f32 v50, v36, v37
  v_cvt_pk_bf16_f32 v51, v38, v39
  v_exp_f32 v40, v40
  v_exp_f32 v41, v41
  v_exp_f32 v42, v42
  v_exp_f32 v43, v43
  s_waitcnt lgkmcnt(5)
  v_mfma_f32_32x32x16_bf16 v[56:71], v[96:99], v[48:51], v[56:71]
  s_add_u32 s50, s66, 1638400
  buffer_load_dwordx4 v[236:239], v120, s[16:19], s50 offen offset:2048
  buffer_load_dwordx4 v[240:243], v120, s[16:19], s50 offen offset:3072
  v_exp_f32 v44, v44
  v_exp_f32 v45, v45
  v_exp_f32 v46, v46
  v_exp_f32 v47, v47
  v_cvt_pk_bf16_f32 v52, v40, v41
  v_cvt_pk_bf16_f32 v53, v42, v43
  v_cvt_pk_bf16_f32 v54, v44, v45
  v_cvt_pk_bf16_f32 v55, v46, v47
  s_setprio 3
  s_waitcnt lgkmcnt(2)
  v_mfma_f32_32x32x16_bf16 v[32:47], v[76:79], v[8:11], 0
  v_exp_f32 v16, v16
  v_exp_f32 v17, v17
  v_mfma_f32_16x16x32_bf16 v[156:159], v[184:187], v[168:171], v[156:159]
  v_exp_f32 v18, v18
  v_exp_f32 v19, v19
  v_mfma_f32_32x32x16_bf16 v[32:47], v[84:87], v[12:15], v[32:47]
  ds_read_b128 v[72:75], v110 offset:11264
  ds_read_b64 v[80:81], v111 offset:10752
  v_exp_f32 v20, v20
  v_exp_f32 v21, v21
  v_mfma_f32_16x16x32_bf16 v[140:143], v[188:191], v[164:167], v[140:143]
  v_exp_f32 v22, v22
  v_exp_f32 v23, v23
  v_cvt_pk_bf16_f32 v48, v16, v17
  v_cvt_pk_bf16_f32 v49, v18, v19
  v_mfma_f32_32x32x16_bf16 v[56:71], v[100:103], v[52:55], v[56:71]
  s_mov_b64 exec, s[46:47]
  ds_read_b128 v[96:99], v112 offset:11520
  ds_read_b128 v[100:103], v112 offset:12160
  s_mov_b64 exec, -1
  v_cvt_pk_bf16_f32 v50, v20, v21
  v_cvt_pk_bf16_f32 v51, v22, v23
  v_exp_f32 v24, v24
  v_exp_f32 v25, v25
  v_exp_f32 v26, v26
  v_exp_f32 v27, v27
  s_waitcnt lgkmcnt(5)
  v_mfma_f32_32x32x16_bf16 v[56:71], v[88:91], v[48:51], v[56:71]
  s_add_u32 s50, s66, 1642496
  buffer_load_dwordx4 v[244:247], v120, s[16:19], s50 offen
  s_add_u32 s50, s64, 20480
  buffer_load_dwordx4 v[220:223], v120, s[16:19], s50 offen
  v_exp_f32 v28, v28
  v_exp_f32 v29, v29
  v_exp_f32 v30, v30
  v_exp_f32 v31, v31
  v_cvt_pk_bf16_f32 v52, v24, v25
  v_cvt_pk_bf16_f32 v53, v26, v27
  v_cvt_pk_bf16_f32 v54, v28, v29
  v_cvt_pk_bf16_f32 v55, v30, v31
  s_setprio 2
  s_waitcnt lgkmcnt(2)
  v_mfma_f32_32x32x16_bf16 v[16:31], v[72:75], v[8:11], 0
  v_exp_f32 v32, v32
  v_exp_f32 v33, v33
  v_mfma_f32_16x16x32_bf16 v[160:163], v[188:191], v[168:171], v[160:163]
  v_exp_f32 v34, v34
  v_exp_f32 v35, v35
  v_mfma_f32_32x32x16_bf16 v[16:31], v[80:83], v[12:15], v[16:31]
  ds_read_b128 v[76:79], v110 offset:11776
  ds_read_b64 v[84:85], v111 offset:11008
  v_exp_f32 v36, v36
  v_exp_f32 v37, v37
  s_waitcnt vmcnt(6)
  v_mfma_f32_16x16x32_bf16 v[124:127], v[200:203], v[192:195], v[124:127]
  v_exp_f32 v38, v38
  v_exp_f32 v39, v39
  v_cvt_pk_bf16_f32 v48, v32, v33
  v_cvt_pk_bf16_f32 v49, v34, v35
  v_mfma_f32_32x32x16_bf16 v[56:71], v[92:95], v[52:55], v[56:71]
  s_mov_b64 exec, s[46:47]
  ds_read_b128 v[88:91], v112 offset:12800
  ds_read_b128 v[92:95], v112 offset:13440
  s_mov_b64 exec, -1
  v_cvt_pk_bf16_f32 v50, v36, v37
  v_cvt_pk_bf16_f32 v51, v38, v39
  v_exp_f32 v40, v40
  v_exp_f32 v41, v41
  v_exp_f32 v42, v42
  v_exp_f32 v43, v43
  s_waitcnt lgkmcnt(5)
  v_mfma_f32_32x32x16_bf16 v[56:71], v[96:99], v[48:51], v[56:71]
  s_add_u32 s50, s64, 69632
  buffer_load_dwordx4 v[224:227], v120, s[16:19], s50 offen
  v_exp_f32 v44, v44
  v_exp_f32 v45, v45
  v_exp_f32 v46, v46
  v_exp_f32 v47, v47
  v_cvt_pk_bf16_f32 v52, v40, v41
  v_cvt_pk_bf16_f32 v53, v42, v43
  v_cvt_pk_bf16_f32 v54, v44, v45
  v_cvt_pk_bf16_f32 v55, v46, v47
  s_setprio 1
  s_waitcnt lgkmcnt(2)
  v_mfma_f32_32x32x16_bf16 v[32:47], v[76:79], v[8:11], 0
  v_exp_f32 v16, v16
  v_exp_f32 v17, v17
  v_mfma_f32_16x16x32_bf16 v[144:147], v[200:203], v[196:199], v[144:147]
  v_exp_f32 v18, v18
  v_exp_f32 v19, v19
  v_mfma_f32_32x32x16_bf16 v[32:47], v[84:87], v[12:15], v[32:47]
  ds_read_b128 v[72:75], v110 offset:20480
  ds_read_b64 v[80:81], v111 offset:20480
  v_exp_f32 v20, v20
  v_exp_f32 v21, v21
  v_mfma_f32_16x16x32_bf16 v[128:131], v[204:207], v[192:195], v[128:131]
  v_exp_f32 v22, v22
  v_exp_f32 v23, v23
  v_cvt_pk_bf16_f32 v48, v16, v17
  v_cvt_pk_bf16_f32 v49, v18, v19
  v_mfma_f32_32x32x16_bf16 v[56:71], v[100:103], v[52:55], v[56:71]
  s_mov_b64 exec, s[46:47]
  ds_read_b128 v[96:99], v112 offset:14080
  ds_read_b128 v[100:103], v112 offset:14720
  s_mov_b64 exec, -1
  v_cvt_pk_bf16_f32 v50, v20, v21
  v_cvt_pk_bf16_f32 v51, v22, v23
  v_exp_f32 v24, v24
  v_exp_f32 v25, v25
  v_mfma_f32_16x16x32_bf16 v[148:151], v[204:207], v[196:199], v[148:151]
  v_exp_f32 v26, v26
  v_exp_f32 v27, v27
  s_waitcnt lgkmcnt(5)
  v_mfma_f32_32x32x16_bf16 v[56:71], v[88:91], v[48:51], v[56:71]
  s_add_u32 s50, s66, 1802240
  buffer_load_dwordx4 v[172:175], v120, s[16:19], s50 offen offset:0
  buffer_load_dwordx4 v[176:179], v120, s[16:19], s50 offen offset:1024
  v_exp_f32 v28, v28
  v_exp_f32 v29, v29
  v_exp_f32 v30, v30
  v_exp_f32 v31, v31
  v_cvt_pk_bf16_f32 v52, v24, v25
  v_cvt_pk_bf16_f32 v53, v26, v27
  v_cvt_pk_bf16_f32 v54, v28, v29
  v_cvt_pk_bf16_f32 v55, v30, v31
  s_setprio 0
  s_waitcnt lgkmcnt(2)
  v_mfma_f32_32x32x16_bf16 v[16:31], v[72:75], v[8:11], 0
  v_exp_f32 v32, v32
  v_exp_f32 v33, v33
  v_mfma_f32_16x16x32_bf16 v[132:135], v[208:211], v[192:195], v[132:135]
  v_exp_f32 v34, v34
  v_exp_f32 v35, v35
  v_mfma_f32_32x32x16_bf16 v[16:31], v[80:83], v[12:15], v[16:31]
  ds_read_b128 v[76:79], v110 offset:20992
  ds_read_b64 v[84:85], v111 offset:20736
  v_exp_f32 v36, v36
  v_exp_f32 v37, v37
  v_mfma_f32_16x16x32_bf16 v[152:155], v[208:211], v[196:199], v[152:155]
  v_exp_f32 v38, v38
  v_exp_f32 v39, v39
  v_cvt_pk_bf16_f32 v48, v32, v33
  v_cvt_pk_bf16_f32 v49, v34, v35
  v_mfma_f32_32x32x16_bf16 v[56:71], v[92:95], v[52:55], v[56:71]
  s_mov_b64 exec, s[46:47]
  ds_read_b128 v[88:91], v112 offset:20480
  ds_read_b128 v[92:95], v112 offset:21120
  s_mov_b64 exec, -1
  v_cvt_pk_bf16_f32 v50, v36, v37
  v_cvt_pk_bf16_f32 v51, v38, v39
  v_exp_f32 v40, v40
  v_exp_f32 v41, v41
  v_exp_f32 v42, v42
  v_exp_f32 v43, v43
  s_waitcnt lgkmcnt(5)
  v_mfma_f32_32x32x16_bf16 v[56:71], v[96:99], v[48:51], v[56:71]
  s_add_u32 s50, s66, 1802240
  buffer_load_dwordx4 v[180:183], v120, s[16:19], s50 offen offset:2048
  buffer_load_dwordx4 v[184:187], v120, s[16:19], s50 offen offset:3072
  v_exp_f32 v44, v44
  v_exp_f32 v45, v45
  v_exp_f32 v46, v46
  v_exp_f32 v47, v47
  v_cvt_pk_bf16_f32 v52, v40, v41
  v_cvt_pk_bf16_f32 v53, v42, v43
  v_cvt_pk_bf16_f32 v54, v44, v45
  v_cvt_pk_bf16_f32 v55, v46, v47
  s_setprio 3
  s_waitcnt lgkmcnt(2)
  v_mfma_f32_32x32x16_bf16 v[32:47], v[76:79], v[8:11], 0
  v_exp_f32 v16, v16
  v_exp_f32 v17, v17
  v_mfma_f32_16x16x32_bf16 v[136:139], v[212:215], v[192:195], v[136:139]
  v_exp_f32 v18, v18
  v_exp_f32 v19, v19
  v_mfma_f32_32x32x16_bf16 v[32:47], v[84:87], v[12:15], v[32:47]
  ds_read_b128 v[72:75], v110 offset:21504
  ds_read_b64 v[80:81], v111 offset:20992
  v_exp_f32 v20, v20
  v_exp_f32 v21, v21
  v_mfma_f32_16x16x32_bf16 v[156:159], v[212:215], v[196:199], v[156:159]
  v_exp_f32 v22, v22
  v_exp_f32 v23, v23
  v_cvt_pk_bf16_f32 v48, v16, v17
  v_cvt_pk_bf16_f32 v49, v18, v19
  v_mfma_f32_32x32x16_bf16 v[56:71], v[100:103], v[52:55], v[56:71]
  s_mov_b64 exec, s[46:47]
  ds_read_b128 v[96:99], v112 offset:21760
  ds_read_b128 v[100:103], v112 offset:22400
  s_mov_b64 exec, -1
  v_cvt_pk_bf16_f32 v50, v20, v21
  v_cvt_pk_bf16_f32 v51, v22, v23
  v_exp_f32 v24, v24
  v_exp_f32 v25, v25
  v_exp_f32 v26, v26
  v_exp_f32 v27, v27
  s_waitcnt lgkmcnt(5)
  v_mfma_f32_32x32x16_bf16 v[56:71], v[88:91], v[48:51], v[56:71]
  s_add_u32 s50, s66, 1806336
  buffer_load_dwordx4 v[188:191], v120, s[16:19], s50 offen
  s_add_u32 s50, s64, 24576
  buffer_load_dwordx4 v[164:167], v120, s[16:19], s50 offen
  v_exp_f32 v28, v28
  v_exp_f32 v29, v29
  v_exp_f32 v30, v30
  v_exp_f32 v31, v31
  v_cvt_pk_bf16_f32 v52, v24, v25
  v_cvt_pk_bf16_f32 v53, v26, v27
  v_cvt_pk_bf16_f32 v54, v28, v29
  v_cvt_pk_bf16_f32 v55, v30, v31
  s_setprio 2
  s_waitcnt lgkmcnt(2)
  v_mfma_f32_32x32x16_bf16 v[16:31], v[72:75], v[8:11], 0
  v_exp_f32 v32, v32
  v_exp_f32 v33, v33
  v_mfma_f32_16x16x32_bf16 v[140:143], v[216:219], v[192:195], v[140:143]
  v_exp_f32 v34, v34
  v_exp_f32 v35, v35
  v_mfma_f32_32x32x16_bf16 v[16:31], v[80:83], v[12:15], v[16:31]
  ds_read_b128 v[76:79], v110 offset:22016
  ds_read_b64 v[84:85], v111 offset:21248
  v_exp_f32 v36, v36
  v_exp_f32 v37, v37
  v_mfma_f32_16x16x32_bf16 v[160:163], v[216:219], v[196:199], v[160:163]
  v_exp_f32 v38, v38
  v_exp_f32 v39, v39
  v_cvt_pk_bf16_f32 v48, v32, v33
  v_cvt_pk_bf16_f32 v49, v34, v35
  v_mfma_f32_32x32x16_bf16 v[56:71], v[92:95], v[52:55], v[56:71]
  s_mov_b64 exec, s[46:47]
  ds_read_b128 v[88:91], v112 offset:23040
  ds_read_b128 v[92:95], v112 offset:23680
  s_mov_b64 exec, -1
  v_cvt_pk_bf16_f32 v50, v36, v37
  v_cvt_pk_bf16_f32 v51, v38, v39
  v_exp_f32 v40, v40
  v_exp_f32 v41, v41
  v_exp_f32 v42, v42
  v_exp_f32 v43, v43
  s_waitcnt lgkmcnt(5)
  v_mfma_f32_32x32x16_bf16 v[56:71], v[96:99], v[48:51], v[56:71]
  s_add_u32 s50, s64, 73728
  buffer_load_dwordx4 v[168:171], v120, s[16:19], s50 offen
  v_exp_f32 v44, v44
  v_exp_f32 v45, v45
  v_exp_f32 v46, v46
  v_exp_f32 v47, v47
  v_cvt_pk_bf16_f32 v52, v40, v41
  v_cvt_pk_bf16_f32 v53, v42, v43
  v_cvt_pk_bf16_f32 v54, v44, v45
  v_cvt_pk_bf16_f32 v55, v46, v47
  s_barrier
  s_lshr_b32 s50, s38, 1
  s_mul_i32 s50, s50, 40960
  s_sub_u32 s62, s66, s50
  s_setprio 1
  s_waitcnt lgkmcnt(2)
  v_mfma_f32_32x32x16_bf16 v[32:47], v[76:79], v[8:11], 0
  v_exp_f32 v16, v16
  v_exp_f32 v17, v17
  s_waitcnt vmcnt(7)
  v_mfma_f32_16x16x32_bf16 v[124:127], v[228:231], v[220:223], v[124:127]
  v_exp_f32 v18, v18
  v_exp_f32 v19, v19
  v_mfma_f32_32x32x16_bf16 v[32:47], v[84:87], v[12:15], v[32:47]
  ds_read_b128 v[72:75], v110 offset:30720
  ds_read_b64 v[80:81], v111 offset:30720
  v_exp_f32 v20, v20
  v_exp_f32 v21, v21
  v_mfma_f32_16x16x32_bf16 v[144:147], v[228:231], v[224:227], v[144:147]
  v_exp_f32 v22, v22
  v_exp_f32 v23, v23
  v_cvt_pk_bf16_f32 v48, v16, v17
  v_cvt_pk_bf16_f32 v49, v18, v19
  v_mfma_f32_32x32x16_bf16 v[56:71], v[100:103], v[52:55], v[56:71]
  s_mov_b64 exec, s[46:47]
  ds_read_b128 v[96:99], v112 offset:24320
  ds_read_b128 v[100:103], v112 offset:24960
  s_mov_b64 exec, -1
  v_cvt_pk_bf16_f32 v50, v20, v21
  v_cvt_pk_bf16_f32 v51, v22, v23
  v_exp_f32 v24, v24
  v_exp_f32 v25, v25
  v_mfma_f32_16x16x32_bf16 v[128:131], v[232:235], v[220:223], v[128:131]
  v_exp_f32 v26, v26
  v_exp_f32 v27, v27
  s_waitcnt lgkmcnt(5)
  v_mfma_f32_32x32x16_bf16 v[56:71], v[88:91], v[48:51], v[56:71]
  s_add_u32 s50, s66, 1966080
  buffer_load_dwordx4 v[200:203], v120, s[16:19], s50 offen offset:0
  buffer_load_dwordx4 v[204:207], v120, s[16:19], s50 offen offset:1024
  v_exp_f32 v28, v28
  v_exp_f32 v29, v29
  v_exp_f32 v30, v30
  v_exp_f32 v31, v31
  v_cvt_pk_bf16_f32 v52, v24, v25
  v_cvt_pk_bf16_f32 v53, v26, v27
  v_cvt_pk_bf16_f32 v54, v28, v29
  v_cvt_pk_bf16_f32 v55, v30, v31
  s_add_u32 s50, s38, 0
  s_min_u32 s50, s50, 99
  s_mul_i32 s51, s50, 205
  s_lshr_b32 s51, s51, 10
  s_mul_i32 s51, s51, 35840
  s_lshl_b32 s50, s50, 10
  s_add_u32 m0, s50, 40960
  s_add_u32 s50, s50, s51
  s_add_u32 s50, s50, s62
  buffer_load_dwordx4 v120, s[16:19], s50 offen lds
  s_setprio 0
  s_waitcnt lgkmcnt(2)
  v_mfma_f32_32x32x16_bf16 v[16:31], v[72:75], v[8:11], 0
  v_exp_f32 v32, v32
  v_exp_f32 v33, v33
  v_mfma_f32_16x16x32_bf16 v[148:151], v[232:235], v[224:227], v[148:151]
  v_exp_f32 v34, v34
  v_exp_f32 v35, v35
  v_mfma_f32_32x32x16_bf16 v[16:31], v[80:83], v[12:15], v[16:31]
  ds_read_b128 v[76:79], v110 offset:31232
  ds_read_b64 v[84:85], v111 offset:30976
  v_exp_f32 v36, v36
  v_exp_f32 v37, v37
  v_mfma_f32_16x16x32_bf16 v[132:135], v[236:239], v[220:223], v[132:135]
  v_exp_f32 v38, v38
  v_exp_f32 v39, v39
  v_cvt_pk_bf16_f32 v48, v32, v33
  v_cvt_pk_bf16_f32 v49, v34, v35
  v_mfma_f32_32x32x16_bf16 v[56:71], v[92:95], v[52:55], v[56:71]
  s_mov_b64 exec, s[46:47]
  ds_read_b128 v[88:91], v112 offset:30720
  ds_read_b128 v[92:95], v112 offset:31360
  s_mov_b64 exec, -1
  v_cvt_pk_bf16_f32 v50, v36, v37
  v_cvt_pk_bf16_f32 v51, v38, v39
  v_exp_f32 v40, v40
  v_exp_f32 v41, v41
  v_exp_f32 v42, v42
  v_exp_f32 v43, v43
  s_waitcnt lgkmcnt(5)
  v_mfma_f32_32x32x16_bf16 v[56:71], v[96:99], v[48:51], v[56:71]
  s_add_u32 s50, s66, 1966080
  buffer_load_dwordx4 v[208:211], v120, s[16:19], s50 offen offset:2048
  buffer_load_dwordx4 v[212:215], v120, s[16:19], s50 offen offset:3072
  v_exp_f32 v44, v44
  v_exp_f32 v45, v45
  v_exp_f32 v46, v46
  v_exp_f32 v47, v47
  v_cvt_pk_bf16_f32 v52, v40, v41
  v_cvt_pk_bf16_f32 v53, v42, v43
  v_cvt_pk_bf16_f32 v54, v44, v45
  v_cvt_pk_bf16_f32 v55, v46, v47
  s_add_u32 s50, s38, 8
  s_min_u32 s50, s50, 99
  s_mul_i32 s51, s50, 205
  s_lshr_b32 s51, s51, 10
  s_mul_i32 s51, s51, 35840
  s_lshl_b32 s50, s50, 10
  s_add_u32 m0, s50, 40960
  s_add_u32 s50, s50, s51
  s_add_u32 s50, s50, s62
  buffer_load_dwordx4 v120, s[16:19], s50 offen lds
  s_setprio 3
  s_waitcnt lgkmcnt(2)
  v_mfma_f32_32x32x16_bf16 v[32:47], v[76:79], v[8:11], 0
  v_exp_f32 v16, v16
  v_exp_f32 v17, v17
  v_mfma_f32_16x16x32_bf16 v[152:155], v[236:239], v[224:227], v[152:155]
  v_exp_f32 v18, v18
  v_exp_f32 v19, v19
  v_mfma_f32_32x32x16_bf16 v[32:47], v[84:87], v[12:15], v[32:47]
  ds_read_b128 v[72:75], v110 offset:31744
  ds_read_b64 v[80:81], v111 offset:31232
  v_exp_f32 v20, v20
  v_exp_f32 v21, v21
  v_mfma_f32_16x16x32_bf16 v[136:139], v[240:243], v[220:223], v[136:139]
  v_exp_f32 v22, v22
  v_exp_f32 v23, v23
  v_cvt_pk_bf16_f32 v48, v16, v17
  v_cvt_pk_bf16_f32 v49, v18, v19
  v_mfma_f32_32x32x16_bf16 v[56:71], v[100:103], v[52:55], v[56:71]
  s_mov_b64 exec, s[46:47]
  ds_read_b128 v[96:99], v112 offset:32000
  ds_read_b128 v[100:103], v112 offset:32640
  s_mov_b64 exec, -1
  v_cvt_pk_bf16_f32 v50, v20, v21
  v_cvt_pk_bf16_f32 v51, v22, v23
  v_exp_f32 v24, v24
  v_exp_f32 v25, v25
  v_exp_f32 v26, v26
  v_exp_f32 v27, v27
  s_waitcnt lgkmcnt(5)
  v_mfma_f32_32x32x16_bf16 v[56:71], v[88:91], v[48:51], v[56:71]
  s_add_u32 s50, s66, 1970176
  buffer_load_dwordx4 v[216:219], v120, s[16:19], s50 offen
  s_add_u32 s50, s64, 28672
  buffer_load_dwordx4 v[192:195], v120, s[16:19], s50 offen
  v_exp_f32 v28, v28
  v_exp_f32 v29, v29
  v_exp_f32 v30, v30
  v_exp_f32 v31, v31
  v_cvt_pk_bf16_f32 v52, v24, v25
  v_cvt_pk_bf16_f32 v53, v26, v27
  v_cvt_pk_bf16_f32 v54, v28, v29
  v_cvt_pk_bf16_f32 v55, v30, v31
  s_add_u32 s50, s38, 16
  s_min_u32 s50, s50, 99
  s_mul_i32 s51, s50, 205
  s_lshr_b32 s51, s51, 10
  s_mul_i32 s51, s51, 35840
  s_lshl_b32 s50, s50, 10
  s_add_u32 m0, s50, 40960
  s_add_u32 s50, s50, s51
  s_add_u32 s50, s50, s62
  buffer_load_dwordx4 v120, s[16:19], s50 offen lds
  s_setprio 2
  s_waitcnt lgkmcnt(2)
  v_mfma_f32_32x32x16_bf16 v[16:31], v[72:75], v[8:11], 0
  v_exp_f32 v32, v32
  v_exp_f32 v33, v33
  v_mfma_f32_16x16x32_bf16 v[156:159], v[240:243], v[224:227], v[156:159]
  v_exp_f32 v34, v34
  v_exp_f32 v35, v35
  v_mfma_f32_32x32x16_bf16 v[16:31], v[80:83], v[12:15], v[16:31]
  ds_read_b128 v[76:79], v110 offset:32256
  ds_read_b64 v[84:85], v111 offset:31488
  v_exp_f32 v36, v36
  v_exp_f32 v37, v37
  v_mfma_f32_16x16x32_bf16 v[140:143], v[244:247], v[220:223], v[140:143]
  v_exp_f32 v38, v38
  v_exp_f32 v39, v39
  v_cvt_pk_bf16_f32 v48, v32, v33
  v_cvt_pk_bf16_f32 v49, v34, v35
  v_mfma_f32_32x32x16_bf16 v[56:71], v[92:95], v[52:55], v[56:71]
  s_mov_b64 exec, s[46:47]
  ds_read_b128 v[88:91], v112 offset:33280
  ds_read_b128 v[92:95], v112 offset:33920
  s_mov_b64 exec, -1
  v_cvt_pk_bf16_f32 v50, v36, v37
  v_cvt_pk_bf16_f32 v51, v38, v39
  v_exp_f32 v40, v40
  v_exp_f32 v41, v41
  v_mfma_f32_16x16x32_bf16 v[160:163], v[244:247], v[224:227], v[160:163]
  v_exp_f32 v42, v42
  v_exp_f32 v43, v43
  s_waitcnt lgkmcnt(5)
  v_mfma_f32_32x32x16_bf16 v[56:71], v[96:99], v[48:51], v[56:71]
  s_add_u32 s50, s64, 77824
  buffer_load_dwordx4 v[196:199], v120, s[16:19], s50 offen
  v_exp_f32 v44, v44
  v_exp_f32 v45, v45
  v_exp_f32 v46, v46
  v_exp_f32 v47, v47
  v_cvt_pk_bf16_f32 v52, v40, v41
  v_cvt_pk_bf16_f32 v53, v42, v43
  v_cvt_pk_bf16_f32 v54, v44, v45
  v_cvt_pk_bf16_f32 v55, v46, v47
  s_add_u32 s50, s38, 24
  s_min_u32 s50, s50, 99
  s_mul_i32 s51, s50, 205
  s_lshr_b32 s51, s51, 10
  s_mul_i32 s51, s51, 35840
  s_lshl_b32 s50, s50, 10
  s_add_u32 m0, s50, 40960
  s_add_u32 s50, s50, s51
  s_add_u32 s50, s50, s62
  buffer_load_dwordx4 v120, s[16:19], s50 offen lds
  s_setprio 1
  s_waitcnt lgkmcnt(2)
  v_mfma_f32_32x32x16_bf16 v[32:47], v[76:79], v[8:11], 0
  v_exp_f32 v16, v16
  v_exp_f32 v17, v17
  s_waitcnt vmcnt(11)
  v_mfma_f32_16x16x32_bf16 v[124:127], v[172:175], v[164:167], v[124:127]
  v_exp_f32 v18, v18
  v_exp_f32 v19, v19
  v_mfma_f32_32x32x16_bf16 v[32:47], v[84:87], v[12:15], v[32:47]
  ds_read_b128 v[72:75], v104 offset:0
  ds_read_b64 v[80:81], v105 offset:0
  v_exp_f32 v20, v20
  v_exp_f32 v21, v21
  v_mfma_f32_16x16x32_bf16 v[144:147], v[172:175], v[168:171], v[144:147]
  v_exp_f32 v22, v22
  v_exp_f32 v23, v23
  v_cvt_pk_bf16_f32 v48, v16, v17
  v_cvt_pk_bf16_f32 v49, v18, v19
  v_mfma_f32_32x32x16_bf16 v[56:71], v[100:103], v[52:55], v[56:71]
  s_mov_b64 exec, s[46:47]
  ds_read_b128 v[96:99], v112 offset:34560
  ds_read_b128 v[100:103], v112 offset:35200
  s_mov_b64 exec, -1
  v_cvt_pk_bf16_f32 v50, v20, v21
  v_cvt_pk_bf16_f32 v51, v22, v23
  v_exp_f32 v24, v24
  v_exp_f32 v25, v25
  v_exp_f32 v26, v26
  v_exp_f32 v27, v27
  s_waitcnt lgkmcnt(5)
  v_mfma_f32_32x32x16_bf16 v[56:71], v[88:91], v[48:51], v[56:71]
  v_exp_f32 v28, v28
  v_exp_f32 v29, v29
  v_exp_f32 v30, v30
  v_exp_f32 v31, v31
  v_cvt_pk_bf16_f32 v52, v24, v25
  v_cvt_pk_bf16_f32 v53, v26, v27
  v_cvt_pk_bf16_f32 v54, v28, v29
  v_cvt_pk_bf16_f32 v55, v30, v31
  s_add_u32 s50, s38, 32
  s_min_u32 s50, s50, 99
  s_mul_i32 s51, s50, 205
  s_lshr_b32 s51, s51, 10
  s_mul_i32 s51, s51, 35840
  s_lshl_b32 s50, s50, 10
  s_add_u32 m0, s50, 40960
  s_add_u32 s50, s50, s51
  s_add_u32 s50, s50, s62
  buffer_load_dwordx4 v120, s[16:19], s50 offen lds
  s_setprio 0
  s_waitcnt lgkmcnt(2)
  v_mfma_f32_32x32x16_bf16 v[16:31], v[72:75], v[8:11], 0
  v_exp_f32 v32, v32
  v_exp_f32 v33, v33
  v_mfma_f32_16x16x32_bf16 v[128:131], v[176:179], v[164:167], v[128:131]
  v_exp_f32 v34, v34
  v_exp_f32 v35, v35
  v_mfma_f32_32x32x16_bf16 v[16:31], v[80:83], v[12:15], v[16:31]
  ds_read_b128 v[76:79], v104 offset:512
  ds_read_b64 v[84:85], v105 offset:256
  v_exp_f32 v36, v36
  v_exp_f32 v37, v37
  v_mfma_f32_16x16x32_bf16 v[148:151], v[176:179], v[168:171], v[148:151]
  v_exp_f32 v38, v38
  v_exp_f32 v39, v39
  v_cvt_pk_bf16_f32 v48, v32, v33
  v_cvt_pk_bf16_f32 v49, v34, v35
  v_mfma_f32_32x32x16_bf16 v[56:71], v[92:95], v[52:55], v[56:71]
  s_mov_b64 exec, s[46:47]
  ds_read_b128 v[88:91], v106 offset:0
  ds_read_b128 v[92:95], v106 offset:640
  s_mov_b64 exec, -1
  v_cvt_pk_bf16_f32 v50, v36, v37
  v_cvt_pk_bf16_f32 v51, v38, v39
  v_exp_f32 v40, v40
  v_exp_f32 v41, v41
  v_exp_f32 v42, v42
  v_exp_f32 v43, v43
  s_waitcnt lgkmcnt(5)
  v_mfma_f32_32x32x16_bf16 v[56:71], v[96:99], v[48:51], v[56:71]
  s_add_u32 s50, s66, 2129920
  buffer_load_dwordx4 v[228:231], v120, s[16:19], s50 offen offset:0
  buffer_load_dwordx4 v[232:235], v120, s[16:19], s50 offen offset:1024
  v_exp_f32 v44, v44
  v_exp_f32 v45, v45
  v_exp_f32 v46, v46
  v_exp_f32 v47, v47
  v_cvt_pk_bf16_f32 v52, v40, v41
  v_cvt_pk_bf16_f32 v53, v42, v43
  v_cvt_pk_bf16_f32 v54, v44, v45
  v_cvt_pk_bf16_f32 v55, v46, v47
  s_add_u32 s50, s38, 40
  s_min_u32 s50, s50, 99
  s_mul_i32 s51, s50, 205
  s_lshr_b32 s51, s51, 10
  s_mul_i32 s51, s51, 35840
  s_lshl_b32 s50, s50, 10
  s_add_u32 m0, s50, 40960
  s_add_u32 s50, s50, s51
  s_add_u32 s50, s50, s62
  buffer_load_dwordx4 v120, s[16:19], s50 offen lds
  s_setprio 3
  s_waitcnt lgkmcnt(2)
  v_mfma_f32_32x32x16_bf16 v[32:47], v[76:79], v[8:11], 0
  v_exp_f32 v16, v16
  v_exp_f32 v17, v17
  v_mfma_f32_16x16x32_bf16 v[132:135], v[180:183], v[164:167], v[132:135]
  v_exp_f32 v18, v18
  v_exp_f32 v19, v19
  v_mfma_f32_32x32x16_bf16 v[32:47], v[84:87], v[12:15], v[32:47]
  ds_read_b128 v[72:75], v104 offset:1024
  ds_read_b64 v[80:81], v105 offset:512
  v_exp_f32 v20, v20
  v_exp_f32 v21, v21
  v_mfma_f32_16x16x32_bf16 v[152:155], v[180:183], v[168:171], v[152:155]
  v_exp_f32 v22, v22
  v_exp_f32 v23, v23
  v_cvt_pk_bf16_f32 v48, v16, v17
  v_cvt_pk_bf16_f32 v49, v18, v19
  v_mfma_f32_32x32x16_bf16 v[56:71], v[100:103], v[52:55], v[56:71]
  s_mov_b64 exec, s[46:47]
  ds_read_b128 v[96:99], v106 offset:1280
  ds_read_b128 v[100:103], v106 offset:1920
  s_mov_b64 exec, -1
  v_cvt_pk_bf16_f32 v50, v20, v21
  v_cvt_pk_bf16_f32 v51, v22, v23
  v_exp_f32 v24, v24
  v_exp_f32 v25, v25
  v_exp_f32 v26, v26
  v_exp_f32 v27, v27
  s_waitcnt lgkmcnt(5)
  v_mfma_f32_32x32x16_bf16 v[56:71], v[88:91], v[48:51], v[56:71]
  s_add_u32 s50, s66, 2129920
  buffer_load_dwordx4 v[236:239], v120, s[16:19], s50 offen offset:2048
  buffer_load_dwordx4 v[240:243], v120, s[16:19], s50 offen offset:3072
  v_exp_f32 v28, v28
  v_exp_f32 v29, v29
  v_exp_f32 v30, v30
  v_exp_f32 v31, v31
  v_cvt_pk_bf16_f32 v52, v24, v25
  v_cvt_pk_bf16_f32 v53, v26, v27
  v_cvt_pk_bf16_f32 v54, v28, v29
  v_cvt_pk_bf16_f32 v55, v30, v31
  s_add_u32 s50, s38, 48
  s_min_u32 s50, s50, 99
  s_mul_i32 s51, s50, 205
  s_lshr_b32 s51, s51, 10
  s_mul_i32 s51, s51, 35840
  s_lshl_b32 s50, s50, 10
  s_add_u32 m0, s50, 40960
  s_add_u32 s50, s50, s51
  s_add_u32 s50, s50, s62
  buffer_load_dwordx4 v120, s[16:19], s50 offen lds
  s_setprio 2
  s_waitcnt lgkmcnt(2)
  v_mfma_f32_32x32x16_bf16 v[16:31], v[72:75], v[8:11], 0
  v_exp_f32 v32, v32
  v_exp_f32 v33, v33
  v_mfma_f32_16x16x32_bf16 v[136:139], v[184:187], v[164:167], v[136:139]
  v_exp_f32 v34, v34
  v_exp_f32 v35, v35
  v_mfma_f32_32x32x16_bf16 v[16:31], v[80:83], v[12:15], v[16:31]
  ds_read_b128 v[76:79], v104 offset:1536
  ds_read_b64 v[84:85], v105 offset:768
  v_exp_f32 v36, v36
  v_exp_f32 v37, v37
  v_mfma_f32_16x16x32_bf16 v[156:159], v[184:187], v[168:171], v[156:159]
  v_exp_f32 v38, v38
  v_exp_f32 v39, v39
  v_cvt_pk_bf16_f32 v48, v32, v33
  v_cvt_pk_bf16_f32 v49, v34, v35
  v_mfma_f32_32x32x16_bf16 v[56:71], v[92:95], v[52:55], v[56:71]
  s_mov_b64 exec, s[46:47]
  ds_read_b128 v[88:91], v106 offset:2560
  ds_read_b128 v[92:95], v106 offset:3200
  s_mov_b64 exec, -1
  v_cvt_pk_bf16_f32 v50, v36, v37
  v_cvt_pk_bf16_f32 v51, v38, v39
  v_exp_f32 v40, v40
  v_exp_f32 v41, v41
  v_mfma_f32_16x16x32_bf16 v[140:143], v[188:191], v[164:167], v[140:143]
  v_exp_f32 v42, v42
  v_exp_f32 v43, v43
  s_waitcnt lgkmcnt(5)
  v_mfma_f32_32x32x16_bf16 v[56:71], v[96:99], v[48:51], v[56:71]
  s_add_u32 s50, s66, 2134016
  buffer_load_dwordx4 v[244:247], v120, s[16:19], s50 offen
  s_add_u32 s50, s64, 32768
  buffer_load_dwordx4 v[220:223], v120, s[16:19], s50 offen
  v_exp_f32 v44, v44
  v_exp_f32 v45, v45
  v_exp_f32 v46, v46
  v_exp_f32 v47, v47
  v_cvt_pk_bf16_f32 v52, v40, v41
  v_cvt_pk_bf16_f32 v53, v42, v43
  v_cvt_pk_bf16_f32 v54, v44, v45
  v_cvt_pk_bf16_f32 v55, v46, v47
  s_add_u32 s50, s38, 56
  s_min_u32 s50, s50, 99
  s_mul_i32 s51, s50, 205
  s_lshr_b32 s51, s51, 10
  s_mul_i32 s51, s51, 35840
  s_lshl_b32 s50, s50, 10
  s_add_u32 m0, s50, 40960
  s_add_u32 s50, s50, s51
  s_add_u32 s50, s50, s62
  buffer_load_dwordx4 v120, s[16:19], s50 offen lds
  s_setprio 1
  s_waitcnt lgkmcnt(2)
  v_mfma_f32_32x32x16_bf16 v[32:47], v[76:79], v[8:11], 0
  v_exp_f32 v16, v16
  v_exp_f32 v17, v17
  v_mfma_f32_16x16x32_bf16 v[160:163], v[188:191], v[168:171], v[160:163]
  v_exp_f32 v18, v18
  v_exp_f32 v19, v19
  v_mfma_f32_32x32x16_bf16 v[32:47], v[84:87], v[12:15], v[32:47]
  ds_read_b128 v[72:75], v104 offset:10240
  ds_read_b64 v[80:81], v105 offset:10240
  v_exp_f32 v20, v20
  v_exp_f32 v21, v21
  s_waitcnt vmcnt(11)
  v_mfma_f32_16x16x32_bf16 v[124:127], v[200:203], v[192:195], v[124:127]
  v_exp_f32 v22, v22
  v_exp_f32 v23, v23
  v_cvt_pk_bf16_f32 v48, v16, v17
  v_cvt_pk_bf16_f32 v49, v18, v19
  v_mfma_f32_32x32x16_bf16 v[56:71], v[100:103], v[52:55], v[56:71]
  s_mov_b64 exec, s[46:47]
  ds_read_b128 v[96:99], v106 offset:3840
  ds_read_b128 v[100:103], v106 offset:4480
  s_mov_b64 exec, -1
  v_cvt_pk_bf16_f32 v50, v20, v21
  v_cvt_pk_bf16_f32 v51, v22, v23
  v_exp_f32 v24, v24
  v_exp_f32 v25, v25
  v_exp_f32 v26, v26
  v_exp_f32 v27, v27
  s_waitcnt lgkmcnt(5)
  v_mfma_f32_32x32x16_bf16 v[56:71], v[88:91], v[48:51], v[56:71]
  s_add_u32 s50, s64, 81920
  buffer_load_dwordx4 v[224:227], v120, s[16:19], s50 offen
  v_exp_f32 v28, v28
  v_exp_f32 v29, v29
  v_exp_f32 v30, v30
  v_exp_f32 v31, v31
  v_cvt_pk_bf16_f32 v52, v24, v25
  v_cvt_pk_bf16_f32 v53, v26, v27
  v_cvt_pk_bf16_f32 v54, v28, v29
  v_cvt_pk_bf16_f32 v55, v30, v31
  s_add_u32 s50, s38, 64
  s_min_u32 s50, s50, 99
  s_mul_i32 s51, s50, 205
  s_lshr_b32 s51, s51, 10
  s_mul_i32 s51, s51, 35840
  s_lshl_b32 s50, s50, 10
  s_add_u32 m0, s50, 40960
  s_add_u32 s50, s50, s51
  s_add_u32 s50, s50, s62
  buffer_load_dwordx4 v120, s[16:19], s50 offen lds
  s_setprio 0
  s_waitcnt lgkmcnt(2)
  v_mfma_f32_32x32x16_bf16 v[16:31], v[72:75], v[8:11], 0
  v_exp_f32 v32, v32
  v_exp_f32 v33, v33
  v_mfma_f32_16x16x32_bf16 v[144:147], v[200:203], v[196:199], v[144:147]
  v_exp_f32 v34, v34
  v_exp_f32 v35, v35
  v_mfma_f32_32x32x16_bf16 v[16:31], v[80:83], v[12:15], v[16:31]
  ds_read_b128 v[76:79], v104 offset:10752
  ds_read_b64 v[84:85], v105 offset:10496
  v_exp_f32 v36, v36
  v_exp_f32 v37, v37
  v_mfma_f32_16x16x32_bf16 v[128:131], v[204:207], v[192:195], v[128:131]
  v_exp_f32 v38, v38
  v_exp_f32 v39, v39
  v_cvt_pk_bf16_f32 v48, v32, v33
  v_cvt_pk_bf16_f32 v49, v34, v35
  v_mfma_f32_32x32x16_bf16 v[56:71], v[92:95], v[52:55], v[56:71]
  s_mov_b64 exec, s[46:47]
  ds_read_b128 v[88:91], v106 offset:10240
  ds_read_b128 v[92:95], v106 offset:10880
  s_mov_b64 exec, -1
  v_cvt_pk_bf16_f32 v50, v36, v37
  v_cvt_pk_bf16_f32 v51, v38, v39
  v_exp_f32 v40, v40
  v_exp_f32 v41, v41
  v_exp_f32 v42, v42
  v_exp_f32 v43, v43
  s_waitcnt lgkmcnt(5)
  v_mfma_f32_32x32x16_bf16 v[56:71], v[96:99], v[48:51], v[56:71]
  s_add_u32 s50, s66, 2293760
  buffer_load_dwordx4 v[172:175], v120, s[16:19], s50 offen offset:0
  buffer_load_dwordx4 v[176:179], v120, s[16:19], s50 offen offset:1024
  v_exp_f32 v44, v44
  v_exp_f32 v45, v45
  v_exp_f32 v46, v46
  v_exp_f32 v47, v47
  v_cvt_pk_bf16_f32 v52, v40, v41
  v_cvt_pk_bf16_f32 v53, v42, v43
  v_cvt_pk_bf16_f32 v54, v44, v45
  v_cvt_pk_bf16_f32 v55, v46, v47
  s_add_u32 s50, s38, 72
  s_min_u32 s50, s50, 99
  s_mul_i32 s51, s50, 205
  s_lshr_b32 s51, s51, 10
  s_mul_i32 s51, s51, 35840
  s_lshl_b32 s50, s50, 10
  s_add_u32 m0, s50, 40960
  s_add_u32 s50, s50, s51
  s_add_u32 s50, s50, s62
  buffer_load_dwordx4 v120, s[16:19], s50 offen lds
  s_setprio 3
  s_waitcnt lgkmcnt(2)
  v_mfma_f32_32x32x16_bf16 v[32:47], v[76:79], v[8:11], 0
  v_exp_f32 v16, v16
  v_exp_f32 v17, v17
  v_mfma_f32_16x16x32_bf16 v[148:151], v[204:207], v[196:199], v[148:151]
  v_exp_f32 v18, v18
  v_exp_f32 v19, v19
  v_mfma_f32_32x32x16_bf16 v[32:47], v[84:87], v[12:15], v[32:47]
  ds_read_b128 v[72:75], v104 offset:11264
  ds_read_b64 v[80:81], v105 offset:10752
  v_exp_f32 v20, v20
  v_exp_f32 v21, v21
  v_mfma_f32_16x16x32_bf16 v[132:135], v[208:211], v[192:195], v[132:135]
  v_exp_f32 v22, v22
  v_exp_f32 v23, v23
  v_cvt_pk_bf16_f32 v48, v16, v17
  v_cvt_pk_bf16_f32 v49, v18, v19
  v_mfma_f32_32x32x16_bf16 v[56:71], v[100:103], v[52:55], v[56:71]
  s_mov_b64 exec, s[46:47]
  ds_read_b128 v[96:99], v106 offset:11520
  ds_read_b128 v[100:103], v106 offset:12160
  s_mov_b64 exec, -1
  v_cvt_pk_bf16_f32 v50, v20, v21
  v_cvt_pk_bf16_f32 v51, v22, v23
  v_exp_f32 v24, v24
  v_exp_f32 v25, v25
  v_exp_f32 v26, v26
  v_exp_f32 v27, v27
  s_waitcnt lgkmcnt(5)
  v_mfma_f32_32x32x16_bf16 v[56:71], v[88:91], v[48:51], v[56:71]
  s_add_u32 s50, s66, 2293760
  buffer_load_dwordx4 v[180:183], v120, s[16:19], s50 offen offset:2048
  buffer_load_dwordx4 v[184:187], v120, s[16:19], s50 offen offset:3072
  v_exp_f32 v28, v28
  v_exp_f32 v29, v29
  v_exp_f32 v30, v30
  v_exp_f32 v31, v31
  v_cvt_pk_bf16_f32 v52, v24, v25
  v_cvt_pk_bf16_f32 v53, v26, v27
  v_cvt_pk_bf16_f32 v54, v28, v29
  v_cvt_pk_bf16_f32 v55, v30, v31
  s_add_u32 s50, s38, 80
  s_min_u32 s50, s50, 99
  s_mul_i32 s51, s50, 205
  s_lshr_b32 s51, s51, 10
  s_mul_i32 s51, s51, 35840
  s_lshl_b32 s50, s50, 10
  s_add_u32 m0, s50, 40960
  s_add_u32 s50, s50, s51
  s_add_u32 s50, s50, s62
  buffer_load_dwordx4 v120, s[16:19], s50 offen lds
  s_setprio 2
  s_waitcnt lgkmcnt(2)
  v_mfma_f32_32x32x16_bf16 v[16:31], v[72:75], v[8:11], 0
  v_exp_f32 v32, v32
  v_exp_f32 v33, v33
  v_mfma_f32_16x16x32_bf16 v[152:155], v[208:211], v[196:199], v[152:155]
  v_exp_f32 v34, v34
  v_exp_f32 v35, v35
  v_mfma_f32_32x32x16_bf16 v[16:31], v[80:83], v[12:15], v[16:31]
  ds_read_b128 v[76:79], v104 offset:11776
  ds_read_b64 v[84:85], v105 offset:11008
  v_exp_f32 v36, v36
  v_exp_f32 v37, v37
  v_mfma_f32_16x16x32_bf16 v[136:139], v[212:215], v[192:195], v[136:139]
  v_exp_f32 v38, v38
  v_exp_f32 v39, v39
  v_cvt_pk_bf16_f32 v48, v32, v33
  v_cvt_pk_bf16_f32 v49, v34, v35
  v_mfma_f32_32x32x16_bf16 v[56:71], v[92:95], v[52:55], v[56:71]
  s_mov_b64 exec, s[46:47]
  ds_read_b128 v[88:91], v106 offset:12800
  ds_read_b128 v[92:95], v106 offset:13440
  s_mov_b64 exec, -1
  v_cvt_pk_bf16_f32 v50, v36, v37
  v_cvt_pk_bf16_f32 v51, v38, v39
  v_exp_f32 v40, v40
  v_exp_f32 v41, v41
  v_mfma_f32_16x16x32_bf16 v[156:159], v[212:215], v[196:199], v[156:159]
  v_exp_f32 v42, v42
  v_exp_f32 v43, v43
  s_waitcnt lgkmcnt(5)
  v_mfma_f32_32x32x16_bf16 v[56:71], v[96:99], v[48:51], v[56:71]
  s_add_u32 s50, s66, 2297856
  buffer_load_dwordx4 v[188:191], v120, s[16:19], s50 offen
  s_add_u32 s50, s64, 36864
  buffer_load_dwordx4 v[164:167], v120, s[16:19], s50 offen
  v_exp_f32 v44, v44
  v_exp_f32 v45, v45
  v_exp_f32 v46, v46
  v_exp_f32 v47, v47
  v_cvt_pk_bf16_f32 v52, v40, v41
  v_cvt_pk_bf16_f32 v53, v42, v43
  v_cvt_pk_bf16_f32 v54, v44, v45
  v_cvt_pk_bf16_f32 v55, v46, v47
  s_add_u32 s50, s38, 88
  s_min_u32 s50, s50, 99
  s_mul_i32 s51, s50, 205
  s_lshr_b32 s51, s51, 10
  s_mul_i32 s51, s51, 35840
  s_lshl_b32 s50, s50, 10
  s_add_u32 m0, s50, 40960
  s_add_u32 s50, s50, s51
  s_add_u32 s50, s50, s62
  buffer_load_dwordx4 v120, s[16:19], s50 offen lds
  s_setprio 1
  s_waitcnt lgkmcnt(2)
  v_mfma_f32_32x32x16_bf16 v[32:47], v[76:79], v[8:11], 0
  v_exp_f32 v16, v16
  v_exp_f32 v17, v17
  v_mfma_f32_16x16x32_bf16 v[140:143], v[216:219], v[192:195], v[140:143]
  v_exp_f32 v18, v18
  v_exp_f32 v19, v19
  v_mfma_f32_32x32x16_bf16 v[32:47], v[84:87], v[12:15], v[32:47]
  ds_read_b128 v[72:75], v104 offset:20480
  ds_read_b64 v[80:81], v105 offset:20480
  v_exp_f32 v20, v20
  v_exp_f32 v21, v21
  v_mfma_f32_16x16x32_bf16 v[160:163], v[216:219], v[196:199], v[160:163]
  v_exp_f32 v22, v22
  v_exp_f32 v23, v23
  v_cvt_pk_bf16_f32 v48, v16, v17
  v_cvt_pk_bf16_f32 v49, v18, v19
  v_mfma_f32_32x32x16_bf16 v[56:71], v[100:103], v[52:55], v[56:71]
  s_mov_b64 exec, s[46:47]
  ds_read_b128 v[96:99], v106 offset:14080
  ds_read_b128 v[100:103], v106 offset:14720
  s_mov_b64 exec, -1
  v_cvt_pk_bf16_f32 v50, v20, v21
  v_cvt_pk_bf16_f32 v51, v22, v23
  v_exp_f32 v24, v24
  v_exp_f32 v25, v25
  v_exp_f32 v26, v26
  v_exp_f32 v27, v27
  s_waitcnt lgkmcnt(5)
  v_mfma_f32_32x32x16_bf16 v[56:71], v[88:91], v[48:51], v[56:71]
  s_add_u32 s50, s64, 86016
  buffer_load_dwordx4 v[168:171], v120, s[16:19], s50 offen
  v_exp_f32 v28, v28
  v_exp_f32 v29, v29
  v_exp_f32 v30, v30
  v_exp_f32 v31, v31
  v_cvt_pk_bf16_f32 v52, v24, v25
  v_cvt_pk_bf16_f32 v53, v26, v27
  v_cvt_pk_bf16_f32 v54, v28, v29
  v_cvt_pk_bf16_f32 v55, v30, v31
  s_add_u32 s50, s38, 96
  s_min_u32 s50, s50, 99
  s_mul_i32 s51, s50, 205
  s_lshr_b32 s51, s51, 10
  s_mul_i32 s51, s51, 35840
  s_lshl_b32 s50, s50, 10
  s_add_u32 m0, s50, 40960
  s_add_u32 s50, s50, s51
  s_add_u32 s50, s50, s62
  buffer_load_dwordx4 v120, s[16:19], s50 offen lds
  s_setprio 0
  s_waitcnt lgkmcnt(2)
  v_mfma_f32_32x32x16_bf16 v[16:31], v[72:75], v[8:11], 0
  v_exp_f32 v32, v32
  v_exp_f32 v33, v33
  s_waitcnt vmcnt(12)
  v_mfma_f32_16x16x32_bf16 v[124:127], v[228:231], v[220:223], v[124:127]
  v_exp_f32 v34, v34
  v_exp_f32 v35, v35
  v_mfma_f32_32x32x16_bf16 v[16:31], v[80:83], v[12:15], v[16:31]
  ds_read_b128 v[76:79], v104 offset:20992
  ds_read_b64 v[84:85], v105 offset:20736
  v_exp_f32 v36, v36
  v_exp_f32 v37, v37
  v_mfma_f32_16x16x32_bf16 v[144:147], v[228:231], v[224:227], v[144:147]
  v_exp_f32 v38, v38
  v_exp_f32 v39, v39
  v_cvt_pk_bf16_f32 v48, v32, v33
  v_cvt_pk_bf16_f32 v49, v34, v35
  v_mfma_f32_32x32x16_bf16 v[56:71], v[92:95], v[52:55], v[56:71]
  s_mov_b64 exec, s[46:47]
  ds_read_b128 v[88:91], v106 offset:20480
  ds_read_b128 v[92:95], v106 offset:21120
  s_mov_b64 exec, -1
  v_cvt_pk_bf16_f32 v50, v36, v37
  v_cvt_pk_bf16_f32 v51, v38, v39
  v_exp_f32 v40, v40
  v_exp_f32 v41, v41
  v_exp_f32 v42, v42
  v_exp_f32 v43, v43
  s_waitcnt lgkmcnt(5)
  v_mfma_f32_32x32x16_bf16 v[56:71], v[96:99], v[48:51], v[56:71]
  v_exp_f32 v44, v44
  v_exp_f32 v45, v45
  v_exp_f32 v46, v46
  v_exp_f32 v47, v47
  v_cvt_pk_bf16_f32 v52, v40, v41
  v_cvt_pk_bf16_f32 v53, v42, v43
  v_cvt_pk_bf16_f32 v54, v44, v45
  v_cvt_pk_bf16_f32 v55, v46, v47
  s_setprio 3
  s_waitcnt lgkmcnt(2)
  v_mfma_f32_32x32x16_bf16 v[32:47], v[76:79], v[8:11], 0
  v_exp_f32 v16, v16
  v_exp_f32 v17, v17
  v_mfma_f32_16x16x32_bf16 v[128:131], v[232:235], v[220:223], v[128:131]
  v_exp_f32 v18, v18
  v_exp_f32 v19, v19
  v_mfma_f32_32x32x16_bf16 v[32:47], v[84:87], v[12:15], v[32:47]
  ds_read_b128 v[72:75], v104 offset:21504
  ds_read_b64 v[80:81], v105 offset:20992
  v_exp_f32 v20, v20
  v_exp_f32 v21, v21
  v_mfma_f32_16x16x32_bf16 v[148:151], v[232:235], v[224:227], v[148:151]
  v_exp_f32 v22, v22
  v_exp_f32 v23, v23
  v_cvt_pk_bf16_f32 v48, v16, v17
  v_cvt_pk_bf16_f32 v49, v18, v19
  v_mfma_f32_32x32x16_bf16 v[56:71], v[100:103], v[52:55], v[56:71]
  s_mov_b64 exec, s[46:47]
  ds_read_b128 v[96:99], v106 offset:21760
  ds_read_b128 v[100:103], v106 offset:22400
  s_mov_b64 exec, -1
  v_cvt_pk_bf16_f32 v50, v20, v21
  v_cvt_pk_bf16_f32 v51, v22, v23
  v_exp_f32 v24, v24
  v_exp_f32 v25, v25
  v_mfma_f32_16x16x32_bf16 v[132:135], v[236:239], v[220:223], v[132:135]
  v_exp_f32 v26, v26
  v_exp_f32 v27, v27
  s_waitcnt lgkmcnt(5)
  v_mfma_f32_32x32x16_bf16 v[56:71], v[88:91], v[48:51], v[56:71]
  s_add_u32 s50, s66, 2457600
  buffer_load_dwordx4 v[200:203], v120, s[16:19], s50 offen offset:0
  buffer_load_dwordx4 v[204:207], v120, s[16:19], s50 offen offset:1024
  v_exp_f32 v28, v28
  v_exp_f32 v29, v29
  v_exp_f32 v30, v30
  v_exp_f32 v31, v31
  v_cvt_pk_bf16_f32 v52, v24, v25
  v_cvt_pk_bf16_f32 v53, v26, v27
  v_cvt_pk_bf16_f32 v54, v28, v29
  v_cvt_pk_bf16_f32 v55, v30, v31
  s_setprio 2
  s_waitcnt lgkmcnt(2)
  v_mfma_f32_32x32x16_bf16 v[16:31], v[72:75], v[8:11], 0
  v_exp_f32 v32, v32
  v_exp_f32 v33, v33
  v_mfma_f32_16x16x32_bf16 v[152:155], v[236:239], v[224:227], v[152:155]
  v_exp_f32 v34, v34
  v_exp_f32 v35, v35
  v_mfma_f32_32x32x16_bf16 v[16:31], v[80:83], v[12:15], v[16:31]
  ds_read_b128 v[76:79], v104 offset:22016
  ds_read_b64 v[84:85], v105 offset:21248
  v_exp_f32 v36, v36
  v_exp_f32 v37, v37
  v_mfma_f32_16x16x32_bf16 v[136:139], v[240:243], v[220:223], v[136:139]
  v_exp_f32 v38, v38
  v_exp_f32 v39, v39
  v_cvt_pk_bf16_f32 v48, v32, v33
  v_cvt_pk_bf16_f32 v49, v34, v35
  v_mfma_f32_32x32x16_bf16 v[56:71], v[92:95], v[52:55], v[56:71]
  s_mov_b64 exec, s[46:47]
  ds_read_b128 v[88:91], v106 offset:23040
  ds_read_b128 v[92:95], v106 offset:23680
  s_mov_b64 exec, -1
  v_cvt_pk_bf16_f32 v50, v36, v37
  v_cvt_pk_bf16_f32 v51, v38, v39
  v_exp_f32 v40, v40
  v_exp_f32 v41, v41
  v_exp_f32 v42, v42
  v_exp_f32 v43, v43
  s_waitcnt lgkmcnt(5)
  v_mfma_f32_32x32x16_bf16 v[56:71], v[96:99], v[48:51], v[56:71]
  s_add_u32 s50, s66, 2457600
  buffer_load_dwordx4 v[208:211], v120, s[16:19], s50 offen offset:2048
  buffer_load_dwordx4 v[212:215], v120, s[16:19], s50 offen offset:3072
  v_exp_f32 v44, v44
  v_exp_f32 v45, v45
  v_exp_f32 v46, v46
  v_exp_f32 v47, v47
  v_cvt_pk_bf16_f32 v52, v40, v41
  v_cvt_pk_bf16_f32 v53, v42, v43
  v_cvt_pk_bf16_f32 v54, v44, v45
  v_cvt_pk_bf16_f32 v55, v46, v47
  s_setprio 1
  s_waitcnt lgkmcnt(2)
  v_mfma_f32_32x32x16_bf16 v[32:47], v[76:79], v[8:11], 0
  v_exp_f32 v16, v16
  v_exp_f32 v17, v17
  v_mfma_f32_16x16x32_bf16 v[156:159], v[240:243], v[224:227], v[156:159]
  v_exp_f32 v18, v18
  v_exp_f32 v19, v19
  v_mfma_f32_32x32x16_bf16 v[32:47], v[84:87], v[12:15], v[32:47]
  ds_read_b128 v[72:75], v104 offset:30720
  ds_read_b64 v[80:81], v105 offset:30720
  v_exp_f32 v20, v20
  v_exp_f32 v21, v21
  v_mfma_f32_16x16x32_bf16 v[140:143], v[244:247], v[220:223], v[140:143]
  v_exp_f32 v22, v22
  v_exp_f32 v23, v23
  v_cvt_pk_bf16_f32 v48, v16, v17
  v_cvt_pk_bf16_f32 v49, v18, v19
  v_mfma_f32_32x32x16_bf16 v[56:71], v[100:103], v[52:55], v[56:71]
  s_mov_b64 exec, s[46:47]
  ds_read_b128 v[96:99], v106 offset:24320
  ds_read_b128 v[100:103], v106 offset:24960
  s_mov_b64 exec, -1
  v_cvt_pk_bf16_f32 v50, v20, v21
  v_cvt_pk_bf16_f32 v51, v22, v23
  v_exp_f32 v24, v24
  v_exp_f32 v25, v25
  v_exp_f32 v26, v26
  v_exp_f32 v27, v27
  s_waitcnt lgkmcnt(5)
  v_mfma_f32_32x32x16_bf16 v[56:71], v[88:91], v[48:51], v[56:71]
  s_add_u32 s50, s66, 2461696
  buffer_load_dwordx4 v[216:219], v120, s[16:19], s50 offen
  s_add_u32 s50, s64, 40960
  buffer_load_dwordx4 v[192:195], v120, s[16:19], s50 offen
  v_exp_f32 v28, v28
  v_exp_f32 v29, v29
  v_exp_f32 v30, v30
  v_exp_f32 v31, v31
  v_cvt_pk_bf16_f32 v52, v24, v25
  v_cvt_pk_bf16_f32 v53, v26, v27
  v_cvt_pk_bf16_f32 v54, v28, v29
  v_cvt_pk_bf16_f32 v55, v30, v31
  s_setprio 0
  s_waitcnt lgkmcnt(2)
  v_mfma_f32_32x32x16_bf16 v[16:31], v[72:75], v[8:11], 0
  v_exp_f32 v32, v32
  v_exp_f32 v33, v33
  v_mfma_f32_16x16x32_bf16 v[160:163], v[244:247], v[224:227], v[160:163]
  v_exp_f32 v34, v34
  v_exp_f32 v35, v35
  v_mfma_f32_32x32x16_bf16 v[16:31], v[80:83], v[12:15], v[16:31]
  ds_read_b128 v[76:79], v104 offset:31232
  ds_read_b64 v[84:85], v105 offset:30976
  v_exp_f32 v36, v36
  v_exp_f32 v37, v37
  s_waitcnt vmcnt(7)
  v_mfma_f32_16x16x32_bf16 v[124:127], v[172:175], v[164:167], v[124:127]
  v_exp_f32 v38, v38
  v_exp_f32 v39, v39
  v_cvt_pk_bf16_f32 v48, v32, v33
  v_cvt_pk_bf16_f32 v49, v34, v35
  v_mfma_f32_32x32x16_bf16 v[56:71], v[92:95], v[52:55], v[56:71]
  s_mov_b64 exec, s[46:47]
  ds_read_b128 v[88:91], v106 offset:30720
  ds_read_b128 v[92:95], v106 offset:31360
  s_mov_b64 exec, -1
  v_cvt_pk_bf16_f32 v50, v36, v37
  v_cvt_pk_bf16_f32 v51, v38, v39
  v_exp_f32 v40, v40
  v_exp_f32 v41, v41
  v_exp_f32 v42, v42
  v_exp_f32 v43, v43
  s_waitcnt lgkmcnt(5)
  v_mfma_f32_32x32x16_bf16 v[56:71], v[96:99], v[48:51], v[56:71]
  s_add_u32 s50, s64, 90112
  buffer_load_dwordx4 v[196:199], v120, s[16:19], s50 offen
  v_exp_f32 v44, v44
  v_exp_f32 v45, v45
  v_exp_f32 v46, v46
  v_exp_f32 v47, v47
  v_cvt_pk_bf16_f32 v52, v40, v41
  v_cvt_pk_bf16_f32 v53, v42, v43
  v_cvt_pk_bf16_f32 v54, v44, v45
  v_cvt_pk_bf16_f32 v55, v46, v47
  s_setprio 3
  s_waitcnt lgkmcnt(2)
  v_mfma_f32_32x32x16_bf16 v[32:47], v[76:79], v[8:11], 0
  v_exp_f32 v16, v16
  v_exp_f32 v17, v17
  v_mfma_f32_16x16x32_bf16 v[144:147], v[172:175], v[168:171], v[144:147]
  v_exp_f32 v18, v18
  v_exp_f32 v19, v19
  v_mfma_f32_32x32x16_bf16 v[32:47], v[84:87], v[12:15], v[32:47]
  ds_read_b128 v[72:75], v104 offset:31744
  ds_read_b64 v[80:81], v105 offset:31232
  v_exp_f32 v20, v20
  v_exp_f32 v21, v21
  v_mfma_f32_16x16x32_bf16 v[128:131], v[176:179], v[164:167], v[128:131]
  v_exp_f32 v22, v22
  v_exp_f32 v23, v23
  v_cvt_pk_bf16_f32 v48, v16, v17
  v_cvt_pk_bf16_f32 v49, v18, v19
  v_mfma_f32_32x32x16_bf16 v[56:71], v[100:103], v[52:55], v[56:71]
  s_mov_b64 exec, s[46:47]
  ds_read_b128 v[96:99], v106 offset:32000
  ds_read_b128 v[100:103], v106 offset:32640
  s_mov_b64 exec, -1
  v_cvt_pk_bf16_f32 v50, v20, v21
  v_cvt_pk_bf16_f32 v51, v22, v23
  v_exp_f32 v24, v24
  v_exp_f32 v25, v25
  v_mfma_f32_16x16x32_bf16 v[148:151], v[176:179], v[168:171], v[148:151]
  v_exp_f32 v26, v26
  v_exp_f32 v27, v27
  s_waitcnt lgkmcnt(5)
  v_mfma_f32_32x32x16_bf16 v[56:71], v[88:91], v[48:51], v[56:71]
  s_add_u32 s50, s66, 2621440
  buffer_load_dwordx4 v[228:231], v120, s[16:19], s50 offen offset:0
  buffer_load_dwordx4 v[232:235], v120, s[16:19], s50 offen offset:1024
  v_exp_f32 v28, v28
  v_exp_f32 v29, v29
  v_exp_f32 v30, v30
  v_exp_f32 v31, v31
  v_cvt_pk_bf16_f32 v52, v24, v25
  v_cvt_pk_bf16_f32 v53, v26, v27
  v_cvt_pk_bf16_f32 v54, v28, v29
  v_cvt_pk_bf16_f32 v55, v30, v31
  s_setprio 2
  s_waitcnt lgkmcnt(2)
  v_mfma_f32_32x32x16_bf16 v[16:31], v[72:75], v[8:11], 0
  v_exp_f32 v32, v32
  v_exp_f32 v33, v33
  v_mfma_f32_16x16x32_bf16 v[132:135], v[180:183], v[164:167], v[132:135]
  v_exp_f32 v34, v34
  v_exp_f32 v35, v35
  v_mfma_f32_32x32x16_bf16 v[16:31], v[80:83], v[12:15], v[16:31]
  ds_read_b128 v[76:79], v104 offset:32256
  ds_read_b64 v[84:85], v105 offset:31488
  v_exp_f32 v36, v36
  v_exp_f32 v37, v37
  v_mfma_f32_16x16x32_bf16 v[152:155], v[180:183], v[168:171], v[152:155]
  v_exp_f32 v38, v38
  v_exp_f32 v39, v39
  v_cvt_pk_bf16_f32 v48, v32, v33
  v_cvt_pk_bf16_f32 v49, v34, v35
  v_mfma_f32_32x32x16_bf16 v[56:71], v[92:95], v[52:55], v[56:71]
  s_mov_b64 exec, s[46:47]
  ds_read_b128 v[88:91], v106 offset:33280
  ds_read_b128 v[92:95], v106 offset:33920
  s_mov_b64 exec, -1
  v_cvt_pk_bf16_f32 v50, v36, v37
  v_cvt_pk_bf16_f32 v51, v38, v39
  v_exp_f32 v40, v40
  v_exp_f32 v41, v41
  v_exp_f32 v42, v42
  v_exp_f32 v43, v43
  s_waitcnt lgkmcnt(5)
  v_mfma_f32_32x32x16_bf16 v[56:71], v[96:99], v[48:51], v[56:71]
  s_add_u32 s50, s66, 2621440
  buffer_load_dwordx4 v[236:239], v120, s[16:19], s50 offen offset:2048
  buffer_load_dwordx4 v[240:243], v120, s[16:19], s50 offen offset:3072
  v_exp_f32 v44, v44
  v_exp_f32 v45, v45
  v_exp_f32 v46, v46
  v_exp_f32 v47, v47
  v_cvt_pk_bf16_f32 v52, v40, v41
  v_cvt_pk_bf16_f32 v53, v42, v43
  v_cvt_pk_bf16_f32 v54, v44, v45
  v_cvt_pk_bf16_f32 v55, v46, v47
  s_setprio 1
  s_waitcnt lgkmcnt(2)
  v_mfma_f32_32x32x16_bf16 v[32:47], v[76:79], v[8:11], 0
  v_exp_f32 v16, v16
  v_exp_f32 v17, v17
  v_mfma_f32_16x16x32_bf16 v[136:139], v[184:187], v[164:167], v[136:139]
  v_exp_f32 v18, v18
  v_exp_f32 v19, v19
  v_mfma_f32_32x32x16_bf16 v[32:47], v[84:87], v[12:15], v[32:47]
  v_exp_f32 v20, v20
  v_exp_f32 v21, v21
  v_mfma_f32_16x16x32_bf16 v[156:159], v[184:187], v[168:171], v[156:159]
  v_exp_f32 v22, v22
  v_exp_f32 v23, v23
  v_cvt_pk_bf16_f32 v48, v16, v17
  v_cvt_pk_bf16_f32 v49, v18, v19
  v_mfma_f32_32x32x16_bf16 v[56:71], v[100:103], v[52:55], v[56:71]
  s_mov_b64 exec, s[46:47]
  ds_read_b128 v[96:99], v106 offset:34560
  ds_read_b128 v[100:103], v106 offset:35200
  s_mov_b64 exec, -1
  v_cvt_pk_bf16_f32 v50, v20, v21
  v_cvt_pk_bf16_f32 v51, v22, v23
  v_exp_f32 v24, v24
  v_exp_f32 v25, v25
  v_exp_f32 v26, v26
  v_exp_f32 v27, v27
  s_waitcnt lgkmcnt(3)
  v_mfma_f32_32x32x16_bf16 v[56:71], v[88:91], v[48:51], v[56:71]
  s_add_u32 s50, s66, 2625536
  buffer_load_dwordx4 v[244:247], v120, s[16:19], s50 offen
  s_add_u32 s50, s64, 45056
  buffer_load_dwordx4 v[220:223], v120, s[16:19], s50 offen
  v_exp_f32 v28, v28
  v_exp_f32 v29, v29
  v_exp_f32 v30, v30
  v_exp_f32 v31, v31
  v_cvt_pk_bf16_f32 v52, v24, v25
  v_cvt_pk_bf16_f32 v53, v26, v27
  v_cvt_pk_bf16_f32 v54, v28, v29
  v_cvt_pk_bf16_f32 v55, v30, v31
  s_setprio 0
  v_exp_f32 v32, v32
  v_exp_f32 v33, v33
  v_mfma_f32_16x16x32_bf16 v[140:143], v[188:191], v[164:167], v[140:143]
  v_exp_f32 v34, v34
  v_exp_f32 v35, v35
  v_exp_f32 v36, v36
  v_exp_f32 v37, v37
  v_mfma_f32_16x16x32_bf16 v[160:163], v[188:191], v[168:171], v[160:163]
  v_exp_f32 v38, v38
  v_exp_f32 v39, v39
  v_cvt_pk_bf16_f32 v48, v32, v33
  v_cvt_pk_bf16_f32 v49, v34, v35
  s_waitcnt lgkmcnt(2)
  v_mfma_f32_32x32x16_bf16 v[56:71], v[92:95], v[52:55], v[56:71]
  v_cvt_pk_bf16_f32 v50, v36, v37
  v_cvt_pk_bf16_f32 v51, v38, v39
  v_exp_f32 v40, v40
  v_exp_f32 v41, v41
  v_exp_f32 v42, v42
  v_exp_f32 v43, v43
  s_waitcnt lgkmcnt(1)
  v_mfma_f32_32x32x16_bf16 v[56:71], v[96:99], v[48:51], v[56:71]
  s_add_u32 s50, s64, 94208
  buffer_load_dwordx4 v[224:227], v120, s[16:19], s50 offen
  v_exp_f32 v44, v44
  v_exp_f32 v45, v45
  v_exp_f32 v46, v46
  v_exp_f32 v47, v47
  v_cvt_pk_bf16_f32 v52, v40, v41
  v_cvt_pk_bf16_f32 v53, v42, v43
  v_cvt_pk_bf16_f32 v54, v44, v45
  v_cvt_pk_bf16_f32 v55, v46, v47
  s_waitcnt lgkmcnt(0)
  s_nop 1
  v_mfma_f32_32x32x16_bf16 v[56:71], v[100:103], v[52:55], v[56:71]
  s_setprio 0
  v_and_b32 v5, 15, v2
  v_lshrrev_b32 v6, 4, v2
  v_mul_u32_u24 v5, 1280, v5
  v_lshl_add_u32 v5, v6, 3, v5
  s_lshl_b32 s50, s38, 5
  s_add_u32 s68, s68, s50
  s_lshr_b32 s50, s38, 1
  s_mul_i32 s50, s50, 5120
  s_add_u32 s50, s50, 40960
  v_add_u32 v7, s50, v120
  v_add_u32 v6, 61440, v7
  s_nop 3
  v_mov_b32 v113, v64
  v_mov_b32 v114, v64
  v_mov_b32 v115, 0
  s_nop 0
  v_permlane32_swap_b32 v113, v114
  v_fma_f32 v115, v56, 0, v115
  v_fma_f32 v115, v57, 0, v115
  v_fma_f32 v115, v58, 0, v115
  v_fma_f32 v115, v59, 0, v115
  v_fma_f32 v115, v60, 0, v115
  v_fma_f32 v115, v61, 0, v115
  v_fma_f32 v115, v62, 0, v115
  v_fma_f32 v115, v63, 0, v115
  v_fma_f32 v115, v64, 0, v115
  v_fma_f32 v115, v65, 0, v115
  v_fma_f32 v115, v66, 0, v115
  v_fma_f32 v115, v67, 0, v115
  s_mov_b32 s50, 0x71800000
  v_add_f32 v115, v115, v114
  v_cmp_ngt_f32 vcc, s50, v115
  s_nop 3
  s_cmp_lg_u64 vcc, 0
  s_cbranch_scc1 L_slow
L_fin:
  v_rcp_f32 v114, v114
  s_lshr_b32 s50, s60, 1
  s_mul_i32 s50, s50, 1280
  s_add_u32 s50, s50, 10485760
  s_and_b32 s51, s60, 1
  s_mul_i32 s52, s51, 768
  s_add_u32 s52, s52, s50
  s_lshl_b32 s51, s51, 3
  s_add_u32 s51, s51, s50
  v_mul_f32 v56, v56, v114
  v_mul_f32 v57, v57, v114
  v_mul_f32 v58, v58, v114
  v_mul_f32 v59, v59, v114
  v_mul_f32 v60, v60, v114
  v_mul_f32 v61, v61, v114
  v_mul_f32 v62, v62, v114
  v_mul_f32 v63, v63, v114
  v_mul_f32 v64, v64, v114
  v_mul_f32 v65, v65, v114
  v_mul_f32 v66, v66, v114
  v_mul_f32 v67, v67, v114
  v_cvt_pk_bf16_f32 v48, v56, v57
  v_cvt_pk_bf16_f32 v49, v58, v59
  v_cvt_pk_bf16_f32 v50, v60, v61
  v_cvt_pk_bf16_f32 v51, v62, v63
  v_cvt_pk_bf16_f32 v52, v64, v65
  v_cvt_pk_bf16_f32 v53, v66, v67
  v_permlane32_swap_b32 v48, v50
  v_permlane32_swap_b32 v49, v51
  buffer_store_dwordx4 v[48:51], v119, s[16:19], s52 offen sc1
  s_mov_b64 exec, s[44:45]
  buffer_store_dwordx2 v[52:53], v118, s[16:19], s51 offen offset:512 sc1
  s_mov_b64 exec, -1
  s_add_u32 s50, s68, 0
  buffer_load_dwordx2 v[20:21], v5, s[8:11], s50 offen
  s_add_u32 s50, s68, 20480
  buffer_load_dwordx2 v[22:23], v5, s[8:11], s50 offen
  s_add_u32 s50, s68, 40960
  buffer_load_dwordx2 v[24:25], v5, s[8:11], s50 offen
  s_add_u32 s50, s68, 61440
  buffer_load_dwordx2 v[26:27], v5, s[8:11], s50 offen
  s_waitcnt vmcnt(13)
  v_mfma_f32_16x16x32_bf16 v[124:127], v[200:203], v[192:195], v[124:127]
  v_mfma_f32_16x16x32_bf16 v[144:147], v[200:203], v[196:199], v[144:147]
  v_mfma_f32_16x16x32_bf16 v[128:131], v[204:207], v[192:195], v[128:131]
  v_mfma_f32_16x16x32_bf16 v[148:151], v[204:207], v[196:199], v[148:151]
  v_mfma_f32_16x16x32_bf16 v[132:135], v[208:211], v[192:195], v[132:135]
  v_mfma_f32_16x16x32_bf16 v[152:155], v[208:211], v[196:199], v[152:155]
  v_mfma_f32_16x16x32_bf16 v[136:139], v[212:215], v[192:195], v[136:139]
  v_mfma_f32_16x16x32_bf16 v[156:159], v[212:215], v[196:199], v[156:159]
  v_mfma_f32_16x16x32_bf16 v[140:143], v[216:219], v[192:195], v[140:143]
  v_mfma_f32_16x16x32_bf16 v[160:163], v[216:219], v[196:199], v[160:163]
  s_waitcnt vmcnt(6)
  v_mfma_f32_16x16x32_bf16 v[124:127], v[228:231], v[220:223], v[124:127]
  v_mfma_f32_16x16x32_bf16 v[144:147], v[228:231], v[224:227], v[144:147]
  v_mfma_f32_16x16x32_bf16 v[128:131], v[232:235], v[220:223], v[128:131]
  v_mfma_f32_16x16x32_bf16 v[148:151], v[232:235], v[224:227], v[148:151]
  v_mfma_f32_16x16x32_bf16 v[132:135], v[236:239], v[220:223], v[132:135]
  v_mfma_f32_16x16x32_bf16 v[152:155], v[236:239], v[224:227], v[152:155]
  v_mfma_f32_16x16x32_bf16 v[136:139], v[240:243], v[220:223], v[136:139]
  v_mfma_f32_16x16x32_bf16 v[156:159], v[240:243], v[224:227], v[156:159]
  v_mfma_f32_16x16x32_bf16 v[140:143], v[244:247], v[220:223], v[140:143]
  v_mfma_f32_16x16x32_bf16 v[160:163], v[244:247], v[224:227], v[160:163]
  s_barrier
  ds_read_b128 v[164:167], v7 offset:0
  ds_read_b128 v[168:171], v7 offset:1024
  ds_read_b128 v[172:175], v7 offset:2048
  ds_read_b128 v[176:179], v7 offset:3072
  ds_read_b128 v[180:183], v7 offset:4096
  ds_read_b128 v[184:187], v7 offset:20480
  ds_read_b128 v[188:191], v7 offset:21504
  ds_read_b128 v[192:195], v7 offset:22528
  ds_read_b128 v[196:199], v7 offset:23552
  ds_read_b128 v[200:203], v7 offset:24576
  ds_read_b128 v[204:207], v7 offset:40960
  ds_read_b128 v[208:211], v7 offset:41984
  ds_read_b128 v[212:215], v7 offset:43008
  ds_read_b128 v[216:219], v7 offset:44032
  ds_read_b128 v[220:223], v7 offset:45056
  ds_read_b128 v[224:227], v6 offset:0
  ds_read_b128 v[228:231], v6 offset:1024
  ds_read_b128 v[232:235], v6 offset:2048
  ds_read_b128 v[236:239], v6 offset:3072
  ds_read_b128 v[240:243], v6 offset:4096
  ds_read_b128 v[44:47], v6 offset:20480
  ds_read_b128 v[48:51], v6 offset:21504
  ds_read_b128 v[52:55], v6 offset:22528
  ds_read_b128 v[56:59], v6 offset:23552
  ds_read_b128 v[60:63], v6 offset:24576
  s_mov_b32 s69, 31
  s_mov_b32 s51, 0
  v_lshrrev_b32 v30, 1, v3
  v_mul_u32_u24 v30, 1280, v30
  v_and_b32 v31, 1, v3
  v_lshl_add_u32 v30, v31, 3, v30
  s_lshr_b32 s53, s38, 1
  s_lshl_b32 s53, s53, 10
  s_sub_u32 s53, s65, s53
  s_waitcnt lgkmcnt(0)
  s_barrier
  s_mov_b32 s52, 31
  s_branch L_sent
L_xo:
  s_waitcnt vmcnt(0)
  s_mov_b32 s52, 0
  s_bitcmp1_b32 s69, 0
  s_cbranch_scc0 L_xo_n0
  v_max3_u32 v28, v72, v73, v74
  v_max3_u32 v29, v75, v76, v77
  v_max3_u32 v28, v28, v78, v79
  v_max_u32 v28, v28, v29
  v_cmp_eq_u32 vcc, -1, v28
  s_nop 3
  s_cmp_eq_u64 vcc, 0
  s_cbranch_scc1 L_xo_y0
  s_cmp_lt_u32 s51, 0x20000
  s_cbranch_scc0 L_xo_y0
  s_bitset1_b32 s52, 0
  s_branch L_xo_n0
L_xo_y0:
  s_bitset0_b32 s69, 0
  v_mfma_f32_16x16x32_bf16 v[124:127], v[164:167], v[72:75], v[124:127]
  v_mfma_f32_16x16x32_bf16 v[144:147], v[164:167], v[76:79], v[144:147]
  v_mfma_f32_16x16x32_bf16 v[128:131], v[168:171], v[72:75], v[128:131]
  v_mfma_f32_16x16x32_bf16 v[148:151], v[168:171], v[76:79], v[148:151]
  v_mfma_f32_16x16x32_bf16 v[132:135], v[172:175], v[72:75], v[132:135]
  v_mfma_f32_16x16x32_bf16 v[152:155], v[172:175], v[76:79], v[152:155]
  v_mfma_f32_16x16x32_bf16 v[136:139], v[176:179], v[72:75], v[136:139]
  v_mfma_f32_16x16x32_bf16 v[156:159], v[176:179], v[76:79], v[156:159]
  v_mfma_f32_16x16x32_bf16 v[140:143], v[180:183], v[72:75], v[140:143]
  v_mfma_f32_16x16x32_bf16 v[160:163], v[180:183], v[76:79], v[160:163]
L_xo_n0:
  s_bitcmp1_b32 s69, 1
  s_cbranch_scc0 L_xo_n1
  v_max3_u32 v28, v80, v81, v82
  v_max3_u32 v29, v83, v84, v85
  v_max3_u32 v28, v28, v86, v87
  v_max_u32 v28, v28, v29
  v_cmp_eq_u32 vcc, -1, v28
  s_nop 3
  s_cmp_eq_u64 vcc, 0
  s_cbranch_scc1 L_xo_y1
  s_cmp_lt_u32 s51, 0x20000
  s_cbranch_scc0 L_xo_y1
  s_bitset1_b32 s52, 1
  s_branch L_xo_n1
L_xo_y1:
  s_cmp_lg_u32 s52, 0
  s_cbranch_scc1 L_xo_n1
  s_bitset0_b32 s69, 1
  v_mfma_f32_16x16x32_bf16 v[124:127], v[184:187], v[80:83], v[124:127]
  v_mfma_f32_16x16x32_bf16 v[144:147], v[184:187], v[84:87], v[144:147]
  v_mfma_f32_16x16x32_bf16 v[128:131], v[188:191], v[80:83], v[128:131]
  v_mfma_f32_16x16x32_bf16 v[148:151], v[188:191], v[84:87], v[148:151]
  v_mfma_f32_16x16x32_bf16 v[132:135], v[192:195], v[80:83], v[132:135]
  v_mfma_f32_16x16x32_bf16 v[152:155], v[192:195], v[84:87], v[152:155]
  v_mfma_f32_16x16x32_bf16 v[136:139], v[196:199], v[80:83], v[136:139]
  v_mfma_f32_16x16x32_bf16 v[156:159], v[196:199], v[84:87], v[156:159]
  v_mfma_f32_16x16x32_bf16 v[140:143], v[200:203], v[80:83], v[140:143]
  v_mfma_f32_16x16x32_bf16 v[160:163], v[200:203], v[84:87], v[160:163]
L_xo_n1:
  s_bitcmp1_b32 s69, 2
  s_cbranch_scc0 L_xo_n2
  v_max3_u32 v28, v88, v89, v90
  v_max3_u32 v29, v91, v92, v93
  v_max3_u32 v28, v28, v94, v95
  v_max_u32 v28, v28, v29
  v_cmp_eq_u32 vcc, -1, v28
  s_nop 3
  s_cmp_eq_u64 vcc, 0
  s_cbranch_scc1 L_xo_y2
  s_cmp_lt_u32 s51, 0x20000
  s_cbranch_scc0 L_xo_y2
  s_bitset1_b32 s52, 2
  s_branch L_xo_n2
L_xo_y2:
  s_cmp_lg_u32 s52, 0
  s_cbranch_scc1 L_xo_n2
  s_bitset0_b32 s69, 2
  v_mfma_f32_16x16x32_bf16 v[124:127], v[204:207], v[88:91], v[124:127]
  v_mfma_f32_16x16x32_bf16 v[144:147], v[204:207], v[92:95], v[144:147]
  v_mfma_f32_16x16x32_bf16 v[128:131], v[208:211], v[88:91], v[128:131]
  v_mfma_f32_16x16x32_bf16 v[148:151], v[208:211], v[92:95], v[148:151]
  v_mfma_f32_16x16x32_bf16 v[132:135], v[212:215], v[88:91], v[132:135]
  v_mfma_f32_16x16x32_bf16 v[152:155], v[212:215], v[92:95], v[152:155]
  v_mfma_f32_16x16x32_bf16 v[136:139], v[216:219], v[88:91], v[136:139]
  v_mfma_f32_16x16x32_bf16 v[156:159], v[216:219], v[92:95], v[156:159]
  v_mfma_f32_16x16x32_bf16 v[140:143], v[220:223], v[88:91], v[140:143]
  v_mfma_f32_16x16x32_bf16 v[160:163], v[220:223], v[92:95], v[160:163]
L_xo_n2:
  s_bitcmp1_b32 s69, 3
  s_cbranch_scc0 L_xo_n3
  v_max3_u32 v28, v96, v97, v98
  v_max3_u32 v29, v99, v100, v101
  v_max3_u32 v28, v28, v102, v103
  v_max_u32 v28, v28, v29
  v_cmp_eq_u32 vcc, -1, v28
  s_nop 3
  s_cmp_eq_u64 vcc, 0
  s_cbranch_scc1 L_xo_y3
  s_cmp_lt_u32 s51, 0x20000
  s_cbranch_scc0 L_xo_y3
  s_bitset1_b32 s52, 3
  s_branch L_xo_n3
L_xo_y3:
  s_cmp_lg_u32 s52, 0
  s_cbranch_scc1 L_xo_n3
  s_bitset0_b32 s69, 3
  v_mfma_f32_16x16x32_bf16 v[124:127], v[224:227], v[96:99], v[124:127]
  v_mfma_f32_16x16x32_bf16 v[144:147], v[224:227], v[100:103], v[144:147]
  v_mfma_f32_16x16x32_bf16 v[128:131], v[228:231], v[96:99], v[128:131]
  v_mfma_f32_16x16x32_bf16 v[148:151], v[228:231], v[100:103], v[148:151]
  v_mfma_f32_16x16x32_bf16 v[132:135], v[232:235], v[96:99], v[132:135]
  v_mfma_f32_16x16x32_bf16 v[152:155], v[232:235], v[100:103], v[152:155]
  v_mfma_f32_16x16x32_bf16 v[136:139], v[236:239], v[96:99], v[136:139]
  v_mfma_f32_16x16x32_bf16 v[156:159], v[236:239], v[100:103], v[156:159]
  v_mfma_f32_16x16x32_bf16 v[140:143], v[240:243], v[96:99], v[140:143]
  v_mfma_f32_16x16x32_bf16 v[160:163], v[240:243], v[100:103], v[160:163]
L_xo_n3:
  s_bitcmp1_b32 s69, 4
  s_cbranch_scc0 L_xo_n4
  v_max3_u32 v28, v36, v37, v38
  v_max3_u32 v29, v39, v40, v41
  v_max3_u32 v28, v28, v42, v43
  v_max_u32 v28, v28, v29
  v_cmp_eq_u32 vcc, -1, v28
  s_nop 3
  s_cmp_eq_u64 vcc, 0
  s_cbranch_scc1 L_xo_y4
  s_cmp_lt_u32 s51, 0x20000
  s_cbranch_scc0 L_xo_y4
  s_bitset1_b32 s52, 4
  s_branch L_xo_n4
L_xo_y4:
  s_cmp_lg_u32 s52, 0
  s_cbranch_scc1 L_xo_n4
  s_bitset0_b32 s69, 4
  v_mfma_f32_16x16x32_bf16 v[124:127], v[44:47], v[36:39], v[124:127]
  v_mfma_f32_16x16x32_bf16 v[144:147], v[44:47], v[40:43], v[144:147]
  v_mfma_f32_16x16x32_bf16 v[128:131], v[48:51], v[36:39], v[128:131]
  v_mfma_f32_16x16x32_bf16 v[148:151], v[48:51], v[40:43], v[148:151]
  v_mfma_f32_16x16x32_bf16 v[132:135], v[52:55], v[36:39], v[132:135]
  v_mfma_f32_16x16x32_bf16 v[152:155], v[52:55], v[40:43], v[152:155]
  v_mfma_f32_16x16x32_bf16 v[136:139], v[56:59], v[36:39], v[136:139]
  v_mfma_f32_16x16x32_bf16 v[156:159], v[56:59], v[40:43], v[156:159]
  v_mfma_f32_16x16x32_bf16 v[140:143], v[60:63], v[36:39], v[140:143]
  v_mfma_f32_16x16x32_bf16 v[160:163], v[60:63], v[40:43], v[160:163]
L_xo_n4:
  s_cmp_eq_u32 s69, 0
  s_cbranch_scc1 L_xo_done
L_sent:
  s_mov_b64 exec, s[44:45]
  buffer_load_dword v31, v30, s[16:19], s53 offen offset:512 sc1
  s_add_u32 s51, s51, 1
  s_waitcnt vmcnt(0)
  v_cmp_eq_u32 vcc, -1, v31
  s_mov_b64 exec, -1
  s_nop 2
  s_cmp_eq_u64 vcc, 0
  s_cbranch_scc1 L_sent_ok
  s_cmp_ge_u32 s51, 0x20000
  s_cbranch_scc1 L_sent_ok
  s_sleep 2
  s_branch L_sent
L_sent_ok:
  s_bitcmp1_b32 s52, 0
  s_cbranch_scc0 L_xr_n0
  s_add_u32 s50, s65, 0
  buffer_load_dwordx4 v[72:75], v120, s[16:19], s50 offen sc1
  s_add_u32 s50, s65, 20480
  buffer_load_dwordx4 v[76:79], v120, s[16:19], s50 offen sc1
L_xr_n0:
  s_bitcmp1_b32 s52, 1
  s_cbranch_scc0 L_xr_n1
  s_add_u32 s50, s65, 4096
  buffer_load_dwordx4 v[80:83], v120, s[16:19], s50 offen sc1
  s_add_u32 s50, s65, 24576
  buffer_load_dwordx4 v[84:87], v120, s[16:19], s50 offen sc1
L_xr_n1:
  s_bitcmp1_b32 s52, 2
  s_cbranch_scc0 L_xr_n2
  s_add_u32 s50, s65, 8192
  buffer_load_dwordx4 v[88:91], v120, s[16:19], s50 offen sc1
  s_add_u32 s50, s65, 28672
  buffer_load_dwordx4 v[92:95], v120, s[16:19], s50 offen sc1
L_xr_n2:
  s_bitcmp1_b32 s52, 3
  s_cbranch_scc0 L_xr_n3
  s_add_u32 s50, s65, 12288
  buffer_load_dwordx4 v[96:99], v120, s[16:19], s50 offen sc1
  s_add_u32 s50, s65, 32768
  buffer_load_dwordx4 v[100:103], v120, s[16:19], s50 offen sc1
L_xr_n3:
  s_bitcmp1_b32 s52, 4
  s_cbranch_scc0 L_xr_n4
  s_add_u32 s50, s65, 16384
  buffer_load_dwordx4 v[36:39], v120, s[16:19], s50 offen sc1
  s_add_u32 s50, s65, 36864
  buffer_load_dwordx4 v[40:43], v120, s[16:19], s50 offen sc1
L_xr_n4:
  s_branch L_xo
L_xo_done:
  s_and_b32 s50, s38, 1
  s_lshl_b32 s50, s50, 3
  s_lshr_b32 s51, s38, 1
  s_add_u32 s50, s50, s51
  s_lshl_b32 s50, s50, 10
  v_add_u32 v6, s50, v120
  v_add_u32 v7, 0x10000, v6
  s_nop 1
  ds_write_b128 v6, v[124:127] offset:0
  ds_write_b128 v6, v[144:147] offset:4096
  ds_write_b128 v6, v[128:131] offset:16384
  ds_write_b128 v6, v[148:151] offset:20480
  ds_write_b128 v6, v[132:135] offset:32768
  ds_write_b128 v6, v[152:155] offset:36864
  ds_write_b128 v6, v[136:139] offset:49152
  ds_write_b128 v6, v[156:159] offset:53248
  ds_write_b128 v7, v[140:143] offset:0
  ds_write_b128 v7, v[160:163] offset:4096
  s_lshl_b32 s50, s38, 14
  v_add_u32 v6, s50, v120
  v_lshlrev_b32 v72, 16, v20
  v_and_b32 v73, 0xffff0000, v20
  v_lshlrev_b32 v74, 16, v21
  v_and_b32 v75, 0xffff0000, v21
  v_lshlrev_b32 v76, 16, v22
  v_and_b32 v77, 0xffff0000, v22
  v_lshlrev_b32 v78, 16, v23
  v_and_b32 v79, 0xffff0000, v23
  v_lshlrev_b32 v80, 16, v24
  v_and_b32 v81, 0xffff0000, v24
  v_lshlrev_b32 v82, 16, v25
  v_and_b32 v83, 0xffff0000, v25
  v_lshlrev_b32 v84, 16, v26
  v_and_b32 v85, 0xffff0000, v26
  v_lshlrev_b32 v86, 16, v27
  v_and_b32 v87, 0xffff0000, v27
  s_waitcnt lgkmcnt(0)
  s_barrier
  s_cmp_ge_u32 s38, 5
  s_cbranch_scc1 L_done
  ds_read_b128 v[124:127], v6 offset:0
  ds_read_b128 v[128:131], v6 offset:1024
  ds_read_b128 v[132:135], v6 offset:2048
  ds_read_b128 v[136:139], v6 offset:3072
  ds_read_b128 v[140:143], v6 offset:4096
  ds_read_b128 v[144:147], v6 offset:5120
  ds_read_b128 v[148:151], v6 offset:6144
  ds_read_b128 v[152:155], v6 offset:7168
  ds_read_b128 v[156:159], v6 offset:8192
  ds_read_b128 v[160:163], v6 offset:9216
  ds_read_b128 v[164:167], v6 offset:10240
  ds_read_b128 v[168:171], v6 offset:11264
  ds_read_b128 v[172:175], v6 offset:12288
  ds_read_b128 v[176:179], v6 offset:13312
  ds_read_b128 v[180:183], v6 offset:14336
  ds_read_b128 v[184:187], v6 offset:15360
  s_waitcnt lgkmcnt(12)
  v_pk_add_f32 v[72:73], v[72:73], v[124:125]
  v_pk_add_f32 v[72:73], v[72:73], v[128:129]
  v_pk_add_f32 v[72:73], v[72:73], v[132:133]
  v_pk_add_f32 v[72:73], v[72:73], v[136:137]
  v_cvt_pk_bf16_f32 v72, v72, v73
  v_pk_add_f32 v[74:75], v[74:75], v[126:127]
  v_pk_add_f32 v[74:75], v[74:75], v[130:131]
  v_pk_add_f32 v[74:75], v[74:75], v[134:135]
  v_pk_add_f32 v[74:75], v[74:75], v[138:139]
  v_cvt_pk_bf16_f32 v73, v74, v75
  s_add_u32 s50, s68, 0
  buffer_store_dwordx2 v[72:73], v5, s[28:31], s50 offen
  s_waitcnt lgkmcnt(8)
  v_pk_add_f32 v[76:77], v[76:77], v[140:141]
  v_pk_add_f32 v[76:77], v[76:77], v[144:145]
  v_pk_add_f32 v[76:77], v[76:77], v[148:149]
  v_pk_add_f32 v[76:77], v[76:77], v[152:153]
  v_cvt_pk_bf16_f32 v76, v76, v77
  v_pk_add_f32 v[78:79], v[78:79], v[142:143]
  v_pk_add_f32 v[78:79], v[78:79], v[146:147]
  v_pk_add_f32 v[78:79], v[78:79], v[150:151]
  v_pk_add_f32 v[78:79], v[78:79], v[154:155]
  v_cvt_pk_bf16_f32 v77, v78, v79
  s_add_u32 s50, s68, 20480
  buffer_store_dwordx2 v[76:77], v5, s[28:31], s50 offen
  s_waitcnt lgkmcnt(4)
  v_pk_add_f32 v[80:81], v[80:81], v[156:157]
  v_pk_add_f32 v[80:81], v[80:81], v[160:161]
  v_pk_add_f32 v[80:81], v[80:81], v[164:165]
  v_pk_add_f32 v[80:81], v[80:81], v[168:169]
  v_cvt_pk_bf16_f32 v80, v80, v81
  v_pk_add_f32 v[82:83], v[82:83], v[158:159]
  v_pk_add_f32 v[82:83], v[82:83], v[162:163]
  v_pk_add_f32 v[82:83], v[82:83], v[166:167]
  v_pk_add_f32 v[82:83], v[82:83], v[170:171]
  v_cvt_pk_bf16_f32 v81, v82, v83
  s_add_u32 s50, s68, 40960
  buffer_store_dwordx2 v[80:81], v5, s[28:31], s50 offen
  s_waitcnt lgkmcnt(0)
  v_pk_add_f32 v[84:85], v[84:85], v[172:173]
  v_pk_add_f32 v[84:85], v[84:85], v[176:177]
  v_pk_add_f32 v[84:85], v[84:85], v[180:181]
  v_pk_add_f32 v[84:85], v[84:85], v[184:185]
  v_cvt_pk_bf16_f32 v84, v84, v85
  v_pk_add_f32 v[86:87], v[86:87], v[174:175]
  v_pk_add_f32 v[86:87], v[86:87], v[178:179]
  v_pk_add_f32 v[86:87], v[86:87], v[182:183]
  v_pk_add_f32 v[86:87], v[86:87], v[186:187]
  v_cvt_pk_bf16_f32 v85, v86, v87
  s_add_u32 s50, s68, 61440
  buffer_store_dwordx2 v[84:85], v5, s[28:31], s50 offen
L_done:
L_end:
  s_endpgm
L_slow:
  v_mov_b32 v14, 0
  v_mov_b32 v117, 0xff800000
  v_mov_b32 v56, 0
  v_mov_b32 v57, 0
  v_mov_b32 v58, 0
  v_mov_b32 v59, 0
  v_mov_b32 v60, 0
  v_mov_b32 v61, 0
  v_mov_b32 v62, 0
  v_mov_b32 v63, 0
  v_mov_b32 v64, 0
  v_mov_b32 v65, 0
  v_mov_b32 v66, 0
  v_mov_b32 v67, 0
  v_mov_b32 v68, 0
  v_mov_b32 v69, 0
  v_mov_b32 v70, 0
  v_mov_b32 v71, 0
  s_mov_b32 s69, 0
  s_mul_i32 s53, s60, 163840
  s_add_u32 s53, s53, 5242880
L_slow_loop:
  buffer_load_dwordx4 v[72:75], v104, s[16:19], s53 offen
  buffer_load_dwordx2 v[80:81], v105, s[16:19], s53 offen
  s_mov_b64 exec, s[46:47]
  buffer_load_dwordx4 v[88:91], v106, s[16:19], s53 offen
  buffer_load_dwordx4 v[92:95], v106, s[16:19], s53 offen offset:640
  s_mov_b64 exec, -1
  s_waitcnt vmcnt(0)
  v_mfma_f32_32x32x16_bf16 v[32:47], v[72:75], v[8:11], 0
  v_mfma_f32_32x32x16_bf16 v[32:47], v[80:83], v[12:15], v[32:47]
  s_nop 11
  v_max3_f32 v113, v32, v33, v34
  v_max3_f32 v114, v35, v36, v37
  v_max3_f32 v115, v38, v39, v40
  v_max3_f32 v116, v41, v42, v43
  v_max3_f32 v113, v113, v44, v45
  v_max3_f32 v114, v114, v46, v47
  v_max3_f32 v113, v113, v114, v115
  v_max3_f32 v113, v113, v116, v117
  v_mov_b32 v114, v113
  s_nop 1
  v_permlane32_swap_b32 v113, v114
  v_max_f32 v113, v113, v114
  v_sub_f32 v114, v117, v113
  v_exp_f32 v114, v114
  v_mov_b32 v117, v113
  v_sub_f32 v32, v32, v113
  v_sub_f32 v33, v33, v113
  v_sub_f32 v34, v34, v113
  v_sub_f32 v35, v35, v113
  v_sub_f32 v36, v36, v113
  v_sub_f32 v37, v37, v113
  v_sub_f32 v38, v38, v113
  v_sub_f32 v39, v39, v113
  v_sub_f32 v40, v40, v113
  v_sub_f32 v41, v41, v113
  v_sub_f32 v42, v42, v113
  v_sub_f32 v43, v43, v113
  v_sub_f32 v44, v44, v113
  v_sub_f32 v45, v45, v113
  v_sub_f32 v46, v46, v113
  v_sub_f32 v47, v47, v113
  v_mul_f32 v56, v56, v114
  v_mul_f32 v57, v57, v114
  v_mul_f32 v58, v58, v114
  v_mul_f32 v59, v59, v114
  v_mul_f32 v60, v60, v114
  v_mul_f32 v61, v61, v114
  v_mul_f32 v62, v62, v114
  v_mul_f32 v63, v63, v114
  v_mul_f32 v64, v64, v114
  v_mul_f32 v65, v65, v114
  v_mul_f32 v66, v66, v114
  v_mul_f32 v67, v67, v114
  v_mul_f32 v68, v68, v114
  v_mul_f32 v69, v69, v114
  v_mul_f32 v70, v70, v114
  v_mul_f32 v71, v71, v114
  v_exp_f32 v32, v32
  v_exp_f32 v33, v33
  v_exp_f32 v34, v34
  v_exp_f32 v35, v35
  v_exp_f32 v36, v36
  v_exp_f32 v37, v37
  v_exp_f32 v38, v38
  v_exp_f32 v39, v39
  v_exp_f32 v40, v40
  v_exp_f32 v41, v41
  v_exp_f32 v42, v42
  v_exp_f32 v43, v43
  v_exp_f32 v44, v44
  v_exp_f32 v45, v45
  v_exp_f32 v46, v46
  v_exp_f32 v47, v47
  s_nop 0
  v_cvt_pk_bf16_f32 v48, v32, v33
  v_cvt_pk_bf16_f32 v49, v34, v35
  v_cvt_pk_bf16_f32 v50, v36, v37
  v_cvt_pk_bf16_f32 v51, v38, v39
  v_cvt_pk_bf16_f32 v52, v40, v41
  v_cvt_pk_bf16_f32 v53, v42, v43
  v_cvt_pk_bf16_f32 v54, v44, v45
  v_cvt_pk_bf16_f32 v55, v46, v47
  s_nop 1
  v_mfma_f32_32x32x16_bf16 v[56:71], v[88:91], v[48:51], v[56:71]
  v_mfma_f32_32x32x16_bf16 v[56:71], v[92:95], v[52:55], v[56:71]
  s_add_u32 s69, s69, 1
  s_and_b32 s50, s69, 3
  s_cmp_eq_u32 s50, 0
  s_movk_i32 s50, 512
  s_movk_i32 s51, 256
  s_movk_i32 s52, 1280
  s_cselect_b32 s50, 8704, s50
  s_cselect_b32 s51, 9472, s51
  s_cselect_b32 s52, 6400, s52
  v_add_u32 v104, s50, v104
  v_add_u32 v105, s51, v105
  v_add_u32 v106, s52, v106
  s_nop 7
  s_cmp_lt_u32 s69, 64
  s_cbranch_scc1 L_slow_loop
  s_nop 3
  v_mov_b32 v113, v64
  v_mov_b32 v114, v64
  s_nop 1
  v_permlane32_swap_b32 v113, v114
  s_branch L_fin
L_code_end:
.section .rodata,"a"
.p2align 6
.amdhsa_kernel parallel_sum__softmax_full_mha__glu_gated_reglu__prompt_kernel
  .amdhsa_next_free_vgpr 252
  .amdhsa_next_free_sgpr 72
  .amdhsa_accum_offset 252
  .amdhsa_group_segment_fixed_size 0
  .amdhsa_kernarg_size 80
  .amdhsa_user_sgpr_count 2
  .amdhsa_user_sgpr_kernarg_segment_ptr 1
  .amdhsa_system_sgpr_workgroup_id_x 1
.end_amdhsa_kernel
```
